```python
import torch

def _softmax(x, axis=-1):
    return torch.softmax(x, dim=axis)
def _gelu(x):
    return torch.nn.functional.gelu(x, approximate="tanh")
def _silu(x):
    return torch.nn.functional.silu(x)
def _sigmoid(x):
    return torch.sigmoid(x)
def _layernorm(x, axis=-1, eps=1e-5):
    m = x.mean(dim=axis, keepdim=True)
    v = x.var(dim=axis, keepdim=True, unbiased=False)
    return (x - m) / torch.sqrt(v + eps)
def _scatter_add(tgt, idx, src, axis=0):
    return tgt.clone().index_add_(axis, idx, src)
def _segment_sum(src, seg, n):
    out = torch.zeros((n,) + src.shape[1:], dtype=src.dtype)
    return out.index_add_(0, seg, src)
def _pad(x, pw):
    flat = tuple(v for pair in reversed(pw) for v in pair)
    return torch.nn.functional.pad(x, flat)

kernel_name = 'gated_mix__mha_block__mixer_s_mlp__prompt'

def setup_inputs():

    _w = (lambda a: (lambda t: t.to(torch.bfloat16) if t.is_floating_point() else t)(torch.as_tensor(a)))
    def _A_setup():
        B, S, D, H = 1, 2048, 1024, 32
        return {
            "x": _w((lambda *s: torch.randn(*s, dtype=torch.bfloat16) * 0.1)(B, S, D)),
            "wqkv": _w((lambda *s: torch.randn(*s, dtype=torch.bfloat16) * 0.4)(D, 3 * D)),
            "wo": _w((lambda *s: torch.randn(*s, dtype=torch.bfloat16) * 0.4)(D, D)),
        }
    _A_in = _A_setup()

    def _B_setup():
        B, S, D, F = 1, 2048, 1024, 3584
        return {
            "x":  _w((lambda *s: torch.randn(*s, dtype=torch.bfloat16) * 0.1)(B, S, D)),
            "w1": _w((lambda *s: torch.randn(*s, dtype=torch.bfloat16) * 3.2)(D, D) * (D ** -0.5)),
            "w2": _w((lambda *s: torch.randn(*s, dtype=torch.bfloat16) * 3.2)(D, D) * (D ** -0.5)),
            "w3": _w((lambda *s: torch.randn(*s, dtype=torch.bfloat16) * 3.2)(D, F) * (D ** -0.5)),
            "w4": _w((lambda *s: torch.randn(*s, dtype=torch.bfloat16) * 3.2)(F, D) * (F ** -0.5)),
        }
    _B_in = _B_setup()

    return {
        "A_x": _A_in["x"],
        "A_wqkv": _A_in["wqkv"],
        "A_wo": _A_in["wo"],
        "B_x": _B_in["x"],
        "B_w1": _B_in["w1"],
        "B_w2": _B_in["w2"],
        "B_w3": _B_in["w3"],
        "B_w4": _B_in["w4"],
        "gate_w": _w((lambda *s: torch.randn(*s, dtype=torch.bfloat16) * 0.4)(1024) * 16.0),
    }

def reference(A_x, A_wqkv, A_wo, B_x, B_w1, B_w2, B_w3, B_w4, gate_w):
    def _A_ref(x, wqkv, wo):
        B, S, D = x.shape
        H = 32
        Dh = D // H
        qkv = (lambda x, *d: x.permute(*d))((x @ wqkv).reshape(B, S, 3, H, Dh), 2, 0, 3, 1, 4)
        q, k, v = qkv[0], qkv[1], qkv[2]
        scores = torch.einsum("bhqd,bhkd->bhqk", q, k) * (Dh ** -0.5)
        p = _softmax(scores, axis=-1)
        o = torch.einsum("bhqk,bhkd->bhqd", p, v)
        return (lambda x, *d: x.permute(*d))(o, 0, 2, 1, 3).reshape(B, S, D) @ wo

    def _B_ref(x, w1, w2, w3, w4):
        B, S, D = x.shape
        h = _gelu(_layernorm(x, axis=-1) @ w1)
        c = D // 4
        g0 = _pad(h[:, :, 0*c:1*c], ((0, 0), (1, 0), (0, 0)))[:, :S, :]
        g1 = _pad(h[:, :, 1*c:2*c], ((0, 0), (0, 1), (0, 0)))[:, 1:, :]
        g2 = _pad(h[:, :, 2*c:3*c], ((0, 0), (2, 0), (0, 0)))[:, :S, :]
        g3 = _pad(h[:, :, 3*c:   ], ((0, 0), (0, 2), (0, 0)))[:, 2:, :]
        hs = torch.concatenate([g0, g1, g2, g3], axis=-1) @ w2
        x1 = x + hs
        h2 = _gelu(_layernorm(x1, axis=-1) @ w3) @ w4
        return x1 + h2

    x = A_x
    g = _sigmoid((x * gate_w).sum(-1, keepdims=True))
    a = _A_ref(x, A_wqkv, A_wo)
    b = _B_ref(x, B_w1, B_w2, B_w3, B_w4)
    return g * a + (1 - g) * b
```

```asm
; @launch kernel=k1_kernel grid=(256,1,1) block=(512,1,1) lds=149568
; @launch kernel=k2_kernel grid=(512,1,1) block=(256,1,1) lds=81920
.amdgcn_target "amdgcn-amd-amdhsa--gfx950"
.text
.globl k1_kernel
.p2align 8
.type k1_kernel,@function
k1_kernel:
    s_cmp_ge_u32 s2, 256
    s_cbranch_scc1 k1_end
    s_load_dwordx4 s[48:51], s[0:1], 0
    s_load_dwordx4 s[52:55], s[0:1], 32
    s_load_dwordx2 s[56:57], s[0:1], 64
    s_load_dwordx4 s[60:63], s[0:1], 80
    v_lshrrev_b32 v1, 6, v0
    s_and_b32 s32, s2, 7
    v_readfirstlane_b32 s66, v1
    s_lshr_b32 s33, s2, 3
    s_and_b32 s64, s32, 1
    s_lshl_b32 s64, s64, 3
    s_and_b32 s34, s33, 7
    s_add_u32 s64, s64, s34
    s_lshr_b32 s65, s32, 1
    s_lshl_b32 s65, s65, 2
    s_lshr_b32 s34, s33, 3
    s_add_u32 s65, s65, s34
    s_lshl_b32 s24, s64, 7
    s_add_u32 s68, s64, s65
    s_and_b32 s68, s68, 15
    s_and_b32 s16, s66, 3
    s_cmp_ge_u32 s66, 4
    s_cbranch_scc1 k1_loader
    v_and_b32 v185, 63, v0
    s_lshr_b32 s17, s16, 1
    s_and_b32 s18, s16, 1
    v_and_b32 v186, 31, v185
    s_mul_i32 s32, s17, 64
    v_add_u32 v186, s32, v186
    v_lshlrev_b32 v186, 7, v186
    v_lshrrev_b32 v187, 5, v185
    v_bfe_u32 v188, v185, 1, 3
    v_xor_b32 v187, v187, v188
    v_lshl_add_u32 v180, v187, 4, v186
    v_xor_b32 v181, 32, v180
    v_xor_b32 v182, 64, v180
    v_xor_b32 v183, 96, v180
    v_lshrrev_b32 v186, 5, v185
    v_mul_u32_u24 v186, 1024, v186
    v_bfe_u32 v187, v185, 2, 2
    v_lshl_add_u32 v186, v187, 6, v186
    v_bfe_u32 v187, v185, 4, 1
    v_lshl_add_u32 v186, v187, 5, v186
    v_and_b32 v187, 3, v185
    v_lshl_add_u32 v186, v187, 3, v186
    s_mul_i32 s32, s18, 256
    s_add_u32 s32, s32, 16384
    v_add_u32 v184, s32, v186
    s_mov_b32 s28, 0
    v_lshlrev_b32 v232, 4, v185
    v_lshlrev_b32 v235, 2, v185
    v_mov_b32 v234, 0
    v_mov_b32 v192, 0
    v_mov_b32 v193, 0
    v_mov_b32 v194, 0
    v_mov_b32 v195, 0
    v_mov_b32 v196, 0
    v_and_b32 v186, 31, v185
    s_lshl_b32 s32, s17, 6
    s_add_u32 s32, s32, s24
    v_add_u32 v187, s32, v186
    v_lshlrev_b32 v200, 7, v187
    v_add_u32 v201, 4096, v200
    v_lshlrev_b32 v202, 2, v186
    s_waitcnt lgkmcnt(0)
    s_mov_b32 s8, s48
    s_and_b32 s9, s49, 0xffff
    s_mov_b32 s10, 4194304
    s_mov_b32 s11, 0x00020000
    s_mov_b32 s12, s52
    s_and_b32 s13, s53, 0xffff
    s_mov_b32 s14, 2097152
    s_mov_b32 s15, 0x00020000
    s_mov_b32 s36, s62
    s_and_b32 s37, s63, 0xffff
    s_mov_b32 s38, 65011712
    s_mov_b32 s39, 0x00020000
    s_mov_b32 s40, s60
    s_and_b32 s41, s61, 0xffff
    s_mov_b32 s42, 256
    s_mov_b32 s43, 0x00020000
    s_lshl_b32 s32, s2, 7
    s_add_u32 s32, s32, 41762816
    buffer_store_dword v234, v234, s[36:39], s32 offen
    s_lshr_b32 s46, s2, 3
    s_lshl_b32 s46, s46, 2
    s_add_u32 s46, s46, s16
    s_lshl_b32 s46, s46, 10
    s_cmp_ge_u32 s46, code_end-k1_kernel
    s_cbranch_scc1 cpf_k1a_end
    s_getpc_b64 s[44:45]
cpf_k1a:
    s_add_u32 s46, s46, k1_kernel-cpf_k1a+0x10000
    s_sub_u32 s44, s44, 0x10000
    s_subb_u32 s45, s45, 0
    v_lshl_add_u32 v224, v185, 4, s46
    v_mov_b32 v225, s45
    v_add_co_u32 v224, vcc, s44, v224
    s_nop 1
    v_addc_co_u32 v225, vcc, 0, v225, vcc
    global_load_dwordx4 v[228:231], v[224:225], off
cpf_k1a_end:
    v_lshrrev_b32 v189, 5, v185
    v_lshl_add_u32 v236, v189, 6, v200
    v_lshlrev_b32 v189, 15, v189
    v_add_u32 v237, v189, v202
    s_mov_b32 s70, 0
    s_mov_b32 s69, 1
    s_setprio 2
    s_barrier
    ds_read_b64_tr_b16 v[148:149], v184 offset:0
    ds_read_b64_tr_b16 v[150:151], v184 offset:512
    ds_read_b128 v[132:135], v180 offset:0
    ds_read_b128 v[136:139], v180 offset:4096
    ds_read_b64_tr_b16 v[152:153], v184 offset:8192
    ds_read_b64_tr_b16 v[154:155], v184 offset:8704
    ds_read_b64_tr_b16 v[156:157], v184 offset:16384
    ds_read_b64_tr_b16 v[158:159], v184 offset:16896
    ds_read_b64_tr_b16 v[160:161], v184 offset:24576
    ds_read_b64_tr_b16 v[162:163], v184 offset:25088
    s_waitcnt lgkmcnt(7)
    v_mfma_f32_32x32x16_bf16 v[4:19], v[148:151], v[132:135], 0
    ds_read_b64_tr_b16 v[164:165], v184 offset:2048
    ds_read_b64_tr_b16 v[166:167], v184 offset:2560
    s_waitcnt lgkmcnt(8)
    v_mfma_f32_32x32x16_bf16 v[20:35], v[148:151], v[136:139], 0
    ds_read_b128 v[140:143], v181 offset:0
    ds_read_b128 v[144:147], v181 offset:4096
    s_waitcnt lgkmcnt(8)
    v_mfma_f32_32x32x16_bf16 v[36:51], v[152:155], v[132:135], 0
    ds_read_b64_tr_b16 v[168:169], v184 offset:10240
    ds_read_b64_tr_b16 v[170:171], v184 offset:10752
    v_mfma_f32_32x32x16_bf16 v[52:67], v[152:155], v[136:139], 0
    ds_read_b64_tr_b16 v[172:173], v184 offset:18432
    ds_read_b64_tr_b16 v[174:175], v184 offset:18944
    s_waitcnt lgkmcnt(10)
    v_mfma_f32_32x32x16_bf16 v[68:83], v[132:135], v[156:159], 0
    ds_read_b64_tr_b16 v[176:177], v184 offset:26624
    ds_read_b64_tr_b16 v[178:179], v184 offset:27136
    v_mfma_f32_32x32x16_bf16 v[84:99], v[136:139], v[156:159], 0
    s_waitcnt lgkmcnt(10)
    v_mfma_f32_32x32x16_bf16 v[100:115], v[160:163], v[132:135], 0
    v_mfma_f32_32x32x16_bf16 v[116:131], v[160:163], v[136:139], 0
    s_waitcnt lgkmcnt(7)
    v_mfma_f32_32x32x16_bf16 v[4:19], v[164:167], v[140:143], v[4:19]
    ds_read_b64_tr_b16 v[148:149], v184 offset:4096
    ds_read_b64_tr_b16 v[150:151], v184 offset:4608
    s_waitcnt lgkmcnt(8)
    v_mfma_f32_32x32x16_bf16 v[20:35], v[164:167], v[144:147], v[20:35]
    ds_read_b128 v[132:135], v182 offset:0
    ds_read_b128 v[136:139], v182 offset:4096
    s_waitcnt lgkmcnt(8)
    v_mfma_f32_32x32x16_bf16 v[36:51], v[168:171], v[140:143], v[36:51]
    ds_read_b64_tr_b16 v[152:153], v184 offset:12288
    ds_read_b64_tr_b16 v[154:155], v184 offset:12800
    v_mfma_f32_32x32x16_bf16 v[52:67], v[168:171], v[144:147], v[52:67]
    ds_read_b64_tr_b16 v[156:157], v184 offset:20480
    ds_read_b64_tr_b16 v[158:159], v184 offset:20992
    s_waitcnt lgkmcnt(10)
    v_mfma_f32_32x32x16_bf16 v[68:83], v[140:143], v[172:175], v[68:83]
    ds_read_b64_tr_b16 v[160:161], v184 offset:28672
    ds_read_b64_tr_b16 v[162:163], v184 offset:29184
    v_mfma_f32_32x32x16_bf16 v[84:99], v[144:147], v[172:175], v[84:99]
    s_waitcnt lgkmcnt(10)
    v_mfma_f32_32x32x16_bf16 v[100:115], v[176:179], v[140:143], v[100:115]
    v_mfma_f32_32x32x16_bf16 v[116:131], v[176:179], v[144:147], v[116:131]
    s_waitcnt lgkmcnt(7)
    v_mfma_f32_32x32x16_bf16 v[4:19], v[148:151], v[132:135], v[4:19]
    ds_read_b64_tr_b16 v[164:165], v184 offset:6144
    ds_read_b64_tr_b16 v[166:167], v184 offset:6656
    s_waitcnt lgkmcnt(8)
    v_mfma_f32_32x32x16_bf16 v[20:35], v[148:151], v[136:139], v[20:35]
    ds_read_b128 v[140:143], v183 offset:0
    ds_read_b128 v[144:147], v183 offset:4096
    s_waitcnt lgkmcnt(8)
    v_mfma_f32_32x32x16_bf16 v[36:51], v[152:155], v[132:135], v[36:51]
    ds_read_b64_tr_b16 v[168:169], v184 offset:14336
    ds_read_b64_tr_b16 v[170:171], v184 offset:14848
    v_mfma_f32_32x32x16_bf16 v[52:67], v[152:155], v[136:139], v[52:67]
    ds_read_b64_tr_b16 v[172:173], v184 offset:22528
    ds_read_b64_tr_b16 v[174:175], v184 offset:23040
    s_waitcnt lgkmcnt(10)
    v_mfma_f32_32x32x16_bf16 v[68:83], v[132:135], v[156:159], v[68:83]
    ds_read_b64_tr_b16 v[176:177], v184 offset:30720
    ds_read_b64_tr_b16 v[178:179], v184 offset:31232
    v_mfma_f32_32x32x16_bf16 v[84:99], v[136:139], v[156:159], v[84:99]
    s_add_u32 s28, s28, 49152
    s_cmp_ge_u32 s28, 147456
    s_waitcnt lgkmcnt(10)
    v_mfma_f32_32x32x16_bf16 v[100:115], v[160:163], v[132:135], v[100:115]
    s_cselect_b32 s29, 147456, 0
    s_sub_u32 s28, s28, s29
    v_mfma_f32_32x32x16_bf16 v[116:131], v[160:163], v[136:139], v[116:131]
    s_sub_u32 s29, 49152, s29
    v_add_u32 v180, s29, v180
    v_add_u32 v181, s29, v181
    v_add_u32 v182, s29, v182
    v_add_u32 v183, s29, v183
    v_add_u32 v184, s29, v184
    s_waitcnt lgkmcnt(0)
    v_mfma_f32_32x32x16_bf16 v[4:19], v[164:167], v[140:143], v[4:19]
    s_barrier
    v_mfma_f32_32x32x16_bf16 v[20:35], v[164:167], v[144:147], v[20:35]
    ds_read_b64_tr_b16 v[148:149], v184 offset:0
    ds_read_b64_tr_b16 v[150:151], v184 offset:512
    v_mfma_f32_32x32x16_bf16 v[36:51], v[168:171], v[140:143], v[36:51]
    ds_read_b128 v[132:135], v180 offset:0
    ds_read_b128 v[136:139], v180 offset:4096
    v_mfma_f32_32x32x16_bf16 v[52:67], v[168:171], v[144:147], v[52:67]
    ds_read_b64_tr_b16 v[152:153], v184 offset:8192
    ds_read_b64_tr_b16 v[154:155], v184 offset:8704
    v_mfma_f32_32x32x16_bf16 v[68:83], v[140:143], v[172:175], v[68:83]
    ds_read_b64_tr_b16 v[156:157], v184 offset:16384
    ds_read_b64_tr_b16 v[158:159], v184 offset:16896
    v_mfma_f32_32x32x16_bf16 v[84:99], v[144:147], v[172:175], v[84:99]
    ds_read_b64_tr_b16 v[160:161], v184 offset:24576
    ds_read_b64_tr_b16 v[162:163], v184 offset:25088
    v_mfma_f32_32x32x16_bf16 v[100:115], v[176:179], v[140:143], v[100:115]
    v_mfma_f32_32x32x16_bf16 v[116:131], v[176:179], v[144:147], v[116:131]
    s_waitcnt lgkmcnt(7)
    v_mfma_f32_32x32x16_bf16 v[4:19], v[148:151], v[132:135], v[4:19]
    ds_read_b64_tr_b16 v[164:165], v184 offset:2048
    ds_read_b64_tr_b16 v[166:167], v184 offset:2560
    s_waitcnt lgkmcnt(8)
    v_mfma_f32_32x32x16_bf16 v[20:35], v[148:151], v[136:139], v[20:35]
    ds_read_b128 v[140:143], v181 offset:0
    ds_read_b128 v[144:147], v181 offset:4096
    s_waitcnt lgkmcnt(8)
    v_mfma_f32_32x32x16_bf16 v[36:51], v[152:155], v[132:135], v[36:51]
    ds_read_b64_tr_b16 v[168:169], v184 offset:10240
    ds_read_b64_tr_b16 v[170:171], v184 offset:10752
    v_mfma_f32_32x32x16_bf16 v[52:67], v[152:155], v[136:139], v[52:67]
    ds_read_b64_tr_b16 v[172:173], v184 offset:18432
    ds_read_b64_tr_b16 v[174:175], v184 offset:18944
    s_waitcnt lgkmcnt(10)
    v_mfma_f32_32x32x16_bf16 v[68:83], v[132:135], v[156:159], v[68:83]
    ds_read_b64_tr_b16 v[176:177], v184 offset:26624
    ds_read_b64_tr_b16 v[178:179], v184 offset:27136
    v_mfma_f32_32x32x16_bf16 v[84:99], v[136:139], v[156:159], v[84:99]
    s_waitcnt lgkmcnt(10)
    v_mfma_f32_32x32x16_bf16 v[100:115], v[160:163], v[132:135], v[100:115]
    v_mfma_f32_32x32x16_bf16 v[116:131], v[160:163], v[136:139], v[116:131]
    s_waitcnt lgkmcnt(7)
    v_mfma_f32_32x32x16_bf16 v[4:19], v[164:167], v[140:143], v[4:19]
    ds_read_b64_tr_b16 v[148:149], v184 offset:4096
    ds_read_b64_tr_b16 v[150:151], v184 offset:4608
    s_waitcnt lgkmcnt(8)
    v_mfma_f32_32x32x16_bf16 v[20:35], v[164:167], v[144:147], v[20:35]
    ds_read_b128 v[132:135], v182 offset:0
    ds_read_b128 v[136:139], v182 offset:4096
    s_waitcnt lgkmcnt(8)
    v_mfma_f32_32x32x16_bf16 v[36:51], v[168:171], v[140:143], v[36:51]
    ds_read_b64_tr_b16 v[152:153], v184 offset:12288
    ds_read_b64_tr_b16 v[154:155], v184 offset:12800
    v_mfma_f32_32x32x16_bf16 v[52:67], v[168:171], v[144:147], v[52:67]
    ds_read_b64_tr_b16 v[156:157], v184 offset:20480
    ds_read_b64_tr_b16 v[158:159], v184 offset:20992
    s_waitcnt lgkmcnt(10)
    v_mfma_f32_32x32x16_bf16 v[68:83], v[140:143], v[172:175], v[68:83]
    ds_read_b64_tr_b16 v[160:161], v184 offset:28672
    ds_read_b64_tr_b16 v[162:163], v184 offset:29184
    v_mfma_f32_32x32x16_bf16 v[84:99], v[144:147], v[172:175], v[84:99]
    s_waitcnt lgkmcnt(10)
    v_mfma_f32_32x32x16_bf16 v[100:115], v[176:179], v[140:143], v[100:115]
    v_mfma_f32_32x32x16_bf16 v[116:131], v[176:179], v[144:147], v[116:131]
    s_waitcnt lgkmcnt(7)
    v_mfma_f32_32x32x16_bf16 v[4:19], v[148:151], v[132:135], v[4:19]
    ds_read_b64_tr_b16 v[164:165], v184 offset:6144
    ds_read_b64_tr_b16 v[166:167], v184 offset:6656
    s_waitcnt lgkmcnt(8)
    v_mfma_f32_32x32x16_bf16 v[20:35], v[148:151], v[136:139], v[20:35]
    ds_read_b128 v[140:143], v183 offset:0
    ds_read_b128 v[144:147], v183 offset:4096
    s_waitcnt lgkmcnt(8)
    v_mfma_f32_32x32x16_bf16 v[36:51], v[152:155], v[132:135], v[36:51]
    ds_read_b64_tr_b16 v[168:169], v184 offset:14336
    ds_read_b64_tr_b16 v[170:171], v184 offset:14848
    v_mfma_f32_32x32x16_bf16 v[52:67], v[152:155], v[136:139], v[52:67]
    ds_read_b64_tr_b16 v[172:173], v184 offset:22528
    ds_read_b64_tr_b16 v[174:175], v184 offset:23040
    s_waitcnt lgkmcnt(10)
    v_mfma_f32_32x32x16_bf16 v[68:83], v[132:135], v[156:159], v[68:83]
    ds_read_b64_tr_b16 v[176:177], v184 offset:30720
    ds_read_b64_tr_b16 v[178:179], v184 offset:31232
    v_mfma_f32_32x32x16_bf16 v[84:99], v[136:139], v[156:159], v[84:99]
    s_add_u32 s28, s28, 49152
    s_cmp_ge_u32 s28, 147456
    s_waitcnt lgkmcnt(10)
    v_mfma_f32_32x32x16_bf16 v[100:115], v[160:163], v[132:135], v[100:115]
    s_cselect_b32 s29, 147456, 0
    s_sub_u32 s28, s28, s29
    v_mfma_f32_32x32x16_bf16 v[116:131], v[160:163], v[136:139], v[116:131]
    s_sub_u32 s29, 49152, s29
    v_add_u32 v180, s29, v180
    v_add_u32 v181, s29, v181
    v_add_u32 v182, s29, v182
    v_add_u32 v183, s29, v183
    v_add_u32 v184, s29, v184
    s_waitcnt lgkmcnt(0)
    v_mfma_f32_32x32x16_bf16 v[4:19], v[164:167], v[140:143], v[4:19]
    s_barrier
    v_mfma_f32_32x32x16_bf16 v[20:35], v[164:167], v[144:147], v[20:35]
    ds_read_b64_tr_b16 v[148:149], v184 offset:0
    ds_read_b64_tr_b16 v[150:151], v184 offset:512
    v_mfma_f32_32x32x16_bf16 v[36:51], v[168:171], v[140:143], v[36:51]
    ds_read_b128 v[132:135], v180 offset:0
    ds_read_b128 v[136:139], v180 offset:4096
    v_mfma_f32_32x32x16_bf16 v[52:67], v[168:171], v[144:147], v[52:67]
    ds_read_b64_tr_b16 v[152:153], v184 offset:8192
    ds_read_b64_tr_b16 v[154:155], v184 offset:8704
    v_mfma_f32_32x32x16_bf16 v[68:83], v[140:143], v[172:175], v[68:83]
    ds_read_b64_tr_b16 v[156:157], v184 offset:16384
    ds_read_b64_tr_b16 v[158:159], v184 offset:16896
    v_mfma_f32_32x32x16_bf16 v[84:99], v[144:147], v[172:175], v[84:99]
    ds_read_b64_tr_b16 v[160:161], v184 offset:24576
    ds_read_b64_tr_b16 v[162:163], v184 offset:25088
    v_mfma_f32_32x32x16_bf16 v[100:115], v[176:179], v[140:143], v[100:115]
    v_mfma_f32_32x32x16_bf16 v[116:131], v[176:179], v[144:147], v[116:131]
    s_waitcnt lgkmcnt(7)
    v_mfma_f32_32x32x16_bf16 v[4:19], v[148:151], v[132:135], v[4:19]
    ds_read_b64_tr_b16 v[164:165], v184 offset:2048
    ds_read_b64_tr_b16 v[166:167], v184 offset:2560
    s_waitcnt lgkmcnt(8)
    v_mfma_f32_32x32x16_bf16 v[20:35], v[148:151], v[136:139], v[20:35]
    ds_read_b128 v[140:143], v181 offset:0
    ds_read_b128 v[144:147], v181 offset:4096
    s_waitcnt lgkmcnt(8)
    v_mfma_f32_32x32x16_bf16 v[36:51], v[152:155], v[132:135], v[36:51]
    ds_read_b64_tr_b16 v[168:169], v184 offset:10240
    ds_read_b64_tr_b16 v[170:171], v184 offset:10752
    v_mfma_f32_32x32x16_bf16 v[52:67], v[152:155], v[136:139], v[52:67]
    ds_read_b64_tr_b16 v[172:173], v184 offset:18432
    ds_read_b64_tr_b16 v[174:175], v184 offset:18944
    s_waitcnt lgkmcnt(10)
    v_mfma_f32_32x32x16_bf16 v[68:83], v[132:135], v[156:159], v[68:83]
    ds_read_b64_tr_b16 v[176:177], v184 offset:26624
    ds_read_b64_tr_b16 v[178:179], v184 offset:27136
    v_mfma_f32_32x32x16_bf16 v[84:99], v[136:139], v[156:159], v[84:99]
    s_waitcnt lgkmcnt(10)
    v_mfma_f32_32x32x16_bf16 v[100:115], v[160:163], v[132:135], v[100:115]
    v_mfma_f32_32x32x16_bf16 v[116:131], v[160:163], v[136:139], v[116:131]
    s_waitcnt lgkmcnt(7)
    v_mfma_f32_32x32x16_bf16 v[4:19], v[164:167], v[140:143], v[4:19]
    ds_read_b64_tr_b16 v[148:149], v184 offset:4096
    ds_read_b64_tr_b16 v[150:151], v184 offset:4608
    s_waitcnt lgkmcnt(8)
    v_mfma_f32_32x32x16_bf16 v[20:35], v[164:167], v[144:147], v[20:35]
    ds_read_b128 v[132:135], v182 offset:0
    ds_read_b128 v[136:139], v182 offset:4096
    s_waitcnt lgkmcnt(8)
    v_mfma_f32_32x32x16_bf16 v[36:51], v[168:171], v[140:143], v[36:51]
    ds_read_b64_tr_b16 v[152:153], v184 offset:12288
    ds_read_b64_tr_b16 v[154:155], v184 offset:12800
    v_mfma_f32_32x32x16_bf16 v[52:67], v[168:171], v[144:147], v[52:67]
    ds_read_b64_tr_b16 v[156:157], v184 offset:20480
    ds_read_b64_tr_b16 v[158:159], v184 offset:20992
    s_waitcnt lgkmcnt(10)
    v_mfma_f32_32x32x16_bf16 v[68:83], v[140:143], v[172:175], v[68:83]
    ds_read_b64_tr_b16 v[160:161], v184 offset:28672
    ds_read_b64_tr_b16 v[162:163], v184 offset:29184
    v_mfma_f32_32x32x16_bf16 v[84:99], v[144:147], v[172:175], v[84:99]
    s_waitcnt lgkmcnt(10)
    v_mfma_f32_32x32x16_bf16 v[100:115], v[176:179], v[140:143], v[100:115]
    v_mfma_f32_32x32x16_bf16 v[116:131], v[176:179], v[144:147], v[116:131]
    s_waitcnt lgkmcnt(7)
    v_mfma_f32_32x32x16_bf16 v[4:19], v[148:151], v[132:135], v[4:19]
    ds_read_b64_tr_b16 v[164:165], v184 offset:6144
    ds_read_b64_tr_b16 v[166:167], v184 offset:6656
    s_waitcnt lgkmcnt(8)
    v_mfma_f32_32x32x16_bf16 v[20:35], v[148:151], v[136:139], v[20:35]
    ds_read_b128 v[140:143], v183 offset:0
    ds_read_b128 v[144:147], v183 offset:4096
    s_waitcnt lgkmcnt(8)
    v_mfma_f32_32x32x16_bf16 v[36:51], v[152:155], v[132:135], v[36:51]
    ds_read_b64_tr_b16 v[168:169], v184 offset:14336
    ds_read_b64_tr_b16 v[170:171], v184 offset:14848
    v_mfma_f32_32x32x16_bf16 v[52:67], v[152:155], v[136:139], v[52:67]
    ds_read_b64_tr_b16 v[172:173], v184 offset:22528
    ds_read_b64_tr_b16 v[174:175], v184 offset:23040
    s_waitcnt lgkmcnt(10)
    v_mfma_f32_32x32x16_bf16 v[68:83], v[132:135], v[156:159], v[68:83]
    ds_read_b64_tr_b16 v[176:177], v184 offset:30720
    ds_read_b64_tr_b16 v[178:179], v184 offset:31232
    v_mfma_f32_32x32x16_bf16 v[84:99], v[136:139], v[156:159], v[84:99]
    s_add_u32 s28, s28, 49152
    s_cmp_ge_u32 s28, 147456
    s_waitcnt lgkmcnt(10)
    v_mfma_f32_32x32x16_bf16 v[100:115], v[160:163], v[132:135], v[100:115]
    s_cselect_b32 s29, 147456, 0
    s_sub_u32 s28, s28, s29
    v_mfma_f32_32x32x16_bf16 v[116:131], v[160:163], v[136:139], v[116:131]
    s_sub_u32 s29, 49152, s29
    v_add_u32 v180, s29, v180
    v_add_u32 v181, s29, v181
    v_add_u32 v182, s29, v182
    v_add_u32 v183, s29, v183
    v_add_u32 v184, s29, v184
    s_waitcnt lgkmcnt(0)
    v_mfma_f32_32x32x16_bf16 v[4:19], v[164:167], v[140:143], v[4:19]
    s_barrier
    v_mfma_f32_32x32x16_bf16 v[20:35], v[164:167], v[144:147], v[20:35]
    ds_read_b64_tr_b16 v[148:149], v184 offset:0
    ds_read_b64_tr_b16 v[150:151], v184 offset:512
    v_mfma_f32_32x32x16_bf16 v[36:51], v[168:171], v[140:143], v[36:51]
    ds_read_b128 v[132:135], v180 offset:0
    ds_read_b128 v[136:139], v180 offset:4096
    v_mfma_f32_32x32x16_bf16 v[52:67], v[168:171], v[144:147], v[52:67]
    ds_read_b64_tr_b16 v[152:153], v184 offset:8192
    ds_read_b64_tr_b16 v[154:155], v184 offset:8704
    v_mfma_f32_32x32x16_bf16 v[68:83], v[140:143], v[172:175], v[68:83]
    ds_read_b64_tr_b16 v[156:157], v184 offset:16384
    ds_read_b64_tr_b16 v[158:159], v184 offset:16896
    v_mfma_f32_32x32x16_bf16 v[84:99], v[144:147], v[172:175], v[84:99]
    ds_read_b64_tr_b16 v[160:161], v184 offset:24576
    ds_read_b64_tr_b16 v[162:163], v184 offset:25088
    v_mfma_f32_32x32x16_bf16 v[100:115], v[176:179], v[140:143], v[100:115]
    v_mfma_f32_32x32x16_bf16 v[116:131], v[176:179], v[144:147], v[116:131]
    s_waitcnt lgkmcnt(7)
    v_mfma_f32_32x32x16_bf16 v[4:19], v[148:151], v[132:135], v[4:19]
    ds_read_b64_tr_b16 v[164:165], v184 offset:2048
    ds_read_b64_tr_b16 v[166:167], v184 offset:2560
    s_waitcnt lgkmcnt(8)
    v_mfma_f32_32x32x16_bf16 v[20:35], v[148:151], v[136:139], v[20:35]
    ds_read_b128 v[140:143], v181 offset:0
    ds_read_b128 v[144:147], v181 offset:4096
    s_waitcnt lgkmcnt(8)
    v_mfma_f32_32x32x16_bf16 v[36:51], v[152:155], v[132:135], v[36:51]
    ds_read_b64_tr_b16 v[168:169], v184 offset:10240
    ds_read_b64_tr_b16 v[170:171], v184 offset:10752
    v_mfma_f32_32x32x16_bf16 v[52:67], v[152:155], v[136:139], v[52:67]
    ds_read_b64_tr_b16 v[172:173], v184 offset:18432
    ds_read_b64_tr_b16 v[174:175], v184 offset:18944
    s_waitcnt lgkmcnt(10)
    v_mfma_f32_32x32x16_bf16 v[68:83], v[132:135], v[156:159], v[68:83]
    ds_read_b64_tr_b16 v[176:177], v184 offset:26624
    ds_read_b64_tr_b16 v[178:179], v184 offset:27136
    v_mfma_f32_32x32x16_bf16 v[84:99], v[136:139], v[156:159], v[84:99]
    s_waitcnt lgkmcnt(10)
    v_mfma_f32_32x32x16_bf16 v[100:115], v[160:163], v[132:135], v[100:115]
    v_mfma_f32_32x32x16_bf16 v[116:131], v[160:163], v[136:139], v[116:131]
    s_waitcnt lgkmcnt(7)
    v_mfma_f32_32x32x16_bf16 v[4:19], v[164:167], v[140:143], v[4:19]
    ds_read_b64_tr_b16 v[148:149], v184 offset:4096
    ds_read_b64_tr_b16 v[150:151], v184 offset:4608
    s_waitcnt lgkmcnt(8)
    v_mfma_f32_32x32x16_bf16 v[20:35], v[164:167], v[144:147], v[20:35]
    ds_read_b128 v[132:135], v182 offset:0
    ds_read_b128 v[136:139], v182 offset:4096
    s_waitcnt lgkmcnt(8)
    v_mfma_f32_32x32x16_bf16 v[36:51], v[168:171], v[140:143], v[36:51]
    ds_read_b64_tr_b16 v[152:153], v184 offset:12288
    ds_read_b64_tr_b16 v[154:155], v184 offset:12800
    v_mfma_f32_32x32x16_bf16 v[52:67], v[168:171], v[144:147], v[52:67]
    ds_read_b64_tr_b16 v[156:157], v184 offset:20480
    ds_read_b64_tr_b16 v[158:159], v184 offset:20992
    s_waitcnt lgkmcnt(10)
    v_mfma_f32_32x32x16_bf16 v[68:83], v[140:143], v[172:175], v[68:83]
    ds_read_b64_tr_b16 v[160:161], v184 offset:28672
    ds_read_b64_tr_b16 v[162:163], v184 offset:29184
    v_mfma_f32_32x32x16_bf16 v[84:99], v[144:147], v[172:175], v[84:99]
    s_waitcnt lgkmcnt(10)
    v_mfma_f32_32x32x16_bf16 v[100:115], v[176:179], v[140:143], v[100:115]
    v_mfma_f32_32x32x16_bf16 v[116:131], v[176:179], v[144:147], v[116:131]
    s_waitcnt lgkmcnt(7)
    v_mfma_f32_32x32x16_bf16 v[4:19], v[148:151], v[132:135], v[4:19]
    ds_read_b64_tr_b16 v[164:165], v184 offset:6144
    ds_read_b64_tr_b16 v[166:167], v184 offset:6656
    s_waitcnt lgkmcnt(8)
    v_mfma_f32_32x32x16_bf16 v[20:35], v[148:151], v[136:139], v[20:35]
    ds_read_b128 v[140:143], v183 offset:0
    ds_read_b128 v[144:147], v183 offset:4096
    s_waitcnt lgkmcnt(8)
    v_mfma_f32_32x32x16_bf16 v[36:51], v[152:155], v[132:135], v[36:51]
    ds_read_b64_tr_b16 v[168:169], v184 offset:14336
    ds_read_b64_tr_b16 v[170:171], v184 offset:14848
    v_mfma_f32_32x32x16_bf16 v[52:67], v[152:155], v[136:139], v[52:67]
    ds_read_b64_tr_b16 v[172:173], v184 offset:22528
    ds_read_b64_tr_b16 v[174:175], v184 offset:23040
    s_waitcnt lgkmcnt(10)
    v_mfma_f32_32x32x16_bf16 v[68:83], v[132:135], v[156:159], v[68:83]
    ds_read_b64_tr_b16 v[176:177], v184 offset:30720
    ds_read_b64_tr_b16 v[178:179], v184 offset:31232
    v_mfma_f32_32x32x16_bf16 v[84:99], v[136:139], v[156:159], v[84:99]
    s_add_u32 s28, s28, 49152
    s_cmp_ge_u32 s28, 147456
    s_waitcnt lgkmcnt(10)
    v_mfma_f32_32x32x16_bf16 v[100:115], v[160:163], v[132:135], v[100:115]
    s_cselect_b32 s29, 147456, 0
    s_sub_u32 s28, s28, s29
    v_mfma_f32_32x32x16_bf16 v[116:131], v[160:163], v[136:139], v[116:131]
    s_sub_u32 s29, 49152, s29
    v_add_u32 v180, s29, v180
    v_add_u32 v181, s29, v181
    v_add_u32 v182, s29, v182
    v_add_u32 v183, s29, v183
    v_add_u32 v184, s29, v184
    s_waitcnt lgkmcnt(0)
    v_mfma_f32_32x32x16_bf16 v[4:19], v[164:167], v[140:143], v[4:19]
    s_barrier
    v_mfma_f32_32x32x16_bf16 v[20:35], v[164:167], v[144:147], v[20:35]
    ds_read_b64_tr_b16 v[148:149], v184 offset:0
    ds_read_b64_tr_b16 v[150:151], v184 offset:512
    v_mfma_f32_32x32x16_bf16 v[36:51], v[168:171], v[140:143], v[36:51]
    ds_read_b128 v[132:135], v180 offset:0
    ds_read_b128 v[136:139], v180 offset:4096
    v_mfma_f32_32x32x16_bf16 v[52:67], v[168:171], v[144:147], v[52:67]
    ds_read_b64_tr_b16 v[152:153], v184 offset:8192
    ds_read_b64_tr_b16 v[154:155], v184 offset:8704
    v_mfma_f32_32x32x16_bf16 v[68:83], v[140:143], v[172:175], v[68:83]
    ds_read_b64_tr_b16 v[156:157], v184 offset:16384
    ds_read_b64_tr_b16 v[158:159], v184 offset:16896
    v_mfma_f32_32x32x16_bf16 v[84:99], v[144:147], v[172:175], v[84:99]
    ds_read_b64_tr_b16 v[160:161], v184 offset:24576
    ds_read_b64_tr_b16 v[162:163], v184 offset:25088
    v_mfma_f32_32x32x16_bf16 v[100:115], v[176:179], v[140:143], v[100:115]
    v_mfma_f32_32x32x16_bf16 v[116:131], v[176:179], v[144:147], v[116:131]
    s_waitcnt lgkmcnt(7)
    v_mfma_f32_32x32x16_bf16 v[4:19], v[148:151], v[132:135], v[4:19]
    ds_read_b64_tr_b16 v[164:165], v184 offset:2048
    ds_read_b64_tr_b16 v[166:167], v184 offset:2560
    s_waitcnt lgkmcnt(8)
    v_mfma_f32_32x32x16_bf16 v[20:35], v[148:151], v[136:139], v[20:35]
    ds_read_b128 v[140:143], v181 offset:0
    ds_read_b128 v[144:147], v181 offset:4096
    s_waitcnt lgkmcnt(8)
    v_mfma_f32_32x32x16_bf16 v[36:51], v[152:155], v[132:135], v[36:51]
    ds_read_b64_tr_b16 v[168:169], v184 offset:10240
    ds_read_b64_tr_b16 v[170:171], v184 offset:10752
    v_mfma_f32_32x32x16_bf16 v[52:67], v[152:155], v[136:139], v[52:67]
    ds_read_b64_tr_b16 v[172:173], v184 offset:18432
    ds_read_b64_tr_b16 v[174:175], v184 offset:18944
    s_waitcnt lgkmcnt(10)
    v_mfma_f32_32x32x16_bf16 v[68:83], v[132:135], v[156:159], v[68:83]
    ds_read_b64_tr_b16 v[176:177], v184 offset:26624
    ds_read_b64_tr_b16 v[178:179], v184 offset:27136
    v_mfma_f32_32x32x16_bf16 v[84:99], v[136:139], v[156:159], v[84:99]
    s_waitcnt lgkmcnt(10)
    v_mfma_f32_32x32x16_bf16 v[100:115], v[160:163], v[132:135], v[100:115]
    v_mfma_f32_32x32x16_bf16 v[116:131], v[160:163], v[136:139], v[116:131]
    s_waitcnt lgkmcnt(7)
    v_mfma_f32_32x32x16_bf16 v[4:19], v[164:167], v[140:143], v[4:19]
    ds_read_b64_tr_b16 v[148:149], v184 offset:4096
    ds_read_b64_tr_b16 v[150:151], v184 offset:4608
    s_waitcnt lgkmcnt(8)
    v_mfma_f32_32x32x16_bf16 v[20:35], v[164:167], v[144:147], v[20:35]
    ds_read_b128 v[132:135], v182 offset:0
    ds_read_b128 v[136:139], v182 offset:4096
    s_waitcnt lgkmcnt(8)
    v_mfma_f32_32x32x16_bf16 v[36:51], v[168:171], v[140:143], v[36:51]
    ds_read_b64_tr_b16 v[152:153], v184 offset:12288
    ds_read_b64_tr_b16 v[154:155], v184 offset:12800
    v_mfma_f32_32x32x16_bf16 v[52:67], v[168:171], v[144:147], v[52:67]
    ds_read_b64_tr_b16 v[156:157], v184 offset:20480
    ds_read_b64_tr_b16 v[158:159], v184 offset:20992
    s_waitcnt lgkmcnt(10)
    v_mfma_f32_32x32x16_bf16 v[68:83], v[140:143], v[172:175], v[68:83]
    ds_read_b64_tr_b16 v[160:161], v184 offset:28672
    ds_read_b64_tr_b16 v[162:163], v184 offset:29184
    v_mfma_f32_32x32x16_bf16 v[84:99], v[144:147], v[172:175], v[84:99]
    s_waitcnt lgkmcnt(10)
    v_mfma_f32_32x32x16_bf16 v[100:115], v[176:179], v[140:143], v[100:115]
    v_mfma_f32_32x32x16_bf16 v[116:131], v[176:179], v[144:147], v[116:131]
    s_waitcnt lgkmcnt(7)
    v_mfma_f32_32x32x16_bf16 v[4:19], v[148:151], v[132:135], v[4:19]
    ds_read_b64_tr_b16 v[164:165], v184 offset:6144
    ds_read_b64_tr_b16 v[166:167], v184 offset:6656
    s_waitcnt lgkmcnt(8)
    v_mfma_f32_32x32x16_bf16 v[20:35], v[148:151], v[136:139], v[20:35]
    ds_read_b128 v[140:143], v183 offset:0
    ds_read_b128 v[144:147], v183 offset:4096
    s_waitcnt lgkmcnt(8)
    v_mfma_f32_32x32x16_bf16 v[36:51], v[152:155], v[132:135], v[36:51]
    ds_read_b64_tr_b16 v[168:169], v184 offset:14336
    ds_read_b64_tr_b16 v[170:171], v184 offset:14848
    v_mfma_f32_32x32x16_bf16 v[52:67], v[152:155], v[136:139], v[52:67]
    ds_read_b64_tr_b16 v[172:173], v184 offset:22528
    ds_read_b64_tr_b16 v[174:175], v184 offset:23040
    s_waitcnt lgkmcnt(10)
    v_mfma_f32_32x32x16_bf16 v[68:83], v[132:135], v[156:159], v[68:83]
    ds_read_b64_tr_b16 v[176:177], v184 offset:30720
    ds_read_b64_tr_b16 v[178:179], v184 offset:31232
    v_mfma_f32_32x32x16_bf16 v[84:99], v[136:139], v[156:159], v[84:99]
    s_add_u32 s28, s28, 49152
    s_cmp_ge_u32 s28, 147456
    s_waitcnt lgkmcnt(10)
    v_mfma_f32_32x32x16_bf16 v[100:115], v[160:163], v[132:135], v[100:115]
    s_cselect_b32 s29, 147456, 0
    s_sub_u32 s28, s28, s29
    v_mfma_f32_32x32x16_bf16 v[116:131], v[160:163], v[136:139], v[116:131]
    s_sub_u32 s29, 49152, s29
    v_add_u32 v180, s29, v180
    v_add_u32 v181, s29, v181
    v_add_u32 v182, s29, v182
    v_add_u32 v183, s29, v183
    v_add_u32 v184, s29, v184
    s_waitcnt lgkmcnt(0)
    v_mfma_f32_32x32x16_bf16 v[4:19], v[164:167], v[140:143], v[4:19]
    s_barrier
    v_mfma_f32_32x32x16_bf16 v[20:35], v[164:167], v[144:147], v[20:35]
    ds_read_b64_tr_b16 v[148:149], v184 offset:0
    ds_read_b64_tr_b16 v[150:151], v184 offset:512
    v_mfma_f32_32x32x16_bf16 v[36:51], v[168:171], v[140:143], v[36:51]
    ds_read_b128 v[132:135], v180 offset:0
    ds_read_b128 v[136:139], v180 offset:4096
    v_mfma_f32_32x32x16_bf16 v[52:67], v[168:171], v[144:147], v[52:67]
    ds_read_b64_tr_b16 v[152:153], v184 offset:8192
    ds_read_b64_tr_b16 v[154:155], v184 offset:8704
    v_mfma_f32_32x32x16_bf16 v[68:83], v[140:143], v[172:175], v[68:83]
    ds_read_b64_tr_b16 v[156:157], v184 offset:16384
    ds_read_b64_tr_b16 v[158:159], v184 offset:16896
    v_mfma_f32_32x32x16_bf16 v[84:99], v[144:147], v[172:175], v[84:99]
    ds_read_b64_tr_b16 v[160:161], v184 offset:24576
    ds_read_b64_tr_b16 v[162:163], v184 offset:25088
    v_mfma_f32_32x32x16_bf16 v[100:115], v[176:179], v[140:143], v[100:115]
    v_mfma_f32_32x32x16_bf16 v[116:131], v[176:179], v[144:147], v[116:131]
    s_waitcnt lgkmcnt(7)
    v_mfma_f32_32x32x16_bf16 v[4:19], v[148:151], v[132:135], v[4:19]
    ds_read_b64_tr_b16 v[164:165], v184 offset:2048
    ds_read_b64_tr_b16 v[166:167], v184 offset:2560
    s_waitcnt lgkmcnt(8)
    v_mfma_f32_32x32x16_bf16 v[20:35], v[148:151], v[136:139], v[20:35]
    ds_read_b128 v[140:143], v181 offset:0
    ds_read_b128 v[144:147], v181 offset:4096
    s_waitcnt lgkmcnt(8)
    v_mfma_f32_32x32x16_bf16 v[36:51], v[152:155], v[132:135], v[36:51]
    ds_read_b64_tr_b16 v[168:169], v184 offset:10240
    ds_read_b64_tr_b16 v[170:171], v184 offset:10752
    v_mfma_f32_32x32x16_bf16 v[52:67], v[152:155], v[136:139], v[52:67]
    ds_read_b64_tr_b16 v[172:173], v184 offset:18432
    ds_read_b64_tr_b16 v[174:175], v184 offset:18944
    s_waitcnt lgkmcnt(10)
    v_mfma_f32_32x32x16_bf16 v[68:83], v[132:135], v[156:159], v[68:83]
    ds_read_b64_tr_b16 v[176:177], v184 offset:26624
    ds_read_b64_tr_b16 v[178:179], v184 offset:27136
    v_mfma_f32_32x32x16_bf16 v[84:99], v[136:139], v[156:159], v[84:99]
    s_waitcnt lgkmcnt(10)
    v_mfma_f32_32x32x16_bf16 v[100:115], v[160:163], v[132:135], v[100:115]
    v_mfma_f32_32x32x16_bf16 v[116:131], v[160:163], v[136:139], v[116:131]
    s_waitcnt lgkmcnt(7)
    v_mfma_f32_32x32x16_bf16 v[4:19], v[164:167], v[140:143], v[4:19]
    ds_read_b64_tr_b16 v[148:149], v184 offset:4096
    ds_read_b64_tr_b16 v[150:151], v184 offset:4608
    s_waitcnt lgkmcnt(8)
    v_mfma_f32_32x32x16_bf16 v[20:35], v[164:167], v[144:147], v[20:35]
    ds_read_b128 v[132:135], v182 offset:0
    ds_read_b128 v[136:139], v182 offset:4096
    s_waitcnt lgkmcnt(8)
    v_mfma_f32_32x32x16_bf16 v[36:51], v[168:171], v[140:143], v[36:51]
    ds_read_b64_tr_b16 v[152:153], v184 offset:12288
    ds_read_b64_tr_b16 v[154:155], v184 offset:12800
    v_mfma_f32_32x32x16_bf16 v[52:67], v[168:171], v[144:147], v[52:67]
    ds_read_b64_tr_b16 v[156:157], v184 offset:20480
    ds_read_b64_tr_b16 v[158:159], v184 offset:20992
    s_waitcnt lgkmcnt(10)
    v_mfma_f32_32x32x16_bf16 v[68:83], v[140:143], v[172:175], v[68:83]
    ds_read_b64_tr_b16 v[160:161], v184 offset:28672
    ds_read_b64_tr_b16 v[162:163], v184 offset:29184
    v_mfma_f32_32x32x16_bf16 v[84:99], v[144:147], v[172:175], v[84:99]
    s_waitcnt lgkmcnt(10)
    v_mfma_f32_32x32x16_bf16 v[100:115], v[176:179], v[140:143], v[100:115]
    v_mfma_f32_32x32x16_bf16 v[116:131], v[176:179], v[144:147], v[116:131]
    s_waitcnt lgkmcnt(7)
    v_mfma_f32_32x32x16_bf16 v[4:19], v[148:151], v[132:135], v[4:19]
    ds_read_b64_tr_b16 v[164:165], v184 offset:6144
    ds_read_b64_tr_b16 v[166:167], v184 offset:6656
    s_waitcnt lgkmcnt(8)
    v_mfma_f32_32x32x16_bf16 v[20:35], v[148:151], v[136:139], v[20:35]
    ds_read_b128 v[140:143], v183 offset:0
    ds_read_b128 v[144:147], v183 offset:4096
    s_waitcnt lgkmcnt(8)
    v_mfma_f32_32x32x16_bf16 v[36:51], v[152:155], v[132:135], v[36:51]
    ds_read_b64_tr_b16 v[168:169], v184 offset:14336
    ds_read_b64_tr_b16 v[170:171], v184 offset:14848
    v_mfma_f32_32x32x16_bf16 v[52:67], v[152:155], v[136:139], v[52:67]
    ds_read_b64_tr_b16 v[172:173], v184 offset:22528
    ds_read_b64_tr_b16 v[174:175], v184 offset:23040
    s_waitcnt lgkmcnt(10)
    v_mfma_f32_32x32x16_bf16 v[68:83], v[132:135], v[156:159], v[68:83]
    ds_read_b64_tr_b16 v[176:177], v184 offset:30720
    ds_read_b64_tr_b16 v[178:179], v184 offset:31232
    v_mfma_f32_32x32x16_bf16 v[84:99], v[136:139], v[156:159], v[84:99]
    s_add_u32 s28, s28, 49152
    s_cmp_ge_u32 s28, 147456
    s_waitcnt lgkmcnt(10)
    v_mfma_f32_32x32x16_bf16 v[100:115], v[160:163], v[132:135], v[100:115]
    s_cselect_b32 s29, 147456, 0
    s_sub_u32 s28, s28, s29
    v_mfma_f32_32x32x16_bf16 v[116:131], v[160:163], v[136:139], v[116:131]
    s_sub_u32 s29, 49152, s29
    v_add_u32 v180, s29, v180
    v_add_u32 v181, s29, v181
    v_add_u32 v182, s29, v182
    v_add_u32 v183, s29, v183
    v_add_u32 v184, s29, v184
    s_waitcnt lgkmcnt(0)
    v_mfma_f32_32x32x16_bf16 v[4:19], v[164:167], v[140:143], v[4:19]
    s_barrier
    v_mfma_f32_32x32x16_bf16 v[20:35], v[164:167], v[144:147], v[20:35]
    ds_read_b64_tr_b16 v[148:149], v184 offset:0
    ds_read_b64_tr_b16 v[150:151], v184 offset:512
    v_mfma_f32_32x32x16_bf16 v[36:51], v[168:171], v[140:143], v[36:51]
    ds_read_b128 v[132:135], v180 offset:0
    ds_read_b128 v[136:139], v180 offset:4096
    v_mfma_f32_32x32x16_bf16 v[52:67], v[168:171], v[144:147], v[52:67]
    ds_read_b64_tr_b16 v[152:153], v184 offset:8192
    ds_read_b64_tr_b16 v[154:155], v184 offset:8704
    v_mfma_f32_32x32x16_bf16 v[68:83], v[140:143], v[172:175], v[68:83]
    ds_read_b64_tr_b16 v[156:157], v184 offset:16384
    ds_read_b64_tr_b16 v[158:159], v184 offset:16896
    v_mfma_f32_32x32x16_bf16 v[84:99], v[144:147], v[172:175], v[84:99]
    ds_read_b64_tr_b16 v[160:161], v184 offset:24576
    ds_read_b64_tr_b16 v[162:163], v184 offset:25088
    v_mfma_f32_32x32x16_bf16 v[100:115], v[176:179], v[140:143], v[100:115]
    v_mfma_f32_32x32x16_bf16 v[116:131], v[176:179], v[144:147], v[116:131]
    s_waitcnt lgkmcnt(7)
    v_mfma_f32_32x32x16_bf16 v[4:19], v[148:151], v[132:135], v[4:19]
    ds_read_b64_tr_b16 v[164:165], v184 offset:2048
    ds_read_b64_tr_b16 v[166:167], v184 offset:2560
    v_lshlrev_b32 v204, 16, v132
    v_and_b32 v205, 0xffff0000, v132
    v_add_f32 v192, v192, v204
    v_fmac_f32 v193, v204, v204
    v_add_f32 v192, v192, v205
    v_fmac_f32 v193, v205, v205
    s_waitcnt lgkmcnt(8)
    v_lshlrev_b32 v206, 16, v136
    v_and_b32 v207, 0xffff0000, v136
    v_mfma_f32_32x32x16_bf16 v[20:35], v[148:151], v[136:139], v[20:35]
    ds_read_b128 v[140:143], v181 offset:0
    ds_read_b128 v[144:147], v181 offset:4096
    v_add_f32 v194, v194, v206
    v_fmac_f32 v195, v206, v206
    v_add_f32 v194, v194, v207
    v_fmac_f32 v195, v207, v207
    s_waitcnt lgkmcnt(5)
    v_lshlrev_b32 v198, 16, v160
    v_and_b32 v199, 0xffff0000, v160
    v_add_f32 v196, v196, v198
    v_add_f32 v196, v196, v199
    v_mfma_f32_32x32x16_bf16 v[36:51], v[152:155], v[132:135], v[36:51]
    ds_read_b64_tr_b16 v[168:169], v184 offset:10240
    ds_read_b64_tr_b16 v[170:171], v184 offset:10752
    v_lshlrev_b32 v204, 16, v133
    v_and_b32 v205, 0xffff0000, v133
    v_add_f32 v192, v192, v204
    v_fmac_f32 v193, v204, v204
    v_add_f32 v192, v192, v205
    v_fmac_f32 v193, v205, v205
    v_lshlrev_b32 v206, 16, v137
    v_and_b32 v207, 0xffff0000, v137
    v_mfma_f32_32x32x16_bf16 v[52:67], v[152:155], v[136:139], v[52:67]
    ds_read_b64_tr_b16 v[172:173], v184 offset:18432
    ds_read_b64_tr_b16 v[174:175], v184 offset:18944
    v_add_f32 v194, v194, v206
    v_fmac_f32 v195, v206, v206
    v_add_f32 v194, v194, v207
    v_fmac_f32 v195, v207, v207
    v_lshlrev_b32 v198, 16, v161
    v_and_b32 v199, 0xffff0000, v161
    v_add_f32 v196, v196, v198
    v_add_f32 v196, v196, v199
    v_mfma_f32_32x32x16_bf16 v[68:83], v[132:135], v[156:159], v[68:83]
    ds_read_b64_tr_b16 v[176:177], v184 offset:26624
    ds_read_b64_tr_b16 v[178:179], v184 offset:27136
    v_lshlrev_b32 v204, 16, v134
    v_and_b32 v205, 0xffff0000, v134
    v_add_f32 v192, v192, v204
    v_fmac_f32 v193, v204, v204
    v_add_f32 v192, v192, v205
    v_fmac_f32 v193, v205, v205
    v_lshlrev_b32 v206, 16, v138
    v_and_b32 v207, 0xffff0000, v138
    v_mfma_f32_32x32x16_bf16 v[84:99], v[136:139], v[156:159], v[84:99]
    v_add_f32 v194, v194, v206
    v_fmac_f32 v195, v206, v206
    v_add_f32 v194, v194, v207
    v_fmac_f32 v195, v207, v207
    s_waitcnt lgkmcnt(10)
    v_lshlrev_b32 v198, 16, v162
    v_and_b32 v199, 0xffff0000, v162
    v_add_f32 v196, v196, v198
    v_add_f32 v196, v196, v199
    v_mfma_f32_32x32x16_bf16 v[100:115], v[160:163], v[132:135], v[100:115]
    v_lshlrev_b32 v204, 16, v135
    v_and_b32 v205, 0xffff0000, v135
    v_add_f32 v192, v192, v204
    v_fmac_f32 v193, v204, v204
    v_add_f32 v192, v192, v205
    v_fmac_f32 v193, v205, v205
    v_lshlrev_b32 v206, 16, v139
    v_and_b32 v207, 0xffff0000, v139
    v_mfma_f32_32x32x16_bf16 v[116:131], v[160:163], v[136:139], v[116:131]
    v_add_f32 v194, v194, v206
    v_fmac_f32 v195, v206, v206
    v_add_f32 v194, v194, v207
    v_fmac_f32 v195, v207, v207
    v_lshlrev_b32 v198, 16, v163
    v_and_b32 v199, 0xffff0000, v163
    v_add_f32 v196, v196, v198
    v_add_f32 v196, v196, v199
    s_waitcnt lgkmcnt(7)
    v_mfma_f32_32x32x16_bf16 v[4:19], v[164:167], v[140:143], v[4:19]
    ds_read_b64_tr_b16 v[148:149], v184 offset:4096
    ds_read_b64_tr_b16 v[150:151], v184 offset:4608
    v_lshlrev_b32 v204, 16, v140
    v_and_b32 v205, 0xffff0000, v140
    v_add_f32 v192, v192, v204
    v_fmac_f32 v193, v204, v204
    v_add_f32 v192, v192, v205
    v_fmac_f32 v193, v205, v205
    s_waitcnt lgkmcnt(8)
    v_lshlrev_b32 v206, 16, v144
    v_and_b32 v207, 0xffff0000, v144
    v_mfma_f32_32x32x16_bf16 v[20:35], v[164:167], v[144:147], v[20:35]
    ds_read_b128 v[132:135], v182 offset:0
    ds_read_b128 v[136:139], v182 offset:4096
    v_add_f32 v194, v194, v206
    v_fmac_f32 v195, v206, v206
    v_add_f32 v194, v194, v207
    v_fmac_f32 v195, v207, v207
    s_waitcnt lgkmcnt(5)
    v_lshlrev_b32 v198, 16, v176
    v_and_b32 v199, 0xffff0000, v176
    v_add_f32 v196, v196, v198
    v_add_f32 v196, v196, v199
    v_mfma_f32_32x32x16_bf16 v[36:51], v[168:171], v[140:143], v[36:51]
    ds_read_b64_tr_b16 v[152:153], v184 offset:12288
    ds_read_b64_tr_b16 v[154:155], v184 offset:12800
    v_lshlrev_b32 v204, 16, v141
    v_and_b32 v205, 0xffff0000, v141
    v_add_f32 v192, v192, v204
    v_fmac_f32 v193, v204, v204
    v_add_f32 v192, v192, v205
    v_fmac_f32 v193, v205, v205
    v_lshlrev_b32 v206, 16, v145
    v_and_b32 v207, 0xffff0000, v145
    v_mfma_f32_32x32x16_bf16 v[52:67], v[168:171], v[144:147], v[52:67]
    ds_read_b64_tr_b16 v[156:157], v184 offset:20480
    ds_read_b64_tr_b16 v[158:159], v184 offset:20992
    v_add_f32 v194, v194, v206
    v_fmac_f32 v195, v206, v206
    v_add_f32 v194, v194, v207
    v_fmac_f32 v195, v207, v207
    v_lshlrev_b32 v198, 16, v177
    v_and_b32 v199, 0xffff0000, v177
    v_add_f32 v196, v196, v198
    v_add_f32 v196, v196, v199
    v_mfma_f32_32x32x16_bf16 v[68:83], v[140:143], v[172:175], v[68:83]
    ds_read_b64_tr_b16 v[160:161], v184 offset:28672
    ds_read_b64_tr_b16 v[162:163], v184 offset:29184
    v_lshlrev_b32 v204, 16, v142
    v_and_b32 v205, 0xffff0000, v142
    v_add_f32 v192, v192, v204
    v_fmac_f32 v193, v204, v204
    v_add_f32 v192, v192, v205
    v_fmac_f32 v193, v205, v205
    v_lshlrev_b32 v206, 16, v146
    v_and_b32 v207, 0xffff0000, v146
    v_mfma_f32_32x32x16_bf16 v[84:99], v[144:147], v[172:175], v[84:99]
    v_add_f32 v194, v194, v206
    v_fmac_f32 v195, v206, v206
    v_add_f32 v194, v194, v207
    v_fmac_f32 v195, v207, v207
    s_waitcnt lgkmcnt(10)
    v_lshlrev_b32 v198, 16, v178
    v_and_b32 v199, 0xffff0000, v178
    v_add_f32 v196, v196, v198
    v_add_f32 v196, v196, v199
    v_mfma_f32_32x32x16_bf16 v[100:115], v[176:179], v[140:143], v[100:115]
    v_lshlrev_b32 v204, 16, v143
    v_and_b32 v205, 0xffff0000, v143
    v_add_f32 v192, v192, v204
    v_fmac_f32 v193, v204, v204
    v_add_f32 v192, v192, v205
    v_fmac_f32 v193, v205, v205
    v_lshlrev_b32 v206, 16, v147
    v_and_b32 v207, 0xffff0000, v147
    v_mfma_f32_32x32x16_bf16 v[116:131], v[176:179], v[144:147], v[116:131]
    v_add_f32 v194, v194, v206
    v_fmac_f32 v195, v206, v206
    v_add_f32 v194, v194, v207
    v_fmac_f32 v195, v207, v207
    v_lshlrev_b32 v198, 16, v179
    v_and_b32 v199, 0xffff0000, v179
    v_add_f32 v196, v196, v198
    v_add_f32 v196, v196, v199
    s_waitcnt lgkmcnt(7)
    v_mfma_f32_32x32x16_bf16 v[4:19], v[148:151], v[132:135], v[4:19]
    ds_read_b64_tr_b16 v[164:165], v184 offset:6144
    ds_read_b64_tr_b16 v[166:167], v184 offset:6656
    v_lshlrev_b32 v204, 16, v132
    v_and_b32 v205, 0xffff0000, v132
    v_add_f32 v192, v192, v204
    v_fmac_f32 v193, v204, v204
    v_add_f32 v192, v192, v205
    v_fmac_f32 v193, v205, v205
    s_waitcnt lgkmcnt(8)
    v_lshlrev_b32 v206, 16, v136
    v_and_b32 v207, 0xffff0000, v136
    v_mfma_f32_32x32x16_bf16 v[20:35], v[148:151], v[136:139], v[20:35]
    ds_read_b128 v[140:143], v183 offset:0
    ds_read_b128 v[144:147], v183 offset:4096
    v_add_f32 v194, v194, v206
    v_fmac_f32 v195, v206, v206
    v_add_f32 v194, v194, v207
    v_fmac_f32 v195, v207, v207
    s_waitcnt lgkmcnt(5)
    v_lshlrev_b32 v198, 16, v160
    v_and_b32 v199, 0xffff0000, v160
    v_add_f32 v196, v196, v198
    v_add_f32 v196, v196, v199
    v_mfma_f32_32x32x16_bf16 v[36:51], v[152:155], v[132:135], v[36:51]
    ds_read_b64_tr_b16 v[168:169], v184 offset:14336
    ds_read_b64_tr_b16 v[170:171], v184 offset:14848
    v_lshlrev_b32 v204, 16, v133
    v_and_b32 v205, 0xffff0000, v133
    v_add_f32 v192, v192, v204
    v_fmac_f32 v193, v204, v204
    v_add_f32 v192, v192, v205
    v_fmac_f32 v193, v205, v205
    v_lshlrev_b32 v206, 16, v137
    v_and_b32 v207, 0xffff0000, v137
    v_mfma_f32_32x32x16_bf16 v[52:67], v[152:155], v[136:139], v[52:67]
    ds_read_b64_tr_b16 v[172:173], v184 offset:22528
    ds_read_b64_tr_b16 v[174:175], v184 offset:23040
    v_add_f32 v194, v194, v206
    v_fmac_f32 v195, v206, v206
    v_add_f32 v194, v194, v207
    v_fmac_f32 v195, v207, v207
    v_lshlrev_b32 v198, 16, v161
    v_and_b32 v199, 0xffff0000, v161
    v_add_f32 v196, v196, v198
    v_add_f32 v196, v196, v199
    v_mfma_f32_32x32x16_bf16 v[68:83], v[132:135], v[156:159], v[68:83]
    ds_read_b64_tr_b16 v[176:177], v184 offset:30720
    ds_read_b64_tr_b16 v[178:179], v184 offset:31232
    v_lshlrev_b32 v204, 16, v134
    v_and_b32 v205, 0xffff0000, v134
    v_add_f32 v192, v192, v204
    v_fmac_f32 v193, v204, v204
    v_add_f32 v192, v192, v205
    v_fmac_f32 v193, v205, v205
    v_lshlrev_b32 v206, 16, v138
    v_and_b32 v207, 0xffff0000, v138
    v_mfma_f32_32x32x16_bf16 v[84:99], v[136:139], v[156:159], v[84:99]
    s_add_u32 s28, s28, 49152
    s_cmp_ge_u32 s28, 147456
    v_add_f32 v194, v194, v206
    v_fmac_f32 v195, v206, v206
    v_add_f32 v194, v194, v207
    v_fmac_f32 v195, v207, v207
    s_waitcnt lgkmcnt(10)
    v_lshlrev_b32 v198, 16, v162
    v_and_b32 v199, 0xffff0000, v162
    v_add_f32 v196, v196, v198
    v_add_f32 v196, v196, v199
    v_mfma_f32_32x32x16_bf16 v[100:115], v[160:163], v[132:135], v[100:115]
    s_cselect_b32 s29, 147456, 0
    s_sub_u32 s28, s28, s29
    v_lshlrev_b32 v204, 16, v135
    v_and_b32 v205, 0xffff0000, v135
    v_add_f32 v192, v192, v204
    v_fmac_f32 v193, v204, v204
    v_add_f32 v192, v192, v205
    v_fmac_f32 v193, v205, v205
    v_lshlrev_b32 v206, 16, v139
    v_and_b32 v207, 0xffff0000, v139
    v_mfma_f32_32x32x16_bf16 v[116:131], v[160:163], v[136:139], v[116:131]
    s_sub_u32 s29, 49152, s29
    v_add_u32 v180, s29, v180
    v_add_u32 v181, s29, v181
    v_add_u32 v182, s29, v182
    v_add_u32 v183, s29, v183
    v_add_u32 v184, s29, v184
    v_add_f32 v194, v194, v206
    v_fmac_f32 v195, v206, v206
    v_add_f32 v194, v194, v207
    v_fmac_f32 v195, v207, v207
    v_lshlrev_b32 v198, 16, v163
    v_and_b32 v199, 0xffff0000, v163
    v_add_f32 v196, v196, v198
    v_add_f32 v196, v196, v199
    s_waitcnt lgkmcnt(0)
    v_mfma_f32_32x32x16_bf16 v[4:19], v[164:167], v[140:143], v[4:19]
    s_barrier
    v_mfma_f32_32x32x16_bf16 v[20:35], v[164:167], v[144:147], v[20:35]
    ds_read_b64_tr_b16 v[148:149], v184 offset:0
    ds_read_b64_tr_b16 v[150:151], v184 offset:512
    v_lshlrev_b32 v204, 16, v140
    v_and_b32 v205, 0xffff0000, v140
    v_add_f32 v192, v192, v204
    v_fmac_f32 v193, v204, v204
    v_add_f32 v192, v192, v205
    v_fmac_f32 v193, v205, v205
    v_lshlrev_b32 v206, 16, v144
    v_and_b32 v207, 0xffff0000, v144
    v_add_f32 v194, v194, v206
    v_fmac_f32 v195, v206, v206
    v_mfma_f32_32x32x16_bf16 v[36:51], v[168:171], v[140:143], v[36:51]
    ds_read_b128 v[132:135], v180 offset:0
    ds_read_b128 v[136:139], v180 offset:4096
    v_add_f32 v194, v194, v207
    v_fmac_f32 v195, v207, v207
    v_lshlrev_b32 v198, 16, v176
    v_and_b32 v199, 0xffff0000, v176
    v_add_f32 v196, v196, v198
    v_add_f32 v196, v196, v199
    v_lshlrev_b32 v204, 16, v141
    v_and_b32 v205, 0xffff0000, v141
    v_add_f32 v192, v192, v204
    v_mfma_f32_32x32x16_bf16 v[52:67], v[168:171], v[144:147], v[52:67]
    ds_read_b64_tr_b16 v[152:153], v184 offset:8192
    ds_read_b64_tr_b16 v[154:155], v184 offset:8704
    v_fmac_f32 v193, v204, v204
    v_add_f32 v192, v192, v205
    v_fmac_f32 v193, v205, v205
    v_lshlrev_b32 v206, 16, v145
    v_and_b32 v207, 0xffff0000, v145
    v_add_f32 v194, v194, v206
    v_fmac_f32 v195, v206, v206
    v_add_f32 v194, v194, v207
    v_fmac_f32 v195, v207, v207
    v_mfma_f32_32x32x16_bf16 v[68:83], v[140:143], v[172:175], v[68:83]
    ds_read_b64_tr_b16 v[156:157], v184 offset:16384
    ds_read_b64_tr_b16 v[158:159], v184 offset:16896
    v_lshlrev_b32 v198, 16, v177
    v_and_b32 v199, 0xffff0000, v177
    v_add_f32 v196, v196, v198
    v_add_f32 v196, v196, v199
    v_lshlrev_b32 v204, 16, v142
    v_and_b32 v205, 0xffff0000, v142
    v_add_f32 v192, v192, v204
    v_fmac_f32 v193, v204, v204
    v_add_f32 v192, v192, v205
    v_mfma_f32_32x32x16_bf16 v[84:99], v[144:147], v[172:175], v[84:99]
    ds_read_b64_tr_b16 v[160:161], v184 offset:24576
    ds_read_b64_tr_b16 v[162:163], v184 offset:25088
    v_fmac_f32 v193, v205, v205
    v_lshlrev_b32 v206, 16, v146
    v_and_b32 v207, 0xffff0000, v146
    v_add_f32 v194, v194, v206
    v_fmac_f32 v195, v206, v206
    v_add_f32 v194, v194, v207
    v_fmac_f32 v195, v207, v207
    v_lshlrev_b32 v198, 16, v178
    v_and_b32 v199, 0xffff0000, v178
    v_mfma_f32_32x32x16_bf16 v[100:115], v[176:179], v[140:143], v[100:115]
    v_add_f32 v196, v196, v198
    v_add_f32 v196, v196, v199
    v_lshlrev_b32 v204, 16, v143
    v_and_b32 v205, 0xffff0000, v143
    v_add_f32 v192, v192, v204
    v_fmac_f32 v193, v204, v204
    v_add_f32 v192, v192, v205
    v_fmac_f32 v193, v205, v205
    v_lshlrev_b32 v206, 16, v147
    v_mfma_f32_32x32x16_bf16 v[116:131], v[176:179], v[144:147], v[116:131]
    v_and_b32 v207, 0xffff0000, v147
    v_add_f32 v194, v194, v206
    v_fmac_f32 v195, v206, v206
    v_add_f32 v194, v194, v207
    v_fmac_f32 v195, v207, v207
    v_lshlrev_b32 v198, 16, v179
    v_and_b32 v199, 0xffff0000, v179
    v_add_f32 v196, v196, v198
    v_add_f32 v196, v196, v199
    v_mov_b32 v208, v192
    v_mov_b32 v209, v193
    v_mov_b32 v210, v194
    v_mov_b32 v211, v195
    v_mov_b32 v212, v196
    s_nop 0
    v_permlane32_swap_b32 v192, v208
    v_permlane32_swap_b32 v193, v209
    v_permlane32_swap_b32 v194, v210
    v_permlane32_swap_b32 v195, v211
    v_permlane32_swap_b32 v196, v212
    s_nop 0
    v_add_f32 v192, v192, v208
    v_add_f32 v193, v193, v209
    v_add_f32 v194, v194, v210
    v_add_f32 v195, v195, v211
    v_add_f32 v196, v196, v212
    s_lshl_b32 s32, s68, 3
    s_add_u32 s32, s32, 41172992
    buffer_store_dwordx2 v[192:193], v200, s[36:39], s32 offen sc1
    buffer_store_dwordx2 v[194:195], v201, s[36:39], s32 offen sc1
    s_lshl_b32 s32, s68, 12
    s_lshl_b32 s33, s65, 8
    s_add_u32 s32, s32, s33
    s_lshl_b32 s33, s18, 7
    s_add_u32 s32, s32, s33
    s_add_u32 s32, s32, 41435136
    buffer_store_dword v196, v202, s[36:39], s32 offen sc1
    s_waitcnt lgkmcnt(7)
    v_mfma_f32_32x32x16_bf16 v[4:19], v[148:151], v[132:135], v[4:19]
    ds_read_b64_tr_b16 v[164:165], v184 offset:2048
    ds_read_b64_tr_b16 v[166:167], v184 offset:2560
    s_waitcnt lgkmcnt(8)
    v_mfma_f32_32x32x16_bf16 v[20:35], v[148:151], v[136:139], v[20:35]
    ds_read_b128 v[140:143], v181 offset:0
    ds_read_b128 v[144:147], v181 offset:4096
    s_waitcnt lgkmcnt(8)
    v_mfma_f32_32x32x16_bf16 v[36:51], v[152:155], v[132:135], v[36:51]
    ds_read_b64_tr_b16 v[168:169], v184 offset:10240
    ds_read_b64_tr_b16 v[170:171], v184 offset:10752
    v_mfma_f32_32x32x16_bf16 v[52:67], v[152:155], v[136:139], v[52:67]
    ds_read_b64_tr_b16 v[172:173], v184 offset:18432
    ds_read_b64_tr_b16 v[174:175], v184 offset:18944
    s_waitcnt lgkmcnt(10)
    v_mfma_f32_32x32x16_bf16 v[68:83], v[132:135], v[156:159], v[68:83]
    ds_read_b64_tr_b16 v[176:177], v184 offset:26624
    ds_read_b64_tr_b16 v[178:179], v184 offset:27136
    v_mfma_f32_32x32x16_bf16 v[84:99], v[136:139], v[156:159], v[84:99]
    s_waitcnt lgkmcnt(10)
    v_mfma_f32_32x32x16_bf16 v[100:115], v[160:163], v[132:135], v[100:115]
    v_mfma_f32_32x32x16_bf16 v[116:131], v[160:163], v[136:139], v[116:131]
    s_waitcnt lgkmcnt(7)
    v_mfma_f32_32x32x16_bf16 v[4:19], v[164:167], v[140:143], v[4:19]
    ds_read_b64_tr_b16 v[148:149], v184 offset:4096
    ds_read_b64_tr_b16 v[150:151], v184 offset:4608
    s_waitcnt lgkmcnt(8)
    v_mfma_f32_32x32x16_bf16 v[20:35], v[164:167], v[144:147], v[20:35]
    ds_read_b128 v[132:135], v182 offset:0
    ds_read_b128 v[136:139], v182 offset:4096
    s_waitcnt lgkmcnt(8)
    v_mfma_f32_32x32x16_bf16 v[36:51], v[168:171], v[140:143], v[36:51]
    ds_read_b64_tr_b16 v[152:153], v184 offset:12288
    ds_read_b64_tr_b16 v[154:155], v184 offset:12800
    v_mfma_f32_32x32x16_bf16 v[52:67], v[168:171], v[144:147], v[52:67]
    ds_read_b64_tr_b16 v[156:157], v184 offset:20480
    ds_read_b64_tr_b16 v[158:159], v184 offset:20992
    s_waitcnt lgkmcnt(10)
    v_mfma_f32_32x32x16_bf16 v[68:83], v[140:143], v[172:175], v[68:83]
    ds_read_b64_tr_b16 v[160:161], v184 offset:28672
    ds_read_b64_tr_b16 v[162:163], v184 offset:29184
    v_mfma_f32_32x32x16_bf16 v[84:99], v[144:147], v[172:175], v[84:99]
    s_waitcnt lgkmcnt(10)
    v_mfma_f32_32x32x16_bf16 v[100:115], v[176:179], v[140:143], v[100:115]
    v_mfma_f32_32x32x16_bf16 v[116:131], v[176:179], v[144:147], v[116:131]
    s_waitcnt lgkmcnt(7)
    v_mfma_f32_32x32x16_bf16 v[4:19], v[148:151], v[132:135], v[4:19]
    ds_read_b64_tr_b16 v[164:165], v184 offset:6144
    ds_read_b64_tr_b16 v[166:167], v184 offset:6656
    s_waitcnt lgkmcnt(8)
    v_mfma_f32_32x32x16_bf16 v[20:35], v[148:151], v[136:139], v[20:35]
    ds_read_b128 v[140:143], v183 offset:0
    ds_read_b128 v[144:147], v183 offset:4096
    s_waitcnt lgkmcnt(8)
    v_mfma_f32_32x32x16_bf16 v[36:51], v[152:155], v[132:135], v[36:51]
    ds_read_b64_tr_b16 v[168:169], v184 offset:14336
    ds_read_b64_tr_b16 v[170:171], v184 offset:14848
    v_mfma_f32_32x32x16_bf16 v[52:67], v[152:155], v[136:139], v[52:67]
    ds_read_b64_tr_b16 v[172:173], v184 offset:22528
    ds_read_b64_tr_b16 v[174:175], v184 offset:23040
    s_waitcnt lgkmcnt(10)
    v_mfma_f32_32x32x16_bf16 v[68:83], v[132:135], v[156:159], v[68:83]
    ds_read_b64_tr_b16 v[176:177], v184 offset:30720
    ds_read_b64_tr_b16 v[178:179], v184 offset:31232
    v_mfma_f32_32x32x16_bf16 v[84:99], v[136:139], v[156:159], v[84:99]
    s_add_u32 s28, s28, 49152
    s_cmp_ge_u32 s28, 147456
    s_waitcnt lgkmcnt(10)
    v_mfma_f32_32x32x16_bf16 v[100:115], v[160:163], v[132:135], v[100:115]
    s_cselect_b32 s29, 147456, 0
    s_sub_u32 s28, s28, s29
    v_mfma_f32_32x32x16_bf16 v[116:131], v[160:163], v[136:139], v[116:131]
    s_sub_u32 s29, 49152, s29
    v_add_u32 v180, s29, v180
    v_add_u32 v181, s29, v181
    v_add_u32 v182, s29, v182
    v_add_u32 v183, s29, v183
    v_add_u32 v184, s29, v184
    s_waitcnt lgkmcnt(0)
    v_mfma_f32_32x32x16_bf16 v[4:19], v[164:167], v[140:143], v[4:19]
    s_barrier
    s_mov_b32 s30, 0
    v_mfma_f32_32x32x16_bf16 v[20:35], v[164:167], v[144:147], v[20:35]
    ds_read_b64_tr_b16 v[148:149], v184 offset:0
    ds_read_b64_tr_b16 v[150:151], v184 offset:512
    v_mfma_f32_32x32x16_bf16 v[36:51], v[168:171], v[140:143], v[36:51]
    ds_read_b128 v[132:135], v180 offset:0
    ds_read_b128 v[136:139], v180 offset:4096
    v_mfma_f32_32x32x16_bf16 v[52:67], v[168:171], v[144:147], v[52:67]
    ds_read_b64_tr_b16 v[152:153], v184 offset:8192
    ds_read_b64_tr_b16 v[154:155], v184 offset:8704
    v_mfma_f32_32x32x16_bf16 v[68:83], v[140:143], v[172:175], v[68:83]
    ds_read_b64_tr_b16 v[156:157], v184 offset:16384
    ds_read_b64_tr_b16 v[158:159], v184 offset:16896
    v_mfma_f32_32x32x16_bf16 v[84:99], v[144:147], v[172:175], v[84:99]
    ds_read_b64_tr_b16 v[160:161], v184 offset:24576
    ds_read_b64_tr_b16 v[162:163], v184 offset:25088
    v_mfma_f32_32x32x16_bf16 v[100:115], v[176:179], v[140:143], v[100:115]
    v_mfma_f32_32x32x16_bf16 v[116:131], v[176:179], v[144:147], v[116:131]
    s_cmp_eq_u32 s30, s69
    s_cbranch_scc1 k1_c_loop_mida
k1_c_loop_backa:
    s_waitcnt lgkmcnt(7)
    v_mfma_f32_32x32x16_bf16 v[4:19], v[148:151], v[132:135], v[4:19]
    ds_read_b64_tr_b16 v[164:165], v184 offset:2048
    ds_read_b64_tr_b16 v[166:167], v184 offset:2560
    s_waitcnt lgkmcnt(8)
    v_mfma_f32_32x32x16_bf16 v[20:35], v[148:151], v[136:139], v[20:35]
    ds_read_b128 v[140:143], v181 offset:0
    ds_read_b128 v[144:147], v181 offset:4096
    s_waitcnt lgkmcnt(8)
    v_mfma_f32_32x32x16_bf16 v[36:51], v[152:155], v[132:135], v[36:51]
    ds_read_b64_tr_b16 v[168:169], v184 offset:10240
    ds_read_b64_tr_b16 v[170:171], v184 offset:10752
    v_mfma_f32_32x32x16_bf16 v[52:67], v[152:155], v[136:139], v[52:67]
    ds_read_b64_tr_b16 v[172:173], v184 offset:18432
    ds_read_b64_tr_b16 v[174:175], v184 offset:18944
    s_waitcnt lgkmcnt(10)
    v_mfma_f32_32x32x16_bf16 v[68:83], v[132:135], v[156:159], v[68:83]
    ds_read_b64_tr_b16 v[176:177], v184 offset:26624
    ds_read_b64_tr_b16 v[178:179], v184 offset:27136
    v_mfma_f32_32x32x16_bf16 v[84:99], v[136:139], v[156:159], v[84:99]
k1_c_loop:
    s_waitcnt lgkmcnt(10)
    v_mfma_f32_32x32x16_bf16 v[100:115], v[160:163], v[132:135], v[100:115]
    v_mfma_f32_32x32x16_bf16 v[116:131], v[160:163], v[136:139], v[116:131]
    s_waitcnt lgkmcnt(7)
    v_mfma_f32_32x32x16_bf16 v[4:19], v[164:167], v[140:143], v[4:19]
    ds_read_b64_tr_b16 v[148:149], v184 offset:4096
    ds_read_b64_tr_b16 v[150:151], v184 offset:4608
    s_waitcnt lgkmcnt(8)
    v_mfma_f32_32x32x16_bf16 v[20:35], v[164:167], v[144:147], v[20:35]
    ds_read_b128 v[132:135], v182 offset:0
    ds_read_b128 v[136:139], v182 offset:4096
    s_waitcnt lgkmcnt(8)
    v_mfma_f32_32x32x16_bf16 v[36:51], v[168:171], v[140:143], v[36:51]
    ds_read_b64_tr_b16 v[152:153], v184 offset:12288
    ds_read_b64_tr_b16 v[154:155], v184 offset:12800
    v_mfma_f32_32x32x16_bf16 v[52:67], v[168:171], v[144:147], v[52:67]
    ds_read_b64_tr_b16 v[156:157], v184 offset:20480
    ds_read_b64_tr_b16 v[158:159], v184 offset:20992
    s_waitcnt lgkmcnt(10)
    v_mfma_f32_32x32x16_bf16 v[68:83], v[140:143], v[172:175], v[68:83]
    ds_read_b64_tr_b16 v[160:161], v184 offset:28672
    ds_read_b64_tr_b16 v[162:163], v184 offset:29184
    v_mfma_f32_32x32x16_bf16 v[84:99], v[144:147], v[172:175], v[84:99]
    s_waitcnt lgkmcnt(10)
    v_mfma_f32_32x32x16_bf16 v[100:115], v[176:179], v[140:143], v[100:115]
    v_mfma_f32_32x32x16_bf16 v[116:131], v[176:179], v[144:147], v[116:131]
    s_waitcnt lgkmcnt(7)
    v_mfma_f32_32x32x16_bf16 v[4:19], v[148:151], v[132:135], v[4:19]
    ds_read_b64_tr_b16 v[164:165], v184 offset:6144
    ds_read_b64_tr_b16 v[166:167], v184 offset:6656
    s_waitcnt lgkmcnt(8)
    v_mfma_f32_32x32x16_bf16 v[20:35], v[148:151], v[136:139], v[20:35]
    ds_read_b128 v[140:143], v183 offset:0
    ds_read_b128 v[144:147], v183 offset:4096
    s_waitcnt lgkmcnt(8)
    v_mfma_f32_32x32x16_bf16 v[36:51], v[152:155], v[132:135], v[36:51]
    ds_read_b64_tr_b16 v[168:169], v184 offset:14336
    ds_read_b64_tr_b16 v[170:171], v184 offset:14848
    v_mfma_f32_32x32x16_bf16 v[52:67], v[152:155], v[136:139], v[52:67]
    ds_read_b64_tr_b16 v[172:173], v184 offset:22528
    ds_read_b64_tr_b16 v[174:175], v184 offset:23040
    s_waitcnt lgkmcnt(10)
    v_mfma_f32_32x32x16_bf16 v[68:83], v[132:135], v[156:159], v[68:83]
    ds_read_b64_tr_b16 v[176:177], v184 offset:30720
    ds_read_b64_tr_b16 v[178:179], v184 offset:31232
    v_mfma_f32_32x32x16_bf16 v[84:99], v[136:139], v[156:159], v[84:99]
    s_add_u32 s28, s28, 49152
    s_cmp_ge_u32 s28, 147456
    s_waitcnt lgkmcnt(10)
    v_mfma_f32_32x32x16_bf16 v[100:115], v[160:163], v[132:135], v[100:115]
    s_cselect_b32 s29, 147456, 0
    s_sub_u32 s28, s28, s29
    v_mfma_f32_32x32x16_bf16 v[116:131], v[160:163], v[136:139], v[116:131]
    s_sub_u32 s29, 49152, s29
    v_add_u32 v180, s29, v180
    v_add_u32 v181, s29, v181
    v_add_u32 v182, s29, v182
    v_add_u32 v183, s29, v183
    v_add_u32 v184, s29, v184
    s_add_u32 s30, s30, 1
    s_cmp_eq_u32 s30, 7
    s_waitcnt lgkmcnt(0)
    v_mfma_f32_32x32x16_bf16 v[4:19], v[164:167], v[140:143], v[4:19]
    s_barrier
    s_cbranch_scc1 k1_c_loop_out
    v_mfma_f32_32x32x16_bf16 v[20:35], v[164:167], v[144:147], v[20:35]
    ds_read_b64_tr_b16 v[148:149], v184 offset:0
    ds_read_b64_tr_b16 v[150:151], v184 offset:512
    v_mfma_f32_32x32x16_bf16 v[36:51], v[168:171], v[140:143], v[36:51]
    ds_read_b128 v[132:135], v180 offset:0
    ds_read_b128 v[136:139], v180 offset:4096
    v_mfma_f32_32x32x16_bf16 v[52:67], v[168:171], v[144:147], v[52:67]
    ds_read_b64_tr_b16 v[152:153], v184 offset:8192
    ds_read_b64_tr_b16 v[154:155], v184 offset:8704
    v_mfma_f32_32x32x16_bf16 v[68:83], v[140:143], v[172:175], v[68:83]
    ds_read_b64_tr_b16 v[156:157], v184 offset:16384
    ds_read_b64_tr_b16 v[158:159], v184 offset:16896
    v_mfma_f32_32x32x16_bf16 v[84:99], v[144:147], v[172:175], v[84:99]
    ds_read_b64_tr_b16 v[160:161], v184 offset:24576
    ds_read_b64_tr_b16 v[162:163], v184 offset:25088
    v_mfma_f32_32x32x16_bf16 v[100:115], v[176:179], v[140:143], v[100:115]
    v_mfma_f32_32x32x16_bf16 v[116:131], v[176:179], v[144:147], v[116:131]
    s_cmp_eq_u32 s30, s69
    s_cbranch_scc1 k1_c_loop_midb
k1_c_loop_backb:
    s_waitcnt lgkmcnt(7)
    v_mfma_f32_32x32x16_bf16 v[4:19], v[148:151], v[132:135], v[4:19]
    ds_read_b64_tr_b16 v[164:165], v184 offset:2048
    ds_read_b64_tr_b16 v[166:167], v184 offset:2560
    s_waitcnt lgkmcnt(8)
    v_mfma_f32_32x32x16_bf16 v[20:35], v[148:151], v[136:139], v[20:35]
    ds_read_b128 v[140:143], v181 offset:0
    ds_read_b128 v[144:147], v181 offset:4096
    s_waitcnt lgkmcnt(8)
    v_mfma_f32_32x32x16_bf16 v[36:51], v[152:155], v[132:135], v[36:51]
    ds_read_b64_tr_b16 v[168:169], v184 offset:10240
    ds_read_b64_tr_b16 v[170:171], v184 offset:10752
    v_mfma_f32_32x32x16_bf16 v[52:67], v[152:155], v[136:139], v[52:67]
    ds_read_b64_tr_b16 v[172:173], v184 offset:18432
    ds_read_b64_tr_b16 v[174:175], v184 offset:18944
    s_waitcnt lgkmcnt(10)
    v_mfma_f32_32x32x16_bf16 v[68:83], v[132:135], v[156:159], v[68:83]
    ds_read_b64_tr_b16 v[176:177], v184 offset:26624
    ds_read_b64_tr_b16 v[178:179], v184 offset:27136
    v_mfma_f32_32x32x16_bf16 v[84:99], v[136:139], v[156:159], v[84:99]
    s_branch k1_c_loop
k1_c_loop_mida:
    s_cmp_eq_u32 s30, 1
    s_cbranch_scc0 k1_h1a
    s_waitcnt vmcnt(0)
    s_mov_b32 s69, 2
    s_branch k1_hEa
k1_h1a:
    s_cmp_eq_u32 s30, 2
    s_cbranch_scc0 k1_h2a
    s_cmp_lg_u32 s16, 0
    s_cbranch_scc1 k1_nosiga
    s_mov_b64 exec, 1
    v_mov_b32 v192, 1
    buffer_atomic_add v192, v234, s[40:43], 0 offen sc1
    s_mov_b64 exec, -1
k1_nosiga:
    s_mov_b32 s69, -1
    s_branch k1_hEa
k1_h2a:
k1_hEa:
    s_branch k1_c_loop_backa
k1_c_loop_midb:
    s_cmp_eq_u32 s30, 1
    s_cbranch_scc0 k1_h1b
    s_waitcnt vmcnt(0)
    s_mov_b32 s69, 2
    s_branch k1_hEb
k1_h1b:
    s_cmp_eq_u32 s30, 2
    s_cbranch_scc0 k1_h2b
    s_cmp_lg_u32 s16, 0
    s_cbranch_scc1 k1_nosigb
    s_mov_b64 exec, 1
    v_mov_b32 v192, 1
    buffer_atomic_add v192, v234, s[40:43], 0 offen sc1
    s_mov_b64 exec, -1
k1_nosigb:
    s_mov_b32 s69, -1
    s_branch k1_hEb
k1_h2b:
k1_hEb:
    s_branch k1_c_loop_backb
k1_c_loop_out:
    v_mfma_f32_32x32x16_bf16 v[20:35], v[164:167], v[144:147], v[20:35]
    ds_read_b64_tr_b16 v[148:149], v184 offset:0
    ds_read_b64_tr_b16 v[150:151], v184 offset:512
    v_mfma_f32_32x32x16_bf16 v[36:51], v[168:171], v[140:143], v[36:51]
    ds_read_b128 v[132:135], v180 offset:0
    ds_read_b128 v[136:139], v180 offset:4096
    v_mfma_f32_32x32x16_bf16 v[52:67], v[168:171], v[144:147], v[52:67]
    ds_read_b64_tr_b16 v[152:153], v184 offset:8192
    ds_read_b64_tr_b16 v[154:155], v184 offset:8704
    v_mfma_f32_32x32x16_bf16 v[68:83], v[140:143], v[172:175], v[68:83]
    ds_read_b64_tr_b16 v[156:157], v184 offset:16384
    ds_read_b64_tr_b16 v[158:159], v184 offset:16896
    v_mfma_f32_32x32x16_bf16 v[84:99], v[144:147], v[172:175], v[84:99]
    ds_read_b64_tr_b16 v[160:161], v184 offset:24576
    ds_read_b64_tr_b16 v[162:163], v184 offset:25088
    v_mfma_f32_32x32x16_bf16 v[100:115], v[176:179], v[140:143], v[100:115]
    v_mfma_f32_32x32x16_bf16 v[116:131], v[176:179], v[144:147], v[116:131]
    s_waitcnt lgkmcnt(7)
    v_mfma_f32_32x32x16_bf16 v[4:19], v[148:151], v[132:135], v[4:19]
    ds_read_b64_tr_b16 v[164:165], v184 offset:2048
    ds_read_b64_tr_b16 v[166:167], v184 offset:2560
    s_waitcnt lgkmcnt(8)
    v_mfma_f32_32x32x16_bf16 v[20:35], v[148:151], v[136:139], v[20:35]
    ds_read_b128 v[140:143], v181 offset:0
    ds_read_b128 v[144:147], v181 offset:4096
    s_waitcnt lgkmcnt(8)
    v_mfma_f32_32x32x16_bf16 v[36:51], v[152:155], v[132:135], v[36:51]
    ds_read_b64_tr_b16 v[168:169], v184 offset:10240
    ds_read_b64_tr_b16 v[170:171], v184 offset:10752
    v_mfma_f32_32x32x16_bf16 v[52:67], v[152:155], v[136:139], v[52:67]
    ds_read_b64_tr_b16 v[172:173], v184 offset:18432
    ds_read_b64_tr_b16 v[174:175], v184 offset:18944
    s_waitcnt lgkmcnt(10)
    v_mfma_f32_32x32x16_bf16 v[68:83], v[132:135], v[156:159], v[68:83]
    ds_read_b64_tr_b16 v[176:177], v184 offset:26624
    ds_read_b64_tr_b16 v[178:179], v184 offset:27136
    v_mfma_f32_32x32x16_bf16 v[84:99], v[136:139], v[156:159], v[84:99]
    s_waitcnt lgkmcnt(10)
    v_mfma_f32_32x32x16_bf16 v[100:115], v[160:163], v[132:135], v[100:115]
    v_mfma_f32_32x32x16_bf16 v[116:131], v[160:163], v[136:139], v[116:131]
    s_waitcnt lgkmcnt(7)
    v_mfma_f32_32x32x16_bf16 v[4:19], v[164:167], v[140:143], v[4:19]
    ds_read_b64_tr_b16 v[148:149], v184 offset:4096
    ds_read_b64_tr_b16 v[150:151], v184 offset:4608
    s_waitcnt lgkmcnt(8)
    v_mfma_f32_32x32x16_bf16 v[20:35], v[164:167], v[144:147], v[20:35]
    ds_read_b128 v[132:135], v182 offset:0
    ds_read_b128 v[136:139], v182 offset:4096
    s_waitcnt lgkmcnt(8)
    v_mfma_f32_32x32x16_bf16 v[36:51], v[168:171], v[140:143], v[36:51]
    ds_read_b64_tr_b16 v[152:153], v184 offset:12288
    ds_read_b64_tr_b16 v[154:155], v184 offset:12800
    v_mfma_f32_32x32x16_bf16 v[52:67], v[168:171], v[144:147], v[52:67]
    ds_read_b64_tr_b16 v[156:157], v184 offset:20480
    ds_read_b64_tr_b16 v[158:159], v184 offset:20992
    s_waitcnt lgkmcnt(10)
    v_mfma_f32_32x32x16_bf16 v[68:83], v[140:143], v[172:175], v[68:83]
    ds_read_b64_tr_b16 v[160:161], v184 offset:28672
    ds_read_b64_tr_b16 v[162:163], v184 offset:29184
    v_mfma_f32_32x32x16_bf16 v[84:99], v[144:147], v[172:175], v[84:99]
    s_waitcnt lgkmcnt(10)
    v_mfma_f32_32x32x16_bf16 v[100:115], v[176:179], v[140:143], v[100:115]
    v_mfma_f32_32x32x16_bf16 v[116:131], v[176:179], v[144:147], v[116:131]
    s_waitcnt lgkmcnt(7)
    v_mfma_f32_32x32x16_bf16 v[4:19], v[148:151], v[132:135], v[4:19]
    ds_read_b64_tr_b16 v[164:165], v184 offset:6144
    ds_read_b64_tr_b16 v[166:167], v184 offset:6656
    s_waitcnt lgkmcnt(8)
    v_mfma_f32_32x32x16_bf16 v[20:35], v[148:151], v[136:139], v[20:35]
    ds_read_b128 v[140:143], v183 offset:0
    ds_read_b128 v[144:147], v183 offset:4096
    s_waitcnt lgkmcnt(8)
    v_mfma_f32_32x32x16_bf16 v[36:51], v[152:155], v[132:135], v[36:51]
    ds_read_b64_tr_b16 v[168:169], v184 offset:14336
    ds_read_b64_tr_b16 v[170:171], v184 offset:14848
    v_mfma_f32_32x32x16_bf16 v[52:67], v[152:155], v[136:139], v[52:67]
    ds_read_b64_tr_b16 v[172:173], v184 offset:22528
    ds_read_b64_tr_b16 v[174:175], v184 offset:23040
    s_waitcnt lgkmcnt(10)
    v_mfma_f32_32x32x16_bf16 v[68:83], v[132:135], v[156:159], v[68:83]
    ds_read_b64_tr_b16 v[176:177], v184 offset:30720
    ds_read_b64_tr_b16 v[178:179], v184 offset:31232
    v_mfma_f32_32x32x16_bf16 v[84:99], v[136:139], v[156:159], v[84:99]
    s_waitcnt lgkmcnt(10)
    v_mfma_f32_32x32x16_bf16 v[100:115], v[160:163], v[132:135], v[100:115]
    v_mfma_f32_32x32x16_bf16 v[116:131], v[160:163], v[136:139], v[116:131]
    s_waitcnt lgkmcnt(7)
    v_mfma_f32_32x32x16_bf16 v[4:19], v[164:167], v[140:143], v[4:19]
    s_waitcnt lgkmcnt(6)
    v_mfma_f32_32x32x16_bf16 v[20:35], v[164:167], v[144:147], v[20:35]
    s_waitcnt lgkmcnt(4)
    v_mfma_f32_32x32x16_bf16 v[36:51], v[168:171], v[140:143], v[36:51]
    v_mfma_f32_32x32x16_bf16 v[52:67], v[168:171], v[144:147], v[52:67]
    s_waitcnt lgkmcnt(2)
    v_mfma_f32_32x32x16_bf16 v[68:83], v[140:143], v[172:175], v[68:83]
    v_mfma_f32_32x32x16_bf16 v[84:99], v[144:147], v[172:175], v[84:99]
    s_waitcnt lgkmcnt(0)
    v_mfma_f32_32x32x16_bf16 v[100:115], v[176:179], v[140:143], v[100:115]
    v_mfma_f32_32x32x16_bf16 v[116:131], v[176:179], v[144:147], v[116:131]
    s_nop 15
    s_lshl_b32 s32, s65, 1
    s_add_u32 s32, s32, s18
    s_lshl_b32 s32, s32, 6
    s_lshl_b32 s33, s64, 2
    s_add_u32 s32, s32, s33
    s_lshl_b32 s33, s17, 1
    s_add_u32 s67, s32, s33
    s_mov_b32 s48, 0x3e8293ee
    s_mov_b32 s49, 0x3e8293ee
    s_lshl_b32 s32, s67, 11
    s_add_u32 s32, s32, 0
    v_pk_mul_f32 v[4:5], v[4:5], s[48:49]
    v_pk_mul_f32 v[6:7], v[6:7], s[48:49]
    v_pk_mul_f32 v[8:9], v[8:9], s[48:49]
    v_pk_mul_f32 v[10:11], v[10:11], s[48:49]
    v_cvt_pk_bf16_f32 v132, v4, v5
    v_cvt_pk_bf16_f32 v133, v6, v7
    v_cvt_pk_bf16_f32 v134, v8, v9
    v_cvt_pk_bf16_f32 v135, v10, v11
    buffer_store_dwordx4 v[132:135], v232, s[36:39], s32 offen offset:0 sc1
    v_pk_mul_f32 v[12:13], v[12:13], s[48:49]
    v_pk_mul_f32 v[14:15], v[14:15], s[48:49]
    v_pk_mul_f32 v[16:17], v[16:17], s[48:49]
    v_pk_mul_f32 v[18:19], v[18:19], s[48:49]
    v_cvt_pk_bf16_f32 v136, v12, v13
    v_cvt_pk_bf16_f32 v137, v14, v15
    v_cvt_pk_bf16_f32 v138, v16, v17
    v_cvt_pk_bf16_f32 v139, v18, v19
    buffer_store_dwordx4 v[136:139], v232, s[36:39], s32 offen offset:1024 sc1
    v_pk_mul_f32 v[20:21], v[20:21], s[48:49]
    v_pk_mul_f32 v[22:23], v[22:23], s[48:49]
    v_pk_mul_f32 v[24:25], v[24:25], s[48:49]
    v_pk_mul_f32 v[26:27], v[26:27], s[48:49]
    v_cvt_pk_bf16_f32 v140, v20, v21
    v_cvt_pk_bf16_f32 v141, v22, v23
    v_cvt_pk_bf16_f32 v142, v24, v25
    v_cvt_pk_bf16_f32 v143, v26, v27
    buffer_store_dwordx4 v[140:143], v232, s[36:39], s32 offen offset:2048 sc1
    v_pk_mul_f32 v[28:29], v[28:29], s[48:49]
    v_pk_mul_f32 v[30:31], v[30:31], s[48:49]
    v_pk_mul_f32 v[32:33], v[32:33], s[48:49]
    v_pk_mul_f32 v[34:35], v[34:35], s[48:49]
    v_cvt_pk_bf16_f32 v144, v28, v29
    v_cvt_pk_bf16_f32 v145, v30, v31
    v_cvt_pk_bf16_f32 v146, v32, v33
    v_cvt_pk_bf16_f32 v147, v34, v35
    buffer_store_dwordx4 v[144:147], v232, s[36:39], s32 offen offset:3072 sc1
    s_lshl_b32 s32, s67, 12
    s_add_u32 s32, s32, 4194304
    s_add_u32 s33, s32, 4096
    v_cvt_pk_bf16_f32 v148, v36, v37
    v_cvt_pk_bf16_f32 v149, v38, v39
    v_cvt_pk_bf16_f32 v150, v40, v41
    v_cvt_pk_bf16_f32 v151, v42, v43
    buffer_store_dwordx4 v[148:151], v232, s[36:39], s32 offen offset:0 sc1
    v_cvt_pk_bf16_f32 v152, v44, v45
    v_cvt_pk_bf16_f32 v153, v46, v47
    v_cvt_pk_bf16_f32 v154, v48, v49
    v_cvt_pk_bf16_f32 v155, v50, v51
    buffer_store_dwordx4 v[152:155], v232, s[36:39], s32 offen offset:1024 sc1
    v_cvt_pk_bf16_f32 v156, v52, v53
    v_cvt_pk_bf16_f32 v157, v54, v55
    v_cvt_pk_bf16_f32 v158, v56, v57
    v_cvt_pk_bf16_f32 v159, v58, v59
    buffer_store_dwordx4 v[156:159], v232, s[36:39], s33 offen offset:0 sc1
    v_cvt_pk_bf16_f32 v160, v60, v61
    v_cvt_pk_bf16_f32 v161, v62, v63
    v_cvt_pk_bf16_f32 v162, v64, v65
    v_cvt_pk_bf16_f32 v163, v66, v67
    buffer_store_dwordx4 v[160:163], v232, s[36:39], s33 offen offset:1024 sc1
    v_cvt_pk_bf16_f32 v132, v68, v69
    v_cvt_pk_bf16_f32 v133, v70, v71
    v_cvt_pk_bf16_f32 v134, v72, v73
    v_cvt_pk_bf16_f32 v135, v74, v75
    buffer_store_dwordx4 v[132:135], v232, s[36:39], s32 offen offset:2048 sc1
    v_cvt_pk_bf16_f32 v136, v76, v77
    v_cvt_pk_bf16_f32 v137, v78, v79
    v_cvt_pk_bf16_f32 v138, v80, v81
    v_cvt_pk_bf16_f32 v139, v82, v83
    buffer_store_dwordx4 v[136:139], v232, s[36:39], s32 offen offset:3072 sc1
    v_cvt_pk_bf16_f32 v140, v84, v85
    v_cvt_pk_bf16_f32 v141, v86, v87
    v_cvt_pk_bf16_f32 v142, v88, v89
    v_cvt_pk_bf16_f32 v143, v90, v91
    buffer_store_dwordx4 v[140:143], v232, s[36:39], s33 offen offset:2048 sc1
    v_cvt_pk_bf16_f32 v144, v92, v93
    v_cvt_pk_bf16_f32 v145, v94, v95
    v_cvt_pk_bf16_f32 v146, v96, v97
    v_cvt_pk_bf16_f32 v147, v98, v99
    buffer_store_dwordx4 v[144:147], v232, s[36:39], s33 offen offset:3072 sc1
    v_and_b32 v186, 31, v185
    s_lshl_b32 s32, s17, 6
    s_add_u32 s32, s32, s24
    v_add_u32 v187, s32, v186
    s_lshl_b32 s32, s17, 13
    s_add_u32 s32, s32, 49152
    v_lshrrev_b32 v189, 5, v185
    v_lshlrev_b32 v188, 7, v186
    v_lshl_add_u32 v188, v189, 6, v188
    v_add_u32 v188, s32, v188
    s_lshl_b32 s32, s18, 7
    s_add_u32 s32, s32, 65536
    v_lshlrev_b32 v189, 11, v189
    v_lshl_add_u32 v189, v186, 2, v189
    v_add_u32 v189, s32, v189
    v_mov_b32 v233, 148544
    s_barrier
    ds_read_b128 v[52:55], v233
    ds_read_b128 v[192:195], v188 offset:0
    ds_read_b128 v[196:199], v188 offset:16
    ds_read_b128 v[200:203], v188 offset:32
    ds_read_b128 v[204:207], v188 offset:48
    ds_read_b128 v[208:211], v188 offset:4096
    ds_read_b128 v[212:215], v188 offset:4112
    ds_read_b128 v[216:219], v188 offset:4128
    ds_read_b128 v[220:223], v188 offset:4144
    ds_read_b32 v224, v189 offset:0
    ds_read_b32 v225, v189 offset:256
    ds_read_b32 v226, v189 offset:512
    ds_read_b32 v227, v189 offset:768
    ds_read_b32 v228, v189 offset:1024
    ds_read_b32 v229, v189 offset:1280
    ds_read_b32 v230, v189 offset:1536
    ds_read_b32 v231, v189 offset:1792
    s_waitcnt lgkmcnt(0)
    v_and_b32 v52, v52, v53
    v_and_b32 v54, v54, v55
    v_and_b32 v52, v52, v54
    s_nop 0
    v_readfirstlane_b32 s32, v52
    s_nop 3
    s_cmp_eq_u32 s32, 1
    s_cbranch_scc0 k1_fallback
    v_pk_add_f32 v[192:193], v[192:193], v[194:195]
    v_pk_add_f32 v[192:193], v[192:193], v[196:197]
    v_pk_add_f32 v[192:193], v[192:193], v[198:199]
    v_pk_add_f32 v[192:193], v[192:193], v[200:201]
    v_pk_add_f32 v[192:193], v[192:193], v[202:203]
    v_pk_add_f32 v[192:193], v[192:193], v[204:205]
    v_pk_add_f32 v[192:193], v[192:193], v[206:207]
    v_mov_b32 v186, v192
    s_nop 1
    v_permlane32_swap_b32 v192, v186
    s_nop 1
    v_add_f32 v192, v192, v186
    v_mov_b32 v186, v193
    s_nop 1
    v_permlane32_swap_b32 v193, v186
    s_nop 1
    v_add_f32 v193, v193, v186
    v_mul_f32 v192, 0x3a800000, v192
    v_mul_f32 v193, 0x3a800000, v193
    v_fma_f32 v186, -v192, v192, v193
    v_max_f32 v186, 0, v186
    v_cvt_pk_bf16_f32 v186, v186, v186
    v_lshlrev_b32 v186, 16, v186
    v_add_f32 v186, 0x3727c5ac, v186
    v_cvt_pk_bf16_f32 v186, v186, v186
    v_lshlrev_b32 v186, 16, v186
    v_sqrt_f32 v186, v186
    s_nop 0
    v_cvt_pk_bf16_f32 v186, v186, v186
    v_lshlrev_b32 v186, 16, v186
    v_rcp_f32 v45, v186
    s_nop 0
    v_cvt_pk_bf16_f32 v44, v192, v192
    v_lshlrev_b32 v44, 16, v44
    v_pk_add_f32 v[208:209], v[208:209], v[210:211]
    v_pk_add_f32 v[208:209], v[208:209], v[212:213]
    v_pk_add_f32 v[208:209], v[208:209], v[214:215]
    v_pk_add_f32 v[208:209], v[208:209], v[216:217]
    v_pk_add_f32 v[208:209], v[208:209], v[218:219]
    v_pk_add_f32 v[208:209], v[208:209], v[220:221]
    v_pk_add_f32 v[208:209], v[208:209], v[222:223]
    v_mov_b32 v186, v208
    s_nop 1
    v_permlane32_swap_b32 v208, v186
    s_nop 1
    v_add_f32 v208, v208, v186
    v_mov_b32 v186, v209
    s_nop 1
    v_permlane32_swap_b32 v209, v186
    s_nop 1
    v_add_f32 v209, v209, v186
    v_mul_f32 v208, 0x3a800000, v208
    v_mul_f32 v209, 0x3a800000, v209
    v_fma_f32 v186, -v208, v208, v209
    v_max_f32 v186, 0, v186
    v_cvt_pk_bf16_f32 v186, v186, v186
    v_lshlrev_b32 v186, 16, v186
    v_add_f32 v186, 0x3727c5ac, v186
    v_cvt_pk_bf16_f32 v186, v186, v186
    v_lshlrev_b32 v186, 16, v186
    v_sqrt_f32 v186, v186
    s_nop 0
    v_cvt_pk_bf16_f32 v186, v186, v186
    v_lshlrev_b32 v186, 16, v186
    v_rcp_f32 v47, v186
    s_nop 0
    v_cvt_pk_bf16_f32 v46, v208, v208
    v_lshlrev_b32 v46, 16, v46
k1_have_stats:
    v_add_f32 v224, v224, v225
    v_add_f32 v224, v224, v226
    v_add_f32 v224, v224, v227
    v_add_f32 v224, v224, v228
    v_add_f32 v224, v224, v229
    v_add_f32 v224, v224, v230
    v_add_f32 v224, v224, v231
    v_mov_b32 v186, v224
    s_nop 1
    v_permlane32_swap_b32 v224, v186
    s_nop 1
    v_add_f32 v224, v224, v186
    v_and_b32 v186, 31, v185
    s_lshl_b32 s32, s16, 7
    s_add_u32 s32, s32, 147520
    v_lshl_add_u32 v188, v186, 2, s32
    ds_write_b32 v188, v224
    v_lshrrev_b32 v189, 5, v185
    v_lshl_add_u32 v188, v189, 4, s32
    v_mul_f32 v186, v45, v45
    v_mul_f32 v186, v186, v45
    v_mul_f32 v6, 0xbdd2d3e8, v186
    v_mov_b32 v7, v45
    v_mul_f32 v5, 0xc0135761, v45
    v_mov_b32 v4, v44
    v_rcp_f32 v7, v7
    s_nop 0
    v_mul_f32 v186, v47, v47
    v_mul_f32 v186, v186, v47
    v_mul_f32 v10, 0xbdd2d3e8, v186
    v_mov_b32 v11, v47
    v_mul_f32 v9, 0xc0135761, v47
    v_mov_b32 v8, v46
    v_rcp_f32 v11, v11
    s_nop 0
    s_waitcnt lgkmcnt(0)
    ds_read_b128 v[20:23], v188 offset:0
    ds_read_b128 v[24:27], v188 offset:32
    ds_read_b128 v[28:31], v188 offset:64
    ds_read_b128 v[32:35], v188 offset:96
    s_lshr_b32 s32, s65, 2
    s_lshr_b32 s33, s32, 1
    s_add_u32 s33, s33, 1
    s_sub_u32 s34, 0, s33
    s_bitcmp1_b32 s32, 0
    s_cselect_b32 s33, s34, s33
    v_add_u32 v187, s33, v187
    v_lshlrev_b32 v189, 9, v189
    v_add_u32 v186, 0, v187
    v_cmp_gt_u32 vcc, 2048, v186
    v_and_b32 v186, 2047, v186
    v_lshrrev_b32 v48, 5, v186
    v_cndmask_b32 v50, 0, -1, vcc
    v_lshlrev_b32 v48, 16, v48
    v_and_b32 v186, 31, v186
    v_lshl_add_u32 v48, v186, 4, v48
    v_add_u32 v48, v48, v189
    v_add_u32 v186, 32, v187
    v_cmp_gt_u32 vcc, 2048, v186
    v_and_b32 v186, 2047, v186
    v_lshrrev_b32 v49, 5, v186
    v_cndmask_b32 v51, 0, -1, vcc
    v_lshlrev_b32 v49, 16, v49
    v_and_b32 v186, 31, v186
    v_lshl_add_u32 v49, v186, 4, v49
    v_add_u32 v49, v49, v189
    s_lshl_b32 s32, s65, 2
    s_lshl_b32 s33, s18, 1
    s_add_u32 s32, s32, s33
    s_lshl_b32 s67, s32, 10
    s_add_u32 s67, s67, 12582912
    s_waitcnt lgkmcnt(0)
    v_mov_b32 v56, v4
    v_mov_b32 v57, v4
    v_mov_b32 v58, v5
    v_mov_b32 v59, v5
    v_mov_b32 v60, v6
    v_mov_b32 v61, v6
    v_mov_b32 v62, v7
    v_mov_b32 v63, v7
    v_pk_fma_f32 v[100:101], v[20:21], v[56:57], v[100:101] neg_lo:[0,1,0] neg_hi:[0,1,0]
    v_pk_fma_f32 v[102:103], v[22:23], v[56:57], v[102:103] neg_lo:[0,1,0] neg_hi:[0,1,0]
    v_pk_fma_f32 v[104:105], v[24:25], v[56:57], v[104:105] neg_lo:[0,1,0] neg_hi:[0,1,0]
    v_pk_fma_f32 v[106:107], v[26:27], v[56:57], v[106:107] neg_lo:[0,1,0] neg_hi:[0,1,0]
    v_pk_mul_f32 v[12:13], v[100:101], v[100:101]
    v_pk_mul_f32 v[14:15], v[102:103], v[102:103]
    v_pk_mul_f32 v[16:17], v[104:105], v[104:105]
    v_pk_mul_f32 v[18:19], v[106:107], v[106:107]
    v_pk_fma_f32 v[12:13], v[12:13], v[60:61], v[58:59]
    v_pk_fma_f32 v[14:15], v[14:15], v[60:61], v[58:59]
    v_pk_fma_f32 v[16:17], v[16:17], v[60:61], v[58:59]
    v_pk_fma_f32 v[18:19], v[18:19], v[60:61], v[58:59]
    v_pk_mul_f32 v[12:13], v[12:13], v[100:101]
    v_pk_mul_f32 v[14:15], v[14:15], v[102:103]
    v_pk_mul_f32 v[16:17], v[16:17], v[104:105]
    v_pk_mul_f32 v[18:19], v[18:19], v[106:107]
    v_exp_f32 v12, v12
    v_exp_f32 v13, v13
    v_exp_f32 v14, v14
    v_exp_f32 v15, v15
    v_exp_f32 v16, v16
    v_exp_f32 v17, v17
    v_exp_f32 v18, v18
    v_exp_f32 v19, v19
    s_nop 0
    v_pk_fma_f32 v[12:13], v[12:13], v[62:63], v[62:63]
    v_pk_fma_f32 v[14:15], v[14:15], v[62:63], v[62:63]
    v_pk_fma_f32 v[16:17], v[16:17], v[62:63], v[62:63]
    v_pk_fma_f32 v[18:19], v[18:19], v[62:63], v[62:63]
    v_rcp_f32 v12, v12
    v_rcp_f32 v13, v13
    v_rcp_f32 v14, v14
    v_rcp_f32 v15, v15
    v_rcp_f32 v16, v16
    v_rcp_f32 v17, v17
    v_rcp_f32 v18, v18
    v_rcp_f32 v19, v19
    s_nop 0
    v_pk_mul_f32 v[12:13], v[12:13], v[100:101]
    v_pk_mul_f32 v[14:15], v[14:15], v[102:103]
    v_pk_mul_f32 v[16:17], v[16:17], v[104:105]
    v_pk_mul_f32 v[18:19], v[18:19], v[106:107]
    v_cvt_pk_bf16_f32 v36, v12, v13
    v_cvt_pk_bf16_f32 v37, v14, v15
    v_cvt_pk_bf16_f32 v38, v16, v17
    v_cvt_pk_bf16_f32 v39, v18, v19
    v_and_b32 v36, v36, v50
    v_and_b32 v37, v37, v50
    v_and_b32 v38, v38, v50
    v_and_b32 v39, v39, v50
    buffer_store_dwordx4 v[36:39], v48, s[36:39], s67 offen offset:0 sc1
    v_pk_fma_f32 v[108:109], v[28:29], v[56:57], v[108:109] neg_lo:[0,1,0] neg_hi:[0,1,0]
    v_pk_fma_f32 v[110:111], v[30:31], v[56:57], v[110:111] neg_lo:[0,1,0] neg_hi:[0,1,0]
    v_pk_fma_f32 v[112:113], v[32:33], v[56:57], v[112:113] neg_lo:[0,1,0] neg_hi:[0,1,0]
    v_pk_fma_f32 v[114:115], v[34:35], v[56:57], v[114:115] neg_lo:[0,1,0] neg_hi:[0,1,0]
    v_pk_mul_f32 v[12:13], v[108:109], v[108:109]
    v_pk_mul_f32 v[14:15], v[110:111], v[110:111]
    v_pk_mul_f32 v[16:17], v[112:113], v[112:113]
    v_pk_mul_f32 v[18:19], v[114:115], v[114:115]
    v_pk_fma_f32 v[12:13], v[12:13], v[60:61], v[58:59]
    v_pk_fma_f32 v[14:15], v[14:15], v[60:61], v[58:59]
    v_pk_fma_f32 v[16:17], v[16:17], v[60:61], v[58:59]
    v_pk_fma_f32 v[18:19], v[18:19], v[60:61], v[58:59]
    v_pk_mul_f32 v[12:13], v[12:13], v[108:109]
    v_pk_mul_f32 v[14:15], v[14:15], v[110:111]
    v_pk_mul_f32 v[16:17], v[16:17], v[112:113]
    v_pk_mul_f32 v[18:19], v[18:19], v[114:115]
    v_exp_f32 v12, v12
    v_exp_f32 v13, v13
    v_exp_f32 v14, v14
    v_exp_f32 v15, v15
    v_exp_f32 v16, v16
    v_exp_f32 v17, v17
    v_exp_f32 v18, v18
    v_exp_f32 v19, v19
    s_nop 0
    v_pk_fma_f32 v[12:13], v[12:13], v[62:63], v[62:63]
    v_pk_fma_f32 v[14:15], v[14:15], v[62:63], v[62:63]
    v_pk_fma_f32 v[16:17], v[16:17], v[62:63], v[62:63]
    v_pk_fma_f32 v[18:19], v[18:19], v[62:63], v[62:63]
    v_rcp_f32 v12, v12
    v_rcp_f32 v13, v13
    v_rcp_f32 v14, v14
    v_rcp_f32 v15, v15
    v_rcp_f32 v16, v16
    v_rcp_f32 v17, v17
    v_rcp_f32 v18, v18
    v_rcp_f32 v19, v19
    s_nop 0
    v_pk_mul_f32 v[12:13], v[12:13], v[108:109]
    v_pk_mul_f32 v[14:15], v[14:15], v[110:111]
    v_pk_mul_f32 v[16:17], v[16:17], v[112:113]
    v_pk_mul_f32 v[18:19], v[18:19], v[114:115]
    v_cvt_pk_bf16_f32 v40, v12, v13
    v_cvt_pk_bf16_f32 v41, v14, v15
    v_cvt_pk_bf16_f32 v42, v16, v17
    v_cvt_pk_bf16_f32 v43, v18, v19
    v_and_b32 v40, v40, v50
    v_and_b32 v41, v41, v50
    v_and_b32 v42, v42, v50
    v_and_b32 v43, v43, v50
    buffer_store_dwordx4 v[40:43], v48, s[36:39], s67 offen offset:1024 sc1
    v_mov_b32 v56, v8
    v_mov_b32 v57, v8
    v_mov_b32 v58, v9
    v_mov_b32 v59, v9
    v_mov_b32 v60, v10
    v_mov_b32 v61, v10
    v_mov_b32 v62, v11
    v_mov_b32 v63, v11
    v_pk_fma_f32 v[116:117], v[20:21], v[56:57], v[116:117] neg_lo:[0,1,0] neg_hi:[0,1,0]
    v_pk_fma_f32 v[118:119], v[22:23], v[56:57], v[118:119] neg_lo:[0,1,0] neg_hi:[0,1,0]
    v_pk_fma_f32 v[120:121], v[24:25], v[56:57], v[120:121] neg_lo:[0,1,0] neg_hi:[0,1,0]
    v_pk_fma_f32 v[122:123], v[26:27], v[56:57], v[122:123] neg_lo:[0,1,0] neg_hi:[0,1,0]
    v_pk_mul_f32 v[12:13], v[116:117], v[116:117]
    v_pk_mul_f32 v[14:15], v[118:119], v[118:119]
    v_pk_mul_f32 v[16:17], v[120:121], v[120:121]
    v_pk_mul_f32 v[18:19], v[122:123], v[122:123]
    v_pk_fma_f32 v[12:13], v[12:13], v[60:61], v[58:59]
    v_pk_fma_f32 v[14:15], v[14:15], v[60:61], v[58:59]
    v_pk_fma_f32 v[16:17], v[16:17], v[60:61], v[58:59]
    v_pk_fma_f32 v[18:19], v[18:19], v[60:61], v[58:59]
    v_pk_mul_f32 v[12:13], v[12:13], v[116:117]
    v_pk_mul_f32 v[14:15], v[14:15], v[118:119]
    v_pk_mul_f32 v[16:17], v[16:17], v[120:121]
    v_pk_mul_f32 v[18:19], v[18:19], v[122:123]
    v_exp_f32 v12, v12
    v_exp_f32 v13, v13
    v_exp_f32 v14, v14
    v_exp_f32 v15, v15
    v_exp_f32 v16, v16
    v_exp_f32 v17, v17
    v_exp_f32 v18, v18
    v_exp_f32 v19, v19
    s_nop 0
    v_pk_fma_f32 v[12:13], v[12:13], v[62:63], v[62:63]
    v_pk_fma_f32 v[14:15], v[14:15], v[62:63], v[62:63]
    v_pk_fma_f32 v[16:17], v[16:17], v[62:63], v[62:63]
    v_pk_fma_f32 v[18:19], v[18:19], v[62:63], v[62:63]
    v_rcp_f32 v12, v12
    v_rcp_f32 v13, v13
    v_rcp_f32 v14, v14
    v_rcp_f32 v15, v15
    v_rcp_f32 v16, v16
    v_rcp_f32 v17, v17
    v_rcp_f32 v18, v18
    v_rcp_f32 v19, v19
    s_nop 0
    v_pk_mul_f32 v[12:13], v[12:13], v[116:117]
    v_pk_mul_f32 v[14:15], v[14:15], v[118:119]
    v_pk_mul_f32 v[16:17], v[16:17], v[120:121]
    v_pk_mul_f32 v[18:19], v[18:19], v[122:123]
    v_cvt_pk_bf16_f32 v36, v12, v13
    v_cvt_pk_bf16_f32 v37, v14, v15
    v_cvt_pk_bf16_f32 v38, v16, v17
    v_cvt_pk_bf16_f32 v39, v18, v19
    v_and_b32 v36, v36, v51
    v_and_b32 v37, v37, v51
    v_and_b32 v38, v38, v51
    v_and_b32 v39, v39, v51
    buffer_store_dwordx4 v[36:39], v49, s[36:39], s67 offen offset:0 sc1
    v_pk_fma_f32 v[124:125], v[28:29], v[56:57], v[124:125] neg_lo:[0,1,0] neg_hi:[0,1,0]
    v_pk_fma_f32 v[126:127], v[30:31], v[56:57], v[126:127] neg_lo:[0,1,0] neg_hi:[0,1,0]
    v_pk_fma_f32 v[128:129], v[32:33], v[56:57], v[128:129] neg_lo:[0,1,0] neg_hi:[0,1,0]
    v_pk_fma_f32 v[130:131], v[34:35], v[56:57], v[130:131] neg_lo:[0,1,0] neg_hi:[0,1,0]
    v_pk_mul_f32 v[12:13], v[124:125], v[124:125]
    v_pk_mul_f32 v[14:15], v[126:127], v[126:127]
    v_pk_mul_f32 v[16:17], v[128:129], v[128:129]
    v_pk_mul_f32 v[18:19], v[130:131], v[130:131]
    v_pk_fma_f32 v[12:13], v[12:13], v[60:61], v[58:59]
    v_pk_fma_f32 v[14:15], v[14:15], v[60:61], v[58:59]
    v_pk_fma_f32 v[16:17], v[16:17], v[60:61], v[58:59]
    v_pk_fma_f32 v[18:19], v[18:19], v[60:61], v[58:59]
    v_pk_mul_f32 v[12:13], v[12:13], v[124:125]
    v_pk_mul_f32 v[14:15], v[14:15], v[126:127]
    v_pk_mul_f32 v[16:17], v[16:17], v[128:129]
    v_pk_mul_f32 v[18:19], v[18:19], v[130:131]
    v_exp_f32 v12, v12
    v_exp_f32 v13, v13
    v_exp_f32 v14, v14
    v_exp_f32 v15, v15
    v_exp_f32 v16, v16
    v_exp_f32 v17, v17
    v_exp_f32 v18, v18
    v_exp_f32 v19, v19
    s_nop 0
    v_pk_fma_f32 v[12:13], v[12:13], v[62:63], v[62:63]
    v_pk_fma_f32 v[14:15], v[14:15], v[62:63], v[62:63]
    v_pk_fma_f32 v[16:17], v[16:17], v[62:63], v[62:63]
    v_pk_fma_f32 v[18:19], v[18:19], v[62:63], v[62:63]
    v_rcp_f32 v12, v12
    v_rcp_f32 v13, v13
    v_rcp_f32 v14, v14
    v_rcp_f32 v15, v15
    v_rcp_f32 v16, v16
    v_rcp_f32 v17, v17
    v_rcp_f32 v18, v18
    v_rcp_f32 v19, v19
    s_nop 0
    v_pk_mul_f32 v[12:13], v[12:13], v[124:125]
    v_pk_mul_f32 v[14:15], v[14:15], v[126:127]
    v_pk_mul_f32 v[16:17], v[16:17], v[128:129]
    v_pk_mul_f32 v[18:19], v[18:19], v[130:131]
    v_cvt_pk_bf16_f32 v40, v12, v13
    v_cvt_pk_bf16_f32 v41, v14, v15
    v_cvt_pk_bf16_f32 v42, v16, v17
    v_cvt_pk_bf16_f32 v43, v18, v19
    v_and_b32 v40, v40, v51
    v_and_b32 v41, v41, v51
    v_and_b32 v42, v42, v51
    v_and_b32 v43, v43, v51
    buffer_store_dwordx4 v[40:43], v49, s[36:39], s67 offen offset:1024 sc1
    s_endpgm
k1_fallback:
    v_and_b32 v186, 31, v185
    s_lshl_b32 s32, s17, 6
    s_add_u32 s32, s32, s24
    v_add_u32 v187, s32, v186
    v_lshrrev_b32 v189, 5, v185
    v_lshlrev_b32 v188, 11, v187
    v_lshl_add_u32 v188, v189, 10, v188
    v_add_u32 v88, 65536, v188
    v_mov_b32 v84, 0
    v_mov_b32 v85, 0
    v_mov_b32 v86, 0
    v_mov_b32 v87, 0
    s_mov_b32 s32, 0
k1_fb_rows:
    buffer_load_dwordx4 v[68:71], v188, s[8:11], s32 offen
    buffer_load_dwordx4 v[72:75], v88, s[8:11], s32 offen
    s_waitcnt vmcnt(0)
    v_lshlrev_b32 v76, 16, v68
    v_and_b32 v77, 0xffff0000, v68
    v_add_f32 v84, v84, v76
    v_fmac_f32 v85, v76, v76
    v_add_f32 v84, v84, v77
    v_fmac_f32 v85, v77, v77
    v_lshlrev_b32 v76, 16, v69
    v_and_b32 v77, 0xffff0000, v69
    v_add_f32 v84, v84, v76
    v_fmac_f32 v85, v76, v76
    v_add_f32 v84, v84, v77
    v_fmac_f32 v85, v77, v77
    v_lshlrev_b32 v76, 16, v70
    v_and_b32 v77, 0xffff0000, v70
    v_add_f32 v84, v84, v76
    v_fmac_f32 v85, v76, v76
    v_add_f32 v84, v84, v77
    v_fmac_f32 v85, v77, v77
    v_lshlrev_b32 v76, 16, v71
    v_and_b32 v77, 0xffff0000, v71
    v_add_f32 v84, v84, v76
    v_fmac_f32 v85, v76, v76
    v_add_f32 v84, v84, v77
    v_fmac_f32 v85, v77, v77
    v_lshlrev_b32 v76, 16, v72
    v_and_b32 v77, 0xffff0000, v72
    v_add_f32 v86, v86, v76
    v_fmac_f32 v87, v76, v76
    v_add_f32 v86, v86, v77
    v_fmac_f32 v87, v77, v77
    v_lshlrev_b32 v76, 16, v73
    v_and_b32 v77, 0xffff0000, v73
    v_add_f32 v86, v86, v76
    v_fmac_f32 v87, v76, v76
    v_add_f32 v86, v86, v77
    v_fmac_f32 v87, v77, v77
    v_lshlrev_b32 v76, 16, v74
    v_and_b32 v77, 0xffff0000, v74
    v_add_f32 v86, v86, v76
    v_fmac_f32 v87, v76, v76
    v_add_f32 v86, v86, v77
    v_fmac_f32 v87, v77, v77
    v_lshlrev_b32 v76, 16, v75
    v_and_b32 v77, 0xffff0000, v75
    v_add_f32 v86, v86, v76
    v_fmac_f32 v87, v76, v76
    v_add_f32 v86, v86, v77
    v_fmac_f32 v87, v77, v77
    s_add_u32 s32, s32, 16
    s_cmp_lt_u32 s32, 1024
    s_cbranch_scc1 k1_fb_rows
    v_mov_b32 v76, v84
    s_nop 1
    v_permlane32_swap_b32 v84, v76
    s_nop 1
    v_add_f32 v84, v84, v76
    v_mov_b32 v76, v85
    s_nop 1
    v_permlane32_swap_b32 v85, v76
    s_nop 1
    v_add_f32 v85, v85, v76
    v_mul_f32 v84, 0x3a800000, v84
    v_mul_f32 v85, 0x3a800000, v85
    v_fma_f32 v76, -v84, v84, v85
    v_max_f32 v76, 0, v76
    v_cvt_pk_bf16_f32 v76, v76, v76
    v_lshlrev_b32 v76, 16, v76
    v_add_f32 v76, 0x3727c5ac, v76
    v_cvt_pk_bf16_f32 v76, v76, v76
    v_lshlrev_b32 v76, 16, v76
    v_sqrt_f32 v76, v76
    s_nop 0
    v_cvt_pk_bf16_f32 v76, v76, v76
    v_lshlrev_b32 v76, 16, v76
    v_rcp_f32 v45, v76
    s_nop 0
    v_cvt_pk_bf16_f32 v44, v84, v84
    v_lshlrev_b32 v44, 16, v44
    v_mov_b32 v76, v86
    s_nop 1
    v_permlane32_swap_b32 v86, v76
    s_nop 1
    v_add_f32 v86, v86, v76
    v_mov_b32 v76, v87
    s_nop 1
    v_permlane32_swap_b32 v87, v76
    s_nop 1
    v_add_f32 v87, v87, v76
    v_mul_f32 v86, 0x3a800000, v86
    v_mul_f32 v87, 0x3a800000, v87
    v_fma_f32 v76, -v86, v86, v87
    v_max_f32 v76, 0, v76
    v_cvt_pk_bf16_f32 v76, v76, v76
    v_lshlrev_b32 v76, 16, v76
    v_add_f32 v76, 0x3727c5ac, v76
    v_cvt_pk_bf16_f32 v76, v76, v76
    v_lshlrev_b32 v76, 16, v76
    v_sqrt_f32 v76, v76
    s_nop 0
    v_cvt_pk_bf16_f32 v76, v76, v76
    v_lshlrev_b32 v76, 16, v76
    v_rcp_f32 v47, v76
    s_nop 0
    v_cvt_pk_bf16_f32 v46, v86, v86
    v_lshlrev_b32 v46, 16, v46
    v_lshlrev_b32 v188, 20, v189
    v_lshl_add_u32 v188, v186, 1, v188
    s_lshl_b32 s32, s65, 7
    s_lshl_b32 s33, s18, 6
    s_add_u32 s32, s32, s33
    s_add_u32 s33, s32, 1048576
    v_mov_b32 v224, 0
    v_mov_b32 v225, 0
    v_mov_b32 v226, 0
    v_mov_b32 v227, 0
    v_mov_b32 v228, 0
    v_mov_b32 v229, 0
    v_mov_b32 v230, 0
    v_mov_b32 v231, 0
k1_fb_cols:
    buffer_load_ushort v68, v188, s[12:15], s32 offen
    buffer_load_ushort v69, v188, s[12:15], s32 offen offset:2048
    s_waitcnt vmcnt(0)
    v_lshlrev_b32 v68, 16, v68
    v_lshlrev_b32 v69, 16, v69
    v_add_f32 v224, v224, v68
    v_add_f32 v225, v225, v69
    s_add_u32 s32, s32, 4096
    s_cmp_lt_u32 s32, s33
    s_cbranch_scc1 k1_fb_cols
    s_branch k1_have_stats
k1_loader:
    s_lshl_b32 s32, s16, 10
    s_lshl_b32 s33, s65, 6
    s_add_u32 s32, s32, s33
    s_cmp_eq_u32 s16, 3
    s_cselect_b32 s23, s33, s32
    s_mov_b32 s22, 3072
    s_cselect_b32 s22, 1024, s22
    v_and_b32 v1, 63, v0
    v_bfe_u32 v2, v1, 2, 2
    v_lshrrev_b32 v3, 4, v1
    v_and_b32 v4, 3, v1
    v_lshrrev_b32 v5, 1, v3
    v_lshl_add_u32 v2, v5, 2, v2
    v_and_b32 v3, 1, v3
    v_lshlrev_b32 v3, 5, v3
    v_lshl_add_u32 v3, v4, 3, v3
    v_add_u32 v3, s23, v3
    v_mul_lo_u32 v2, v2, s22
    v_add_lshl_u32 v10, v2, v3, 1
    s_mul_i32 s32, s22, 16
    s_sub_u32 s33, s32, 1024
    s_add_u32 s34, s32, 3072
    v_add_u32 v11, s33, v10
    v_add_u32 v12, s33, v11
    v_add_u32 v13, s33, v12
    v_add_u32 v14, s34, v13
    v_add_u32 v15, s33, v14
    v_add_u32 v16, s33, v15
    v_add_u32 v17, s33, v16
    s_mov_b32 s20, 0
    s_lshl_b32 s21, s22, 7
    v_lshrrev_b32 v2, 3, v1
    v_and_b32 v3, 7, v1
    v_lshrrev_b32 v4, 4, v1
    v_xor_b32 v5, v3, v4
    v_lshlrev_b32 v5, 4, v5
    v_lshl_add_u32 v5, v2, 11, v5
    v_add_u32 v6, 0, v5
    v_xor_b32 v5, v3, v4
    v_xor_b32 v5, 4, v5
    v_lshlrev_b32 v5, 4, v5
    v_lshl_add_u32 v5, v2, 11, v5
    v_add_u32 v7, 15360, v5
    v_xor_b32 v5, v3, v4
    v_lshlrev_b32 v5, 4, v5
    v_lshl_add_u32 v5, v2, 11, v5
    v_add_u32 v8, 30720, v5
    v_xor_b32 v5, v3, v4
    v_xor_b32 v5, 4, v5
    v_lshlrev_b32 v5, 4, v5
    v_lshl_add_u32 v5, v2, 11, v5
    v_add_u32 v9, 46080, v5
    s_mul_i32 s32, s16, 32
    s_add_u32 s32, s32, s24
    s_add_u32 s32, s32, 0
    s_lshl_b32 s19, s32, 11
    s_mul_i32 s26, s16, 4096
    s_mul_i32 s27, s16, 8192
    s_add_u32 s27, s27, 16384
    v_lshlrev_b32 v32, 4, v1
    s_cmp_eq_u32 s16, 3
    s_mov_b32 s14, 6291456
    s_cselect_b32 s14, 2097152, s14
    s_mov_b32 s15, 0x00020000
    s_waitcnt lgkmcnt(0)
    s_cselect_b32 s12, s52, s50
    s_cselect_b32 s13, s53, s51
    s_and_b32 s13, s13, 0xffff
    s_mov_b32 s8, s48
    s_and_b32 s9, s49, 0xffff
    s_mov_b32 s10, 4194304
    s_mov_b32 s11, 0x00020000
    s_mov_b32 s71, 0
    s_mov_b32 s72, s19
    s_mov_b32 s36, s62
    s_and_b32 s37, s63, 0xffff
    s_mov_b32 s38, 65011712
    s_mov_b32 s39, 0x00020000
    s_mov_b32 s40, s60
    s_and_b32 s41, s61, 0xffff
    s_mov_b32 s42, 256
    s_mov_b32 s43, 0x00020000
    v_mov_b32 v33, 0
    s_mul_i32 s74, s68, s21
    s_lshl_b32 s73, s68, 7
    s_add_u32 s73, s73, s72
    s_cmp_eq_u32 s71, s68
    s_addc_u32 s71, s71, 0
    s_mul_i32 s20, s71, s21
    s_lshl_b32 s19, s71, 7
    s_add_u32 s19, s19, s72
    s_add_u32 s71, s71, 1
    s_add_u32 m0, s26, 0
    s_nop 0
    buffer_load_dwordx4 v6, s[8:11], s19 offen offset:0 lds
    buffer_load_dwordx4 v7, s[8:11], s19 offen offset:1024 lds
    buffer_load_dwordx4 v8, s[8:11], s19 offen offset:2048 lds
    buffer_load_dwordx4 v9, s[8:11], s19 offen offset:3072 lds
    s_add_u32 s19, s19, 128
    s_add_u32 m0, s27, 0
    s_nop 0
    buffer_load_dwordx4 v10, s[12:15], s20 offen offset:0 lds
    buffer_load_dwordx4 v11, s[12:15], s20 offen offset:1024 lds
    buffer_load_dwordx4 v12, s[12:15], s20 offen offset:2048 lds
    buffer_load_dwordx4 v13, s[12:15], s20 offen offset:3072 lds
    s_add_u32 m0, s27, 4096
    s_nop 0
    buffer_load_dwordx4 v14, s[12:15], s20 offen offset:0 lds
    buffer_load_dwordx4 v15, s[12:15], s20 offen offset:1024 lds
    buffer_load_dwordx4 v16, s[12:15], s20 offen offset:2048 lds
    buffer_load_dwordx4 v17, s[12:15], s20 offen offset:3072 lds
    s_add_u32 s20, s20, s21
    s_add_u32 s26, s26, 49152
    s_add_u32 s27, s27, 49152
    s_cmp_ge_u32 s26, 147456
    s_cselect_b32 s34, 147456, 0
    s_sub_u32 s26, s26, s34
    s_sub_u32 s27, s27, s34
    s_cmp_eq_u32 s71, s68
    s_addc_u32 s71, s71, 0
    s_mul_i32 s20, s71, s21
    s_lshl_b32 s19, s71, 7
    s_add_u32 s19, s19, s72
    s_add_u32 s71, s71, 1
    s_add_u32 m0, s26, 0
    s_nop 0
    buffer_load_dwordx4 v6, s[8:11], s19 offen offset:0 lds
    buffer_load_dwordx4 v7, s[8:11], s19 offen offset:1024 lds
    buffer_load_dwordx4 v8, s[8:11], s19 offen offset:2048 lds
    buffer_load_dwordx4 v9, s[8:11], s19 offen offset:3072 lds
    s_add_u32 s19, s19, 128
    s_add_u32 m0, s27, 0
    s_nop 0
    buffer_load_dwordx4 v10, s[12:15], s20 offen offset:0 lds
    buffer_load_dwordx4 v11, s[12:15], s20 offen offset:1024 lds
    buffer_load_dwordx4 v12, s[12:15], s20 offen offset:2048 lds
    buffer_load_dwordx4 v13, s[12:15], s20 offen offset:3072 lds
    s_add_u32 m0, s27, 4096
    s_nop 0
    buffer_load_dwordx4 v14, s[12:15], s20 offen offset:0 lds
    buffer_load_dwordx4 v15, s[12:15], s20 offen offset:1024 lds
    buffer_load_dwordx4 v16, s[12:15], s20 offen offset:2048 lds
    buffer_load_dwordx4 v17, s[12:15], s20 offen offset:3072 lds
    s_add_u32 s20, s20, s21
    s_add_u32 s26, s26, 49152
    s_add_u32 s27, s27, 49152
    s_cmp_ge_u32 s26, 147456
    s_cselect_b32 s34, 147456, 0
    s_sub_u32 s26, s26, s34
    s_sub_u32 s27, s27, s34
    s_setprio 3
    s_waitcnt vmcnt(12)
    s_barrier
    s_cmp_eq_u32 s71, s68
    s_addc_u32 s71, s71, 0
    s_mul_i32 s20, s71, s21
    s_lshl_b32 s19, s71, 7
    s_add_u32 s19, s19, s72
    s_add_u32 s71, s71, 1
    s_add_u32 m0, s26, 0
    s_nop 0
    buffer_load_dwordx4 v6, s[8:11], s19 offen offset:0 lds
    buffer_load_dwordx4 v7, s[8:11], s19 offen offset:1024 lds
    buffer_load_dwordx4 v8, s[8:11], s19 offen offset:2048 lds
    buffer_load_dwordx4 v9, s[8:11], s19 offen offset:3072 lds
    s_add_u32 s19, s19, 128
    s_add_u32 m0, s27, 0
    s_nop 0
    buffer_load_dwordx4 v10, s[12:15], s20 offen offset:0 lds
    buffer_load_dwordx4 v11, s[12:15], s20 offen offset:1024 lds
    buffer_load_dwordx4 v12, s[12:15], s20 offen offset:2048 lds
    buffer_load_dwordx4 v13, s[12:15], s20 offen offset:3072 lds
    s_add_u32 m0, s27, 4096
    s_nop 0
    buffer_load_dwordx4 v14, s[12:15], s20 offen offset:0 lds
    buffer_load_dwordx4 v15, s[12:15], s20 offen offset:1024 lds
    buffer_load_dwordx4 v16, s[12:15], s20 offen offset:2048 lds
    buffer_load_dwordx4 v17, s[12:15], s20 offen offset:3072 lds
    s_add_u32 s20, s20, s21
    s_add_u32 s26, s26, 49152
    s_add_u32 s27, s27, 49152
    s_cmp_ge_u32 s26, 147456
    s_cselect_b32 s34, 147456, 0
    s_sub_u32 s26, s26, s34
    s_sub_u32 s27, s27, s34
    buffer_load_dwordx4 v[28:31], v6, s[8:11], s73 offen offset:0
    buffer_load_dwordx4 v[28:31], v7, s[8:11], s73 offen offset:1024
    buffer_load_dwordx4 v[28:31], v8, s[8:11], s73 offen offset:2048
    s_waitcnt vmcnt(15)
    s_barrier
    s_cmp_eq_u32 s71, s68
    s_addc_u32 s71, s71, 0
    s_mul_i32 s20, s71, s21
    s_lshl_b32 s19, s71, 7
    s_add_u32 s19, s19, s72
    s_add_u32 s71, s71, 1
    s_add_u32 m0, s26, 0
    s_nop 0
    buffer_load_dwordx4 v6, s[8:11], s19 offen offset:0 lds
    buffer_load_dwordx4 v7, s[8:11], s19 offen offset:1024 lds
    buffer_load_dwordx4 v8, s[8:11], s19 offen offset:2048 lds
    buffer_load_dwordx4 v9, s[8:11], s19 offen offset:3072 lds
    s_add_u32 s19, s19, 128
    s_add_u32 m0, s27, 0
    s_nop 0
    buffer_load_dwordx4 v10, s[12:15], s20 offen offset:0 lds
    buffer_load_dwordx4 v11, s[12:15], s20 offen offset:1024 lds
    buffer_load_dwordx4 v12, s[12:15], s20 offen offset:2048 lds
    buffer_load_dwordx4 v13, s[12:15], s20 offen offset:3072 lds
    s_add_u32 m0, s27, 4096
    s_nop 0
    buffer_load_dwordx4 v14, s[12:15], s20 offen offset:0 lds
    buffer_load_dwordx4 v15, s[12:15], s20 offen offset:1024 lds
    buffer_load_dwordx4 v16, s[12:15], s20 offen offset:2048 lds
    buffer_load_dwordx4 v17, s[12:15], s20 offen offset:3072 lds
    s_add_u32 s20, s20, s21
    s_add_u32 s26, s26, 49152
    s_add_u32 s27, s27, 49152
    s_cmp_ge_u32 s26, 147456
    s_cselect_b32 s34, 147456, 0
    s_sub_u32 s26, s26, s34
    s_sub_u32 s27, s27, s34
    s_setprio 3
    buffer_load_dwordx4 v[28:31], v9, s[8:11], s73 offen offset:3072
    buffer_load_dwordx4 v[28:31], v10, s[12:15], s74 offen offset:0
    buffer_load_dwordx4 v[28:31], v11, s[12:15], s74 offen offset:1024
    s_setprio 3
    s_waitcnt vmcnt(18)
    s_barrier
    s_cmp_eq_u32 s71, s68
    s_addc_u32 s71, s71, 0
    s_mul_i32 s20, s71, s21
    s_lshl_b32 s19, s71, 7
    s_add_u32 s19, s19, s72
    s_add_u32 s71, s71, 1
    s_add_u32 m0, s26, 0
    s_nop 0
    buffer_load_dwordx4 v6, s[8:11], s19 offen offset:0 lds
    buffer_load_dwordx4 v7, s[8:11], s19 offen offset:1024 lds
    buffer_load_dwordx4 v8, s[8:11], s19 offen offset:2048 lds
    buffer_load_dwordx4 v9, s[8:11], s19 offen offset:3072 lds
    s_add_u32 s19, s19, 128
    s_add_u32 m0, s27, 0
    s_nop 0
    buffer_load_dwordx4 v10, s[12:15], s20 offen offset:0 lds
    buffer_load_dwordx4 v11, s[12:15], s20 offen offset:1024 lds
    buffer_load_dwordx4 v12, s[12:15], s20 offen offset:2048 lds
    buffer_load_dwordx4 v13, s[12:15], s20 offen offset:3072 lds
    s_add_u32 m0, s27, 4096
    s_nop 0
    buffer_load_dwordx4 v14, s[12:15], s20 offen offset:0 lds
    buffer_load_dwordx4 v15, s[12:15], s20 offen offset:1024 lds
    buffer_load_dwordx4 v16, s[12:15], s20 offen offset:2048 lds
    buffer_load_dwordx4 v17, s[12:15], s20 offen offset:3072 lds
    s_add_u32 s20, s20, s21
    s_add_u32 s26, s26, 49152
    s_add_u32 s27, s27, 49152
    s_cmp_ge_u32 s26, 147456
    s_cselect_b32 s34, 147456, 0
    s_sub_u32 s26, s26, s34
    s_sub_u32 s27, s27, s34
    s_setprio 3
    buffer_load_dwordx4 v[28:31], v12, s[12:15], s74 offen offset:2048
    buffer_load_dwordx4 v[28:31], v13, s[12:15], s74 offen offset:3072
    buffer_load_dwordx4 v[28:31], v14, s[12:15], s74 offen offset:0
    s_setprio 3
    s_waitcnt vmcnt(18)
    s_barrier
    s_cmp_eq_u32 s71, s68
    s_addc_u32 s71, s71, 0
    s_mul_i32 s20, s71, s21
    s_lshl_b32 s19, s71, 7
    s_add_u32 s19, s19, s72
    s_add_u32 s71, s71, 1
    s_add_u32 m0, s26, 0
    s_nop 0
    buffer_load_dwordx4 v6, s[8:11], s19 offen offset:0 lds
    buffer_load_dwordx4 v7, s[8:11], s19 offen offset:1024 lds
    buffer_load_dwordx4 v8, s[8:11], s19 offen offset:2048 lds
    buffer_load_dwordx4 v9, s[8:11], s19 offen offset:3072 lds
    s_add_u32 s19, s19, 128
    s_add_u32 m0, s27, 0
    s_nop 0
    buffer_load_dwordx4 v10, s[12:15], s20 offen offset:0 lds
    buffer_load_dwordx4 v11, s[12:15], s20 offen offset:1024 lds
    buffer_load_dwordx4 v12, s[12:15], s20 offen offset:2048 lds
    buffer_load_dwordx4 v13, s[12:15], s20 offen offset:3072 lds
    s_add_u32 m0, s27, 4096
    s_nop 0
    buffer_load_dwordx4 v14, s[12:15], s20 offen offset:0 lds
    buffer_load_dwordx4 v15, s[12:15], s20 offen offset:1024 lds
    buffer_load_dwordx4 v16, s[12:15], s20 offen offset:2048 lds
    buffer_load_dwordx4 v17, s[12:15], s20 offen offset:3072 lds
    s_add_u32 s20, s20, s21
    s_add_u32 s26, s26, 49152
    s_add_u32 s27, s27, 49152
    s_cmp_ge_u32 s26, 147456
    s_cselect_b32 s34, 147456, 0
    s_sub_u32 s26, s26, s34
    s_sub_u32 s27, s27, s34
    s_setprio 3
    buffer_load_dwordx4 v[28:31], v15, s[12:15], s74 offen offset:1024
    buffer_load_dwordx4 v[28:31], v16, s[12:15], s74 offen offset:2048
    buffer_load_dwordx4 v[28:31], v17, s[12:15], s74 offen offset:3072
    s_setprio 3
    s_waitcnt vmcnt(18)
    s_barrier
    s_mul_i32 s20, s68, s21
    s_lshl_b32 s19, s68, 7
    s_add_u32 s19, s19, s72
    s_add_u32 m0, s26, 0
    s_nop 0
    buffer_load_dwordx4 v6, s[8:11], s19 offen offset:0 lds
    buffer_load_dwordx4 v7, s[8:11], s19 offen offset:1024 lds
    buffer_load_dwordx4 v8, s[8:11], s19 offen offset:2048 lds
    buffer_load_dwordx4 v9, s[8:11], s19 offen offset:3072 lds
    s_add_u32 s19, s19, 128
    s_add_u32 m0, s27, 0
    s_nop 0
    buffer_load_dwordx4 v10, s[12:15], s20 offen offset:0 lds
    buffer_load_dwordx4 v11, s[12:15], s20 offen offset:1024 lds
    buffer_load_dwordx4 v12, s[12:15], s20 offen offset:2048 lds
    buffer_load_dwordx4 v13, s[12:15], s20 offen offset:3072 lds
    s_add_u32 m0, s27, 4096
    s_nop 0
    buffer_load_dwordx4 v14, s[12:15], s20 offen offset:0 lds
    buffer_load_dwordx4 v15, s[12:15], s20 offen offset:1024 lds
    buffer_load_dwordx4 v16, s[12:15], s20 offen offset:2048 lds
    buffer_load_dwordx4 v17, s[12:15], s20 offen offset:3072 lds
    s_add_u32 s20, s20, s21
    s_add_u32 s26, s26, 49152
    s_add_u32 s27, s27, 49152
    s_cmp_ge_u32 s26, 147456
    s_cselect_b32 s34, 147456, 0
    s_sub_u32 s26, s26, s34
    s_sub_u32 s27, s27, s34
    s_setprio 3
    s_setprio 3
    s_waitcnt vmcnt(15)
    s_barrier
    s_cmp_eq_u32 s71, s68
    s_addc_u32 s71, s71, 0
    s_mul_i32 s20, s71, s21
    s_lshl_b32 s19, s71, 7
    s_add_u32 s19, s19, s72
    s_add_u32 s71, s71, 1
    s_add_u32 m0, s26, 0
    s_nop 0
    buffer_load_dwordx4 v6, s[8:11], s19 offen offset:0 lds
    buffer_load_dwordx4 v7, s[8:11], s19 offen offset:1024 lds
    buffer_load_dwordx4 v8, s[8:11], s19 offen offset:2048 lds
    buffer_load_dwordx4 v9, s[8:11], s19 offen offset:3072 lds
    s_add_u32 s19, s19, 128
    s_add_u32 m0, s27, 0
    s_nop 0
    buffer_load_dwordx4 v10, s[12:15], s20 offen offset:0 lds
    buffer_load_dwordx4 v11, s[12:15], s20 offen offset:1024 lds
    buffer_load_dwordx4 v12, s[12:15], s20 offen offset:2048 lds
    buffer_load_dwordx4 v13, s[12:15], s20 offen offset:3072 lds
    s_add_u32 m0, s27, 4096
    s_nop 0
    buffer_load_dwordx4 v14, s[12:15], s20 offen offset:0 lds
    buffer_load_dwordx4 v15, s[12:15], s20 offen offset:1024 lds
    buffer_load_dwordx4 v16, s[12:15], s20 offen offset:2048 lds
    buffer_load_dwordx4 v17, s[12:15], s20 offen offset:3072 lds
    s_add_u32 s20, s20, s21
    s_add_u32 s26, s26, 49152
    s_add_u32 s27, s27, 49152
    s_cmp_ge_u32 s26, 147456
    s_cselect_b32 s34, 147456, 0
    s_sub_u32 s26, s26, s34
    s_sub_u32 s27, s27, s34
    s_waitcnt vmcnt(12)
    s_barrier
    s_cmp_eq_u32 s71, s68
    s_addc_u32 s71, s71, 0
    s_mul_i32 s20, s71, s21
    s_lshl_b32 s19, s71, 7
    s_add_u32 s19, s19, s72
    s_add_u32 s71, s71, 1
    s_add_u32 m0, s26, 0
    s_nop 0
    buffer_load_dwordx4 v6, s[8:11], s19 offen offset:0 lds
    buffer_load_dwordx4 v7, s[8:11], s19 offen offset:1024 lds
    buffer_load_dwordx4 v8, s[8:11], s19 offen offset:2048 lds
    buffer_load_dwordx4 v9, s[8:11], s19 offen offset:3072 lds
    s_add_u32 s19, s19, 128
    s_add_u32 m0, s27, 0
    s_nop 0
    buffer_load_dwordx4 v10, s[12:15], s20 offen offset:0 lds
    buffer_load_dwordx4 v11, s[12:15], s20 offen offset:1024 lds
    buffer_load_dwordx4 v12, s[12:15], s20 offen offset:2048 lds
    buffer_load_dwordx4 v13, s[12:15], s20 offen offset:3072 lds
    s_add_u32 m0, s27, 4096
    s_nop 0
    buffer_load_dwordx4 v14, s[12:15], s20 offen offset:0 lds
    buffer_load_dwordx4 v15, s[12:15], s20 offen offset:1024 lds
    buffer_load_dwordx4 v16, s[12:15], s20 offen offset:2048 lds
    buffer_load_dwordx4 v17, s[12:15], s20 offen offset:3072 lds
    s_add_u32 s20, s20, s21
    s_add_u32 s26, s26, 49152
    s_add_u32 s27, s27, 49152
    s_cmp_ge_u32 s26, 147456
    s_cselect_b32 s34, 147456, 0
    s_sub_u32 s26, s26, s34
    s_sub_u32 s27, s27, s34
    s_mov_b32 s30, 7
k1_ld_loop:
    s_waitcnt vmcnt(12)
    s_barrier
    s_cmp_eq_u32 s71, s68
    s_addc_u32 s71, s71, 0
    s_mul_i32 s20, s71, s21
    s_lshl_b32 s19, s71, 7
    s_add_u32 s19, s19, s72
    s_add_u32 s71, s71, 1
    s_add_u32 m0, s26, 0
    s_nop 0
    buffer_load_dwordx4 v6, s[8:11], s19 offen offset:0 lds
    buffer_load_dwordx4 v7, s[8:11], s19 offen offset:1024 lds
    buffer_load_dwordx4 v8, s[8:11], s19 offen offset:2048 lds
    buffer_load_dwordx4 v9, s[8:11], s19 offen offset:3072 lds
    s_add_u32 s19, s19, 128
    s_add_u32 m0, s27, 0
    s_nop 0
    buffer_load_dwordx4 v10, s[12:15], s20 offen offset:0 lds
    buffer_load_dwordx4 v11, s[12:15], s20 offen offset:1024 lds
    buffer_load_dwordx4 v12, s[12:15], s20 offen offset:2048 lds
    buffer_load_dwordx4 v13, s[12:15], s20 offen offset:3072 lds
    s_add_u32 m0, s27, 4096
    s_nop 0
    buffer_load_dwordx4 v14, s[12:15], s20 offen offset:0 lds
    buffer_load_dwordx4 v15, s[12:15], s20 offen offset:1024 lds
    buffer_load_dwordx4 v16, s[12:15], s20 offen offset:2048 lds
    buffer_load_dwordx4 v17, s[12:15], s20 offen offset:3072 lds
    s_add_u32 s20, s20, s21
    s_add_u32 s26, s26, 49152
    s_add_u32 s27, s27, 49152
    s_cmp_ge_u32 s26, 147456
    s_cselect_b32 s34, 147456, 0
    s_sub_u32 s26, s26, s34
    s_sub_u32 s27, s27, s34
    s_sub_u32 s30, s30, 1
    s_cmp_lg_u32 s30, 0
    s_cbranch_scc1 k1_ld_loop
    s_waitcnt vmcnt(12)
    s_barrier
    s_waitcnt vmcnt(0)
    s_barrier
    s_mov_b32 s34, 0
    s_mov_b32 s70, 1
k1_poll:
    buffer_load_dword v34, v33, s[40:43], 0 offen sc1
    s_waitcnt vmcnt(0)
    v_readfirstlane_b32 s33, v34
    s_nop 3
    s_cmp_ge_u32 s33, 256
    s_cbranch_scc1 k1_ready
    s_add_u32 s34, s34, 1
    s_sleep 4
    s_cmp_lt_u32 s34, 256
    s_cbranch_scc1 k1_poll
    s_mov_b32 s70, 0
k1_ready:
    s_lshl_b32 s32, s16, 12
    s_add_u32 m0, s32, 49152
    s_lshl_b32 s33, s24, 7
    s_add_u32 s32, s32, s33
    s_add_u32 s32, s32, 41172992
    buffer_load_dwordx4 v32, s[36:39], s32 offen offset:0 sc1 lds
    buffer_load_dwordx4 v32, s[36:39], s32 offen offset:1024 sc1 lds
    buffer_load_dwordx4 v32, s[36:39], s32 offen offset:2048 sc1 lds
    buffer_load_dwordx4 v32, s[36:39], s32 offen offset:3072 sc1 lds
    v_lshrrev_b32 v35, 4, v1
    v_lshlrev_b32 v35, 12, v35
    v_and_b32 v34, 15, v1
    v_lshl_add_u32 v35, v34, 4, v35
    s_lshl_b32 s32, s16, 10
    s_add_u32 m0, s32, 65536
    s_lshl_b32 s32, s16, 14
    s_lshl_b32 s33, s65, 8
    s_add_u32 s32, s32, s33
    s_add_u32 s32, s32, 41435136
    buffer_load_dwordx4 v35, s[36:39], s32 offen sc1 lds
    s_lshl_b32 s32, s16, 2
    s_add_u32 s32, s32, 148544
    v_mov_b32 v35, s32
    v_mov_b32 v34, s70
    s_waitcnt vmcnt(0)
    ds_write_b32 v35, v34
    s_waitcnt lgkmcnt(0)
    s_barrier
    s_setprio 0
    s_mov_b32 s44, s54
    s_and_b32 s45, s55, 0xffff
    s_mov_b32 s46, 2097152
    s_mov_b32 s47, 0x00020000
    s_lshr_b32 s32, s2, 3
    s_lshl_b32 s32, s32, 2
    s_add_u32 s32, s32, s16
    s_lshl_b32 s69, s32, 14
    s_and_b32 s32, s2, 1
    s_lshl_b32 s32, s32, 10
    s_add_u32 s69, s69, s32
    buffer_load_dwordx4 v[28:31], v32, s[44:47], s69 offen
    s_add_u32 s69, s69, 2048
    buffer_load_dwordx4 v[28:31], v32, s[44:47], s69 offen
    s_add_u32 s69, s69, 2048
    buffer_load_dwordx4 v[28:31], v32, s[44:47], s69 offen
    s_add_u32 s69, s69, 2048
    buffer_load_dwordx4 v[28:31], v32, s[44:47], s69 offen
    s_add_u32 s69, s69, 2048
    buffer_load_dwordx4 v[28:31], v32, s[44:47], s69 offen
    s_add_u32 s69, s69, 2048
    buffer_load_dwordx4 v[28:31], v32, s[44:47], s69 offen
    s_add_u32 s69, s69, 2048
    buffer_load_dwordx4 v[28:31], v32, s[44:47], s69 offen
    s_add_u32 s69, s69, 2048
    buffer_load_dwordx4 v[28:31], v32, s[44:47], s69 offen
    s_add_u32 s69, s69, 2048
    s_lshr_b32 s42, s2, 3
    s_lshl_b32 s42, s42, 2
    s_add_u32 s42, s42, s16
    s_lshl_b32 s42, s42, 10
    s_cmp_ge_u32 s42, code_end-k2_kernel
    s_cbranch_scc1 cpf_k1b_end
    s_getpc_b64 s[40:41]
cpf_k1b:
    s_add_u32 s42, s42, k2_kernel-cpf_k1b+0x10000
    s_sub_u32 s40, s40, 0x10000
    s_subb_u32 s41, s41, 0
    v_lshl_add_u32 v36, v1, 4, s42
    v_mov_b32 v37, s41
    v_add_co_u32 v36, vcc, s40, v36
    s_nop 1
    v_addc_co_u32 v37, vcc, 0, v37, vcc
    global_load_dwordx4 v[28:31], v[36:37], off
cpf_k1b_end:
k1_end:
    s_endpgm
.globl k2_kernel
.p2align 8
.type k2_kernel,@function
k2_kernel:
    s_cmp_ge_u32 s2, 512
    s_cbranch_scc1 k2_end
    s_load_dwordx2 s[12:13], s[0:1], 0
    s_load_dwordx2 s[14:15], s[0:1], 16
    s_load_dwordx4 s[16:19], s[0:1], 40
    s_load_dwordx4 s[20:23], s[0:1], 56
    s_load_dwordx2 s[24:25], s[0:1], 72
    s_load_dwordx2 s[26:27], s[0:1], 88
    v_lshrrev_b32 v1, 6, v0
    s_and_b32 s28, s2, 7
    v_readfirstlane_b32 s30, v1
    s_lshr_b32 s3, s2, 3
    s_lshr_b32 s29, s3, 1
    s_lshr_b32 s4, s3, 5
    s_xor_b32 s3, s3, s4
    s_bitcmp1_b32 s3, 0
    s_cbranch_scc1 k2_g2
    v_and_b32 v179, 63, v0
    v_lshlrev_b32 v176, 4, v179
    s_lshr_b32 s31, s29, 3
    s_lshl_b32 s37, s28, 2
    s_add_u32 s31, s31, s37
    s_and_b32 s32, s29, 7
    s_lshl_b32 s32, s32, 2
    s_add_u32 s32, s32, s30
    s_lshl_b32 s32, s32, 1
    s_lshl_b32 s33, s31, 18
    s_lshl_b32 s34, s30, 12
    s_add_u32 s33, s33, s34
    s_add_u32 s33, s33, 4194304
    s_mov_b32 s38, s33
    s_lshl_b32 s37, s31, 6
    s_add_u32 s37, s37, s32
    s_lshl_b32 s37, s37, 11
    s_add_u32 s37, s37, 0
    s_waitcnt lgkmcnt(0)
    s_mov_b32 s8, s26
    s_and_b32 s9, s27, 0xffff
    s_mov_b32 s10, 65011712
    s_mov_b32 s11, 0x00020000
    s_setprio 1
    s_mov_b32 m0, s34
    s_add_u32 s34, s34, 16384
    buffer_load_dwordx4 v176, s[8:11], s33 offen offset:0 lds
    buffer_load_dwordx4 v176, s[8:11], s33 offen offset:1024 lds
    buffer_load_dwordx4 v176, s[8:11], s33 offen offset:2048 lds
    buffer_load_dwordx4 v176, s[8:11], s33 offen offset:3072 lds
    s_and_b32 s34, s34, 65535
    s_add_u32 s33, s33, 16384
    buffer_load_dwordx4 v[4:7], v176, s[8:11], s37 offen offset:0
    buffer_load_dwordx4 v[8:11], v176, s[8:11], s37 offen offset:1024
    buffer_load_dwordx4 v[12:15], v176, s[8:11], s37 offen offset:2048
    buffer_load_dwordx4 v[16:19], v176, s[8:11], s37 offen offset:3072
    v_bfe_u32 v180, v179, 4, 1
    v_bfe_u32 v181, v179, 2, 1
    v_cmp_eq_u32 vcc, v180, v181
    v_mov_b32 v180, 0x3f803f80
    s_nop 0
    v_cndmask_b32 v172, 0, v180, vcc
    v_mov_b32 v173, v172
    v_mov_b32 v174, v172
    v_mov_b32 v175, v172
    v_mov_b32 v100, 0
    v_mov_b32 v101, 0
    v_mov_b32 v102, 0
    v_mov_b32 v103, 0
    v_mov_b32 v104, 0
    v_mov_b32 v105, 0
    v_mov_b32 v106, 0
    v_mov_b32 v107, 0
    v_mov_b32 v108, 0
    v_mov_b32 v109, 0
    v_mov_b32 v110, 0
    v_mov_b32 v111, 0
    v_mov_b32 v112, 0
    v_mov_b32 v113, 0
    v_mov_b32 v114, 0
    v_mov_b32 v115, 0
    v_mov_b32 v132, 0
    v_mov_b32 v133, 0
    v_mov_b32 v134, 0
    v_mov_b32 v135, 0
    v_mov_b32 v116, 0
    v_mov_b32 v117, 0
    v_mov_b32 v118, 0
    v_mov_b32 v119, 0
    v_mov_b32 v120, 0
    v_mov_b32 v121, 0
    v_mov_b32 v122, 0
    v_mov_b32 v123, 0
    v_mov_b32 v124, 0
    v_mov_b32 v125, 0
    v_mov_b32 v126, 0
    v_mov_b32 v127, 0
    v_mov_b32 v128, 0
    v_mov_b32 v129, 0
    v_mov_b32 v130, 0
    v_mov_b32 v131, 0
    v_mov_b32 v136, 0
    v_mov_b32 v137, 0
    v_mov_b32 v138, 0
    v_mov_b32 v139, 0
    v_mov_b32 v92, 0
    v_mov_b32 v164, 0
    v_mov_b32 v93, 0
    v_mov_b32 v165, 0
    v_mov_b32 v94, 0
    v_mov_b32 v166, 0
    v_mov_b32 v95, 0
    v_mov_b32 v167, 0
    v_mov_b32 v96, 0
    v_mov_b32 v168, 0
    v_mov_b32 v97, 0
    v_mov_b32 v169, 0
    v_mov_b32 v98, 0
    v_mov_b32 v170, 0
    v_mov_b32 v99, 0
    v_mov_b32 v171, 0
    v_mov_b32 v177, v176
    v_add_u32 v178, 16384, v176
    s_mov_b32 s36, 16384
    s_mov_b32 s35, 0
    v_mov_b32 v180, 65536
    v_mov_b32 v181, 0
    ds_write_b32 v180, v181
    s_waitcnt vmcnt(0) lgkmcnt(0)
    s_barrier
    s_mov_b32 s40, s18
    s_and_b32 s41, s19, 0xffff
    s_mov_b32 s42, 7340032
    s_mov_b32 s43, 0x00020000
    s_lshl_b32 s45, s29, 2
    s_add_u32 s45, s45, s30
    s_and_b32 s46, s45, 15
    s_lshr_b32 s44, s45, 4
    s_lshr_b32 s47, s28, 1
    s_mul_i32 s47, s47, 7
    s_add_u32 s44, s44, s47
    s_mul_i32 s46, s46, 458752
    s_lshl_b32 s44, s44, 8
    s_add_u32 s44, s44, s46
    s_cmp_ge_u32 s45, 112
    s_cselect_b32 s44, 0x7f000000, s44
    v_lshrrev_b32 v224, 4, v179
    v_mul_u32_u24 v224, 7168, v224
    v_and_b32 v180, 15, v179
    v_lshl_add_u32 v224, v180, 4, v224
    v_mov_b32 v216, 0
    v_mov_b32 v217, 0
    v_mov_b32 v218, 0
    v_mov_b32 v219, 0
    v_mov_b32 v220, 0
    v_mov_b32 v221, 0
    v_mov_b32 v222, 0
    v_mov_b32 v223, 0
    s_mov_b32 m0, s34
    s_add_u32 s34, s34, 16384
    buffer_load_dwordx4 v176, s[8:11], s33 offen offset:0 lds
    buffer_load_dwordx4 v176, s[8:11], s33 offen offset:1024 lds
    buffer_load_dwordx4 v176, s[8:11], s33 offen offset:2048 lds
    buffer_load_dwordx4 v176, s[8:11], s33 offen offset:3072 lds
    s_and_b32 s34, s34, 65535
    s_add_u32 s33, s33, 16384
    s_mov_b32 m0, s34
    s_add_u32 s34, s34, 16384
    buffer_load_dwordx4 v176, s[8:11], s33 offen offset:0 lds
    buffer_load_dwordx4 v176, s[8:11], s33 offen offset:1024 lds
    buffer_load_dwordx4 v176, s[8:11], s33 offen offset:2048 lds
    buffer_load_dwordx4 v176, s[8:11], s33 offen offset:3072 lds
    s_and_b32 s34, s34, 65535
    s_add_u32 s33, s33, 16384
    buffer_load_dwordx4 v[184:187], v224, s[40:43], s44 offen
    s_add_u32 s44, s44, 28672
    buffer_load_dwordx4 v[188:191], v224, s[40:43], s44 offen
    s_add_u32 s44, s44, 28672
    buffer_load_dwordx4 v[192:195], v224, s[40:43], s44 offen
    s_add_u32 s44, s44, 28672
    buffer_load_dwordx4 v[196:199], v224, s[40:43], s44 offen
    s_add_u32 s44, s44, 28672
    buffer_load_dwordx4 v[200:203], v224, s[40:43], s44 offen
    s_add_u32 s44, s44, 28672
    buffer_load_dwordx4 v[204:207], v224, s[40:43], s44 offen
    s_add_u32 s44, s44, 28672
    buffer_load_dwordx4 v[208:211], v224, s[40:43], s44 offen
    s_add_u32 s44, s44, 28672
    buffer_load_dwordx4 v[212:215], v224, s[40:43], s44 offen
    s_add_u32 s44, s44, 28672
    ds_read_b128 v[140:143], v177 offset:0
    ds_read_b128 v[144:147], v177 offset:1024
    ds_read_b128 v[148:151], v177 offset:4096
    ds_read_b128 v[152:155], v177 offset:5120
    ds_read_b128 v[156:159], v177 offset:2048
    ds_read_b128 v[160:163], v177 offset:3072
    s_waitcnt lgkmcnt(0)
    v_mfma_f32_32x32x16_bf16 v[52:67], v[140:143], v[4:7], 0
    v_mfma_f32_32x32x16_bf16 v[52:67], v[144:147], v[8:11], v[52:67]
    v_mfma_f32_32x32x16_bf16 v[68:83], v[140:143], v[12:15], 0
    v_mfma_f32_32x32x16_bf16 v[68:83], v[144:147], v[16:19], v[68:83]
    s_nop 15
    s_nop 3
    v_max3_f32 v180, v52, v53, v54
    v_max3_f32 v180, v180, v55, v56
    v_max3_f32 v180, v180, v57, v58
    v_max3_f32 v180, v180, v59, v60
    v_max3_f32 v180, v180, v61, v62
    v_max3_f32 v180, v180, v63, v64
    v_max3_f32 v180, v180, v65, v66
    v_max_f32 v180, v180, v67
    v_mov_b32 v181, v180
    s_nop 1
    v_permlane32_swap_b32 v180, v181
    s_nop 1
    v_max_f32 v180, v180, v181
    v_sub_f32 v20, 0, v180
    v_sub_f32 v21, 0, v180
    v_sub_f32 v22, 0, v180
    v_sub_f32 v23, 0, v180
    v_sub_f32 v24, 0, v180
    v_sub_f32 v25, 0, v180
    v_sub_f32 v26, 0, v180
    v_sub_f32 v27, 0, v180
    v_sub_f32 v28, 0, v180
    v_sub_f32 v29, 0, v180
    v_sub_f32 v30, 0, v180
    v_sub_f32 v31, 0, v180
    v_sub_f32 v32, 0, v180
    v_sub_f32 v33, 0, v180
    v_sub_f32 v34, 0, v180
    v_sub_f32 v35, 0, v180
    v_max3_f32 v180, v68, v69, v70
    v_max3_f32 v180, v180, v71, v72
    v_max3_f32 v180, v180, v73, v74
    v_max3_f32 v180, v180, v75, v76
    v_max3_f32 v180, v180, v77, v78
    v_max3_f32 v180, v180, v79, v80
    v_max3_f32 v180, v180, v81, v82
    v_max_f32 v180, v180, v83
    v_mov_b32 v181, v180
    s_nop 1
    v_permlane32_swap_b32 v180, v181
    s_nop 1
    v_max_f32 v180, v180, v181
    v_sub_f32 v36, 0, v180
    v_sub_f32 v37, 0, v180
    v_sub_f32 v38, 0, v180
    v_sub_f32 v39, 0, v180
    v_sub_f32 v40, 0, v180
    v_sub_f32 v41, 0, v180
    v_sub_f32 v42, 0, v180
    v_sub_f32 v43, 0, v180
    v_sub_f32 v44, 0, v180
    v_sub_f32 v45, 0, v180
    v_sub_f32 v46, 0, v180
    v_sub_f32 v47, 0, v180
    v_sub_f32 v48, 0, v180
    v_sub_f32 v49, 0, v180
    v_sub_f32 v50, 0, v180
    v_sub_f32 v51, 0, v180
    s_nop 1
    v_mfma_f32_32x32x16_bf16 v[52:67], v[140:143], v[4:7], v[20:35]
    v_mfma_f32_32x32x16_bf16 v[52:67], v[144:147], v[8:11], v[52:67]
    s_nop 15
k2_att_loop:
    v_mfma_f32_32x32x16_bf16 v[68:83], v[140:143], v[12:15], v[36:51]
    v_exp_f32 v52, v52
    v_exp_f32 v53, v53
    v_exp_f32 v54, v54
    v_mfma_f32_32x32x16_bf16 v[68:83], v[144:147], v[16:19], v[68:83]
    ds_read_b128 v[140:143], v177 offset:8192
    ds_read_b128 v[144:147], v177 offset:9216
    v_exp_f32 v55, v55
    v_exp_f32 v56, v56
    v_exp_f32 v57, v57
    v_mfma_f32_32x32x16_bf16 v[116:131], v[164:167], v[92:95], v[116:131]
    v_exp_f32 v58, v58
    v_exp_f32 v59, v59
    v_cvt_pk_bf16_f32 v84, v52, v53
    v_cvt_pk_bf16_f32 v85, v54, v55
    v_mfma_f32_32x32x16_bf16 v[116:131], v[168:171], v[96:99], v[116:131]
    ds_read_b128 v[164:167], v177 offset:6144
    ds_read_b128 v[168:171], v177 offset:7168
    v_exp_f32 v60, v60
    v_exp_f32 v61, v61
    v_cvt_pk_bf16_f32 v86, v56, v57
    v_cvt_pk_bf16_f32 v87, v58, v59
    v_mfma_f32_16x16x32_bf16 v[136:139], v[172:175], v[92:95], v[136:139]
    v_exp_f32 v62, v62
    v_exp_f32 v63, v63
    v_mfma_f32_16x16x32_bf16 v[136:139], v[172:175], v[96:99], v[136:139]
    v_exp_f32 v64, v64
    v_exp_f32 v65, v65
    v_cvt_pk_bf16_f32 v88, v60, v61
    v_exp_f32 v66, v66
    v_cvt_pk_bf16_f32 v89, v62, v63
    v_exp_f32 v67, v67
    v_cvt_pk_bf16_f32 v90, v64, v65
    s_nop 0
    v_cvt_pk_bf16_f32 v91, v66, v67
    s_waitcnt lgkmcnt(4)
    v_mfma_f32_32x32x16_bf16 v[52:67], v[148:151], v[4:7], v[20:35]
    v_exp_f32 v68, v68
    v_exp_f32 v69, v69
    v_exp_f32 v70, v70
    v_mfma_f32_32x32x16_bf16 v[52:67], v[152:155], v[8:11], v[52:67]
    v_exp_f32 v71, v71
    v_exp_f32 v72, v72
    v_exp_f32 v73, v73
    v_mfma_f32_32x32x16_bf16 v[100:115], v[156:159], v[84:87], v[100:115]
    v_exp_f32 v74, v74
    v_exp_f32 v75, v75
    v_cvt_pk_bf16_f32 v92, v68, v69
    v_cvt_pk_bf16_f32 v93, v70, v71
    v_mfma_f32_32x32x16_bf16 v[100:115], v[160:163], v[88:91], v[100:115]
    v_exp_f32 v76, v76
    v_exp_f32 v77, v77
    v_cvt_pk_bf16_f32 v94, v72, v73
    v_cvt_pk_bf16_f32 v95, v74, v75
    v_mfma_f32_16x16x32_bf16 v[132:135], v[172:175], v[84:87], v[132:135]
    v_exp_f32 v78, v78
    v_exp_f32 v79, v79
    v_mfma_f32_16x16x32_bf16 v[132:135], v[172:175], v[88:91], v[132:135]
    v_exp_f32 v80, v80
    v_exp_f32 v81, v81
    v_cvt_pk_bf16_f32 v96, v76, v77
    v_exp_f32 v82, v82
    v_cvt_pk_bf16_f32 v97, v78, v79
    v_exp_f32 v83, v83
    v_cvt_pk_bf16_f32 v98, v80, v81
    s_nop 0
    v_cvt_pk_bf16_f32 v99, v82, v83
    v_mfma_f32_32x32x16_bf16 v[68:83], v[148:151], v[12:15], v[36:51]
    v_exp_f32 v52, v52
    v_exp_f32 v53, v53
    v_exp_f32 v54, v54
    v_mfma_f32_32x32x16_bf16 v[68:83], v[152:155], v[16:19], v[68:83]
    ds_read_b128 v[148:151], v177 offset:12288
    ds_read_b128 v[152:155], v177 offset:13312
    v_exp_f32 v55, v55
    v_exp_f32 v56, v56
    v_exp_f32 v57, v57
    v_mfma_f32_32x32x16_bf16 v[116:131], v[156:159], v[92:95], v[116:131]
    v_exp_f32 v58, v58
    v_exp_f32 v59, v59
    v_cvt_pk_bf16_f32 v84, v52, v53
    v_cvt_pk_bf16_f32 v85, v54, v55
    v_mfma_f32_32x32x16_bf16 v[116:131], v[160:163], v[96:99], v[116:131]
    ds_read_b128 v[156:159], v177 offset:10240
    ds_read_b128 v[160:163], v177 offset:11264
    v_exp_f32 v60, v60
    v_exp_f32 v61, v61
    v_cvt_pk_bf16_f32 v86, v56, v57
    v_cvt_pk_bf16_f32 v87, v58, v59
    v_mfma_f32_16x16x32_bf16 v[136:139], v[172:175], v[92:95], v[136:139]
    v_exp_f32 v62, v62
    v_exp_f32 v63, v63
    v_mfma_f32_16x16x32_bf16 v[136:139], v[172:175], v[96:99], v[136:139]
    v_exp_f32 v64, v64
    v_exp_f32 v65, v65
    v_cvt_pk_bf16_f32 v88, v60, v61
    v_exp_f32 v66, v66
    v_cvt_pk_bf16_f32 v89, v62, v63
    v_exp_f32 v67, v67
    v_cvt_pk_bf16_f32 v90, v64, v65
    s_nop 0
    v_cvt_pk_bf16_f32 v91, v66, v67
    s_waitcnt lgkmcnt(4)
    v_mfma_f32_32x32x16_bf16 v[52:67], v[140:143], v[4:7], v[20:35]
    v_exp_f32 v68, v68
    v_exp_f32 v69, v69
    v_exp_f32 v70, v70
    v_mfma_f32_32x32x16_bf16 v[52:67], v[144:147], v[8:11], v[52:67]
    v_exp_f32 v71, v71
    v_exp_f32 v72, v72
    v_exp_f32 v73, v73
    v_mfma_f32_32x32x16_bf16 v[100:115], v[164:167], v[84:87], v[100:115]
    v_exp_f32 v74, v74
    v_exp_f32 v75, v75
    v_cvt_pk_bf16_f32 v92, v68, v69
    v_cvt_pk_bf16_f32 v93, v70, v71
    v_mfma_f32_32x32x16_bf16 v[100:115], v[168:171], v[88:91], v[100:115]
    v_exp_f32 v76, v76
    v_exp_f32 v77, v77
    v_cvt_pk_bf16_f32 v94, v72, v73
    v_cvt_pk_bf16_f32 v95, v74, v75
    v_mfma_f32_16x16x32_bf16 v[132:135], v[172:175], v[84:87], v[132:135]
    v_exp_f32 v78, v78
    v_exp_f32 v79, v79
    v_mfma_f32_16x16x32_bf16 v[132:135], v[172:175], v[88:91], v[132:135]
    v_exp_f32 v80, v80
    v_exp_f32 v81, v81
    v_cvt_pk_bf16_f32 v96, v76, v77
    v_exp_f32 v82, v82
    v_cvt_pk_bf16_f32 v97, v78, v79
    v_exp_f32 v83, v83
    v_cvt_pk_bf16_f32 v98, v80, v81
    s_nop 0
    v_cvt_pk_bf16_f32 v99, v82, v83
    s_cmp_ge_u32 s35, 13
    s_cbranch_scc1 k2_att_tailbar
    s_waitcnt vmcnt(4)
    s_barrier
    s_mov_b32 m0, s34
    s_add_u32 s34, s34, 16384
    buffer_load_dwordx4 v176, s[8:11], s33 offen offset:0 lds
    buffer_load_dwordx4 v176, s[8:11], s33 offen offset:1024 lds
    buffer_load_dwordx4 v176, s[8:11], s33 offen offset:2048 lds
    buffer_load_dwordx4 v176, s[8:11], s33 offen offset:3072 lds
    s_and_b32 s34, s34, 65535
    s_add_u32 s33, s33, 16384
    s_cmp_le_u32 s35, 11
    s_cbranch_scc1 k2_side
k2_att_bardone:
    v_mfma_f32_32x32x16_bf16 v[68:83], v[140:143], v[12:15], v[36:51]
    v_exp_f32 v52, v52
    v_exp_f32 v53, v53
    v_exp_f32 v54, v54
    v_mfma_f32_32x32x16_bf16 v[68:83], v[144:147], v[16:19], v[68:83]
    ds_read_b128 v[140:143], v178 offset:0
    ds_read_b128 v[144:147], v178 offset:1024
    v_exp_f32 v55, v55
    v_exp_f32 v56, v56
    v_exp_f32 v57, v57
    v_mfma_f32_32x32x16_bf16 v[116:131], v[164:167], v[92:95], v[116:131]
    v_exp_f32 v58, v58
    v_exp_f32 v59, v59
    v_cvt_pk_bf16_f32 v84, v52, v53
    v_cvt_pk_bf16_f32 v85, v54, v55
    v_mfma_f32_32x32x16_bf16 v[116:131], v[168:171], v[96:99], v[116:131]
    ds_read_b128 v[164:167], v177 offset:14336
    ds_read_b128 v[168:171], v177 offset:15360
    v_exp_f32 v60, v60
    v_exp_f32 v61, v61
    v_cvt_pk_bf16_f32 v86, v56, v57
    v_cvt_pk_bf16_f32 v87, v58, v59
    v_mfma_f32_16x16x32_bf16 v[136:139], v[172:175], v[92:95], v[136:139]
    v_exp_f32 v62, v62
    v_exp_f32 v63, v63
    v_mfma_f32_16x16x32_bf16 v[136:139], v[172:175], v[96:99], v[136:139]
    v_exp_f32 v64, v64
    v_exp_f32 v65, v65
    v_cvt_pk_bf16_f32 v88, v60, v61
    v_exp_f32 v66, v66
    v_cvt_pk_bf16_f32 v89, v62, v63
    v_exp_f32 v67, v67
    v_cvt_pk_bf16_f32 v90, v64, v65
    s_nop 0
    v_cvt_pk_bf16_f32 v91, v66, v67
    s_waitcnt lgkmcnt(4)
    v_mfma_f32_32x32x16_bf16 v[52:67], v[148:151], v[4:7], v[20:35]
    v_exp_f32 v68, v68
    v_exp_f32 v69, v69
    v_exp_f32 v70, v70
    v_mfma_f32_32x32x16_bf16 v[52:67], v[152:155], v[8:11], v[52:67]
    v_exp_f32 v71, v71
    v_exp_f32 v72, v72
    v_exp_f32 v73, v73
    v_mfma_f32_32x32x16_bf16 v[100:115], v[156:159], v[84:87], v[100:115]
    v_exp_f32 v74, v74
    v_exp_f32 v75, v75
    v_cvt_pk_bf16_f32 v92, v68, v69
    v_cvt_pk_bf16_f32 v93, v70, v71
    v_mfma_f32_32x32x16_bf16 v[100:115], v[160:163], v[88:91], v[100:115]
    v_exp_f32 v76, v76
    v_exp_f32 v77, v77
    v_cvt_pk_bf16_f32 v94, v72, v73
    v_cvt_pk_bf16_f32 v95, v74, v75
    v_mfma_f32_16x16x32_bf16 v[132:135], v[172:175], v[84:87], v[132:135]
    v_exp_f32 v78, v78
    v_exp_f32 v79, v79
    v_mfma_f32_16x16x32_bf16 v[132:135], v[172:175], v[88:91], v[132:135]
    v_exp_f32 v80, v80
    v_exp_f32 v81, v81
    v_cvt_pk_bf16_f32 v96, v76, v77
    v_exp_f32 v82, v82
    v_cvt_pk_bf16_f32 v97, v78, v79
    v_exp_f32 v83, v83
    v_cvt_pk_bf16_f32 v98, v80, v81
    s_nop 0
    v_cvt_pk_bf16_f32 v99, v82, v83
    v_mfma_f32_32x32x16_bf16 v[68:83], v[148:151], v[12:15], v[36:51]
    v_exp_f32 v52, v52
    v_exp_f32 v53, v53
    v_exp_f32 v54, v54
    v_mfma_f32_32x32x16_bf16 v[68:83], v[152:155], v[16:19], v[68:83]
    ds_read_b128 v[148:151], v178 offset:4096
    ds_read_b128 v[152:155], v178 offset:5120
    v_exp_f32 v55, v55
    v_exp_f32 v56, v56
    v_exp_f32 v57, v57
    v_mfma_f32_32x32x16_bf16 v[116:131], v[156:159], v[92:95], v[116:131]
    v_exp_f32 v58, v58
    v_exp_f32 v59, v59
    v_cvt_pk_bf16_f32 v84, v52, v53
    v_cvt_pk_bf16_f32 v85, v54, v55
    v_mfma_f32_32x32x16_bf16 v[116:131], v[160:163], v[96:99], v[116:131]
    ds_read_b128 v[156:159], v178 offset:2048
    ds_read_b128 v[160:163], v178 offset:3072
    v_exp_f32 v60, v60
    v_exp_f32 v61, v61
    v_cvt_pk_bf16_f32 v86, v56, v57
    v_cvt_pk_bf16_f32 v87, v58, v59
    v_mfma_f32_16x16x32_bf16 v[136:139], v[172:175], v[92:95], v[136:139]
    v_exp_f32 v62, v62
    v_exp_f32 v63, v63
    v_mfma_f32_16x16x32_bf16 v[136:139], v[172:175], v[96:99], v[136:139]
    v_exp_f32 v64, v64
    v_exp_f32 v65, v65
    v_cvt_pk_bf16_f32 v88, v60, v61
    v_exp_f32 v66, v66
    v_cvt_pk_bf16_f32 v89, v62, v63
    v_exp_f32 v67, v67
    v_cvt_pk_bf16_f32 v90, v64, v65
    s_add_u32 s35, s35, 1
    v_cvt_pk_bf16_f32 v91, v66, v67
    s_waitcnt lgkmcnt(4)
    v_mfma_f32_32x32x16_bf16 v[52:67], v[140:143], v[4:7], v[20:35]
    v_exp_f32 v68, v68
    v_exp_f32 v69, v69
    v_exp_f32 v70, v70
    v_mfma_f32_32x32x16_bf16 v[52:67], v[144:147], v[8:11], v[52:67]
    v_exp_f32 v71, v71
    v_exp_f32 v72, v72
    v_exp_f32 v73, v73
    v_mfma_f32_32x32x16_bf16 v[100:115], v[164:167], v[84:87], v[100:115]
    v_exp_f32 v74, v74
    v_exp_f32 v75, v75
    v_cvt_pk_bf16_f32 v92, v68, v69
    v_cvt_pk_bf16_f32 v93, v70, v71
    v_mfma_f32_32x32x16_bf16 v[100:115], v[168:171], v[88:91], v[100:115]
    v_exp_f32 v76, v76
    v_exp_f32 v77, v77
    v_cvt_pk_bf16_f32 v94, v72, v73
    v_cvt_pk_bf16_f32 v95, v74, v75
    v_mfma_f32_16x16x32_bf16 v[132:135], v[172:175], v[84:87], v[132:135]
    v_exp_f32 v78, v78
    v_exp_f32 v79, v79
    v_mfma_f32_16x16x32_bf16 v[132:135], v[172:175], v[88:91], v[132:135]
    v_exp_f32 v80, v80
    v_exp_f32 v81, v81
    v_cvt_pk_bf16_f32 v96, v76, v77
    v_exp_f32 v82, v82
    v_cvt_pk_bf16_f32 v97, v78, v79
    v_exp_f32 v83, v83
    v_cvt_pk_bf16_f32 v98, v80, v81
    s_add_u32 s36, s36, 16384
    v_cvt_pk_bf16_f32 v99, v82, v83
    v_mov_b32 v177, v178
    s_and_b32 s36, s36, 65535
    v_add_u32 v178, s36, v176
    s_cmp_lt_u32 s35, 16
    s_cbranch_scc1 k2_att_loop
    s_waitcnt lgkmcnt(0)
    v_mfma_f32_32x32x16_bf16 v[116:131], v[164:167], v[92:95], v[116:131]
    v_mfma_f32_32x32x16_bf16 v[116:131], v[168:171], v[96:99], v[116:131]
    v_mfma_f32_16x16x32_bf16 v[136:139], v[172:175], v[92:95], v[136:139]
    v_mfma_f32_16x16x32_bf16 v[136:139], v[172:175], v[96:99], v[136:139]
    s_nop 15
    s_nop 7
    v_mov_b32 v180, 0
    v_fma_f32 v180, v100, 0, v180
    v_fma_f32 v180, v101, 0, v180
    v_fma_f32 v180, v102, 0, v180
    v_fma_f32 v180, v103, 0, v180
    v_fma_f32 v180, v104, 0, v180
    v_fma_f32 v180, v105, 0, v180
    v_fma_f32 v180, v106, 0, v180
    v_fma_f32 v180, v107, 0, v180
    v_fma_f32 v180, v108, 0, v180
    v_fma_f32 v180, v109, 0, v180
    v_fma_f32 v180, v110, 0, v180
    v_fma_f32 v180, v111, 0, v180
    v_fma_f32 v180, v112, 0, v180
    v_fma_f32 v180, v113, 0, v180
    v_fma_f32 v180, v114, 0, v180
    v_fma_f32 v180, v115, 0, v180
    v_fma_f32 v180, v116, 0, v180
    v_fma_f32 v180, v117, 0, v180
    v_fma_f32 v180, v118, 0, v180
    v_fma_f32 v180, v119, 0, v180
    v_fma_f32 v180, v120, 0, v180
    v_fma_f32 v180, v121, 0, v180
    v_fma_f32 v180, v122, 0, v180
    v_fma_f32 v180, v123, 0, v180
    v_fma_f32 v180, v124, 0, v180
    v_fma_f32 v180, v125, 0, v180
    v_fma_f32 v180, v126, 0, v180
    v_fma_f32 v180, v127, 0, v180
    v_fma_f32 v180, v128, 0, v180
    v_fma_f32 v180, v129, 0, v180
    v_fma_f32 v180, v130, 0, v180
    v_fma_f32 v180, v131, 0, v180
    v_add_f32 v180, v180, v132
    v_add_f32 v180, v180, v136
    v_mov_b32 v181, 0x4e800000
    v_cmp_nlt_f32 vcc, v180, v181
    s_nop 3
    s_cmp_eq_u64 vcc, 0
    s_cbranch_scc1 k2_att_noflag
    v_mov_b32 v180, 65536
    v_mov_b32 v181, 1
    ds_write_b32 v180, v181
k2_att_noflag:
    s_waitcnt vmcnt(0) lgkmcnt(0)
    s_barrier
    v_mov_b32 v180, 65536
    ds_read_b32 v181, v180
    s_waitcnt lgkmcnt(0)
    v_readfirstlane_b32 s37, v181
    s_nop 3
    s_cmp_eq_u32 s37, 0
    s_cbranch_scc0 k2_slow
k2_att_fin:
    s_lshr_b32 s37, s32, 2
    s_lshl_b32 s37, s37, 7
    s_add_u32 s37, s37, 41783296
    v_mov_b32 v180, 0
    s_mov_b32 s36, 0
k2_pl1:
    buffer_load_dword v181, v180, s[8:11], s37 offen sc1
    s_waitcnt vmcnt(0)
    v_readfirstlane_b32 s35, v181
    s_nop 3
    s_cmp_ge_u32 s35, 16
    s_cbranch_scc1 k2_pk1
    s_add_u32 s36, s36, 1
    s_sleep 8
    s_cmp_lt_u32 s36, 0x40000
    s_cbranch_scc1 k2_pl1
k2_pk1:
    v_and_b32 v180, 31, v0
    v_lshlrev_b32 v180, 2, v180
    s_lshl_b32 s37, s32, 7
    s_add_u32 s37, s37, 41156608
    buffer_load_dword v181, v180, s[8:11], s37 offen sc1
    buffer_load_dword v182, v180, s[8:11], s37 offen offset:128 sc1
    s_mul_i32 s37, s32, 288
    s_lshl_b32 s35, s31, 1
    s_add_u32 s37, s37, s35
    s_lshl_b32 s37, s37, 10
    s_add_u32 s37, s37, 20971520
    s_waitcnt vmcnt(0)
    v_rcp_f32 v180, v132
    s_nop 0
    v_mul_f32 v180, v180, v181
    v_mul_f32 v100, v100, v180
    v_mul_f32 v101, v101, v180
    v_mul_f32 v102, v102, v180
    v_mul_f32 v103, v103, v180
    v_mul_f32 v104, v104, v180
    v_mul_f32 v105, v105, v180
    v_mul_f32 v106, v106, v180
    v_mul_f32 v107, v107, v180
    v_mul_f32 v108, v108, v180
    v_mul_f32 v109, v109, v180
    v_mul_f32 v110, v110, v180
    v_mul_f32 v111, v111, v180
    v_mul_f32 v112, v112, v180
    v_mul_f32 v113, v113, v180
    v_mul_f32 v114, v114, v180
    v_mul_f32 v115, v115, v180
    v_cvt_pk_bf16_f32 v84, v100, v101
    v_cvt_pk_bf16_f32 v85, v102, v103
    v_cvt_pk_bf16_f32 v86, v108, v109
    v_cvt_pk_bf16_f32 v87, v110, v111
    v_cvt_pk_bf16_f32 v88, v104, v105
    v_cvt_pk_bf16_f32 v89, v106, v107
    v_cvt_pk_bf16_f32 v90, v112, v113
    v_cvt_pk_bf16_f32 v91, v114, v115
    buffer_store_dwordx4 v[84:87], v176, s[8:11], s37 offen sc1
    buffer_store_dwordx4 v[88:91], v176, s[8:11], s37 offen offset:1024 sc1
    s_add_u32 s37, s37, 294912
    v_rcp_f32 v180, v136
    s_nop 0
    v_mul_f32 v180, v180, v182
    v_mul_f32 v116, v116, v180
    v_mul_f32 v117, v117, v180
    v_mul_f32 v118, v118, v180
    v_mul_f32 v119, v119, v180
    v_mul_f32 v120, v120, v180
    v_mul_f32 v121, v121, v180
    v_mul_f32 v122, v122, v180
    v_mul_f32 v123, v123, v180
    v_mul_f32 v124, v124, v180
    v_mul_f32 v125, v125, v180
    v_mul_f32 v126, v126, v180
    v_mul_f32 v127, v127, v180
    v_mul_f32 v128, v128, v180
    v_mul_f32 v129, v129, v180
    v_mul_f32 v130, v130, v180
    v_mul_f32 v131, v131, v180
    v_cvt_pk_bf16_f32 v92, v116, v117
    v_cvt_pk_bf16_f32 v93, v118, v119
    v_cvt_pk_bf16_f32 v94, v124, v125
    v_cvt_pk_bf16_f32 v95, v126, v127
    v_cvt_pk_bf16_f32 v96, v120, v121
    v_cvt_pk_bf16_f32 v97, v122, v123
    v_cvt_pk_bf16_f32 v98, v128, v129
    v_cvt_pk_bf16_f32 v99, v130, v131
    buffer_store_dwordx4 v[92:95], v176, s[8:11], s37 offen sc1
    buffer_store_dwordx4 v[96:99], v176, s[8:11], s37 offen offset:1024 sc1
    s_add_u32 s37, s37, 294912
    s_lshr_b32 s37, s32, 3
    s_lshl_b32 s37, s37, 7
    s_add_u32 s37, s37, 41782272
    s_waitcnt vmcnt(0)
    s_barrier
    s_cmp_lg_u32 s30, 0
    s_cbranch_scc1 k2_ns2
    s_mov_b64 exec, 1
    v_mov_b32 v180, 0
    v_mov_b32 v181, 1
    buffer_atomic_add v181, v180, s[8:11], s37 offen sc1
    s_mov_b64 exec, -1
k2_ns2:
    s_endpgm
k2_side:
    s_cmp_ge_u32 s35, 2
    s_cbranch_scc1 k2_side5
    s_waitcnt vmcnt(4)
    v_lshlrev_b32 v226, 16, v184
    v_and_b32 v227, 0xffff0000, v184
    v_pk_add_f32 v[216:217], v[216:217], v[226:227]
    v_lshlrev_b32 v226, 16, v185
    v_and_b32 v227, 0xffff0000, v185
    v_pk_add_f32 v[218:219], v[218:219], v[226:227]
    v_lshlrev_b32 v226, 16, v186
    v_and_b32 v227, 0xffff0000, v186
    v_pk_add_f32 v[220:221], v[220:221], v[226:227]
    v_lshlrev_b32 v226, 16, v187
    v_and_b32 v227, 0xffff0000, v187
    v_pk_add_f32 v[222:223], v[222:223], v[226:227]
    v_lshlrev_b32 v226, 16, v188
    v_and_b32 v227, 0xffff0000, v188
    v_pk_add_f32 v[216:217], v[216:217], v[226:227]
    v_lshlrev_b32 v226, 16, v189
    v_and_b32 v227, 0xffff0000, v189
    v_pk_add_f32 v[218:219], v[218:219], v[226:227]
    v_lshlrev_b32 v226, 16, v190
    v_and_b32 v227, 0xffff0000, v190
    v_pk_add_f32 v[220:221], v[220:221], v[226:227]
    v_lshlrev_b32 v226, 16, v191
    v_and_b32 v227, 0xffff0000, v191
    v_pk_add_f32 v[222:223], v[222:223], v[226:227]
    v_lshlrev_b32 v226, 16, v192
    v_and_b32 v227, 0xffff0000, v192
    v_pk_add_f32 v[216:217], v[216:217], v[226:227]
    v_lshlrev_b32 v226, 16, v193
    v_and_b32 v227, 0xffff0000, v193
    v_pk_add_f32 v[218:219], v[218:219], v[226:227]
    v_lshlrev_b32 v226, 16, v194
    v_and_b32 v227, 0xffff0000, v194
    v_pk_add_f32 v[220:221], v[220:221], v[226:227]
    v_lshlrev_b32 v226, 16, v195
    v_and_b32 v227, 0xffff0000, v195
    v_pk_add_f32 v[222:223], v[222:223], v[226:227]
    v_lshlrev_b32 v226, 16, v196
    v_and_b32 v227, 0xffff0000, v196
    v_pk_add_f32 v[216:217], v[216:217], v[226:227]
    v_lshlrev_b32 v226, 16, v197
    v_and_b32 v227, 0xffff0000, v197
    v_pk_add_f32 v[218:219], v[218:219], v[226:227]
    v_lshlrev_b32 v226, 16, v198
    v_and_b32 v227, 0xffff0000, v198
    v_pk_add_f32 v[220:221], v[220:221], v[226:227]
    v_lshlrev_b32 v226, 16, v199
    v_and_b32 v227, 0xffff0000, v199
    v_pk_add_f32 v[222:223], v[222:223], v[226:227]
    v_lshlrev_b32 v226, 16, v200
    v_and_b32 v227, 0xffff0000, v200
    v_pk_add_f32 v[216:217], v[216:217], v[226:227]
    v_lshlrev_b32 v226, 16, v201
    v_and_b32 v227, 0xffff0000, v201
    v_pk_add_f32 v[218:219], v[218:219], v[226:227]
    v_lshlrev_b32 v226, 16, v202
    v_and_b32 v227, 0xffff0000, v202
    v_pk_add_f32 v[220:221], v[220:221], v[226:227]
    v_lshlrev_b32 v226, 16, v203
    v_and_b32 v227, 0xffff0000, v203
    v_pk_add_f32 v[222:223], v[222:223], v[226:227]
    v_lshlrev_b32 v226, 16, v204
    v_and_b32 v227, 0xffff0000, v204
    v_pk_add_f32 v[216:217], v[216:217], v[226:227]
    v_lshlrev_b32 v226, 16, v205
    v_and_b32 v227, 0xffff0000, v205
    v_pk_add_f32 v[218:219], v[218:219], v[226:227]
    v_lshlrev_b32 v226, 16, v206
    v_and_b32 v227, 0xffff0000, v206
    v_pk_add_f32 v[220:221], v[220:221], v[226:227]
    v_lshlrev_b32 v226, 16, v207
    v_and_b32 v227, 0xffff0000, v207
    v_pk_add_f32 v[222:223], v[222:223], v[226:227]
    v_lshlrev_b32 v226, 16, v208
    v_and_b32 v227, 0xffff0000, v208
    v_pk_add_f32 v[216:217], v[216:217], v[226:227]
    v_lshlrev_b32 v226, 16, v209
    v_and_b32 v227, 0xffff0000, v209
    v_pk_add_f32 v[218:219], v[218:219], v[226:227]
    v_lshlrev_b32 v226, 16, v210
    v_and_b32 v227, 0xffff0000, v210
    v_pk_add_f32 v[220:221], v[220:221], v[226:227]
    v_lshlrev_b32 v226, 16, v211
    v_and_b32 v227, 0xffff0000, v211
    v_pk_add_f32 v[222:223], v[222:223], v[226:227]
    v_lshlrev_b32 v226, 16, v212
    v_and_b32 v227, 0xffff0000, v212
    v_pk_add_f32 v[216:217], v[216:217], v[226:227]
    v_lshlrev_b32 v226, 16, v213
    v_and_b32 v227, 0xffff0000, v213
    v_pk_add_f32 v[218:219], v[218:219], v[226:227]
    v_lshlrev_b32 v226, 16, v214
    v_and_b32 v227, 0xffff0000, v214
    v_pk_add_f32 v[220:221], v[220:221], v[226:227]
    v_lshlrev_b32 v226, 16, v215
    v_and_b32 v227, 0xffff0000, v215
    v_pk_add_f32 v[222:223], v[222:223], v[226:227]
    s_cmp_eq_u32 s35, 1
    s_cbranch_scc1 k2_side4
k2_sideL:
    buffer_load_dwordx4 v[184:187], v224, s[40:43], s44 offen
    s_add_u32 s44, s44, 28672
    buffer_load_dwordx4 v[188:191], v224, s[40:43], s44 offen
    s_add_u32 s44, s44, 28672
    buffer_load_dwordx4 v[192:195], v224, s[40:43], s44 offen
    s_add_u32 s44, s44, 28672
    buffer_load_dwordx4 v[196:199], v224, s[40:43], s44 offen
    s_add_u32 s44, s44, 28672
    buffer_load_dwordx4 v[200:203], v224, s[40:43], s44 offen
    s_add_u32 s44, s44, 28672
    buffer_load_dwordx4 v[204:207], v224, s[40:43], s44 offen
    s_add_u32 s44, s44, 28672
    buffer_load_dwordx4 v[208:211], v224, s[40:43], s44 offen
    s_add_u32 s44, s44, 28672
    buffer_load_dwordx4 v[212:215], v224, s[40:43], s44 offen
    s_add_u32 s44, s44, 28672
    s_branch k2_att_bardone
k2_side4:
    s_cmp_ge_u32 s45, 112
    s_cbranch_scc1 k2_att_bardone
    s_xor_b32 s46, s45, s28
    s_bitcmp1_b32 s46, 0
    s_cbranch_scc1 k2_att_bardone
    v_mov_b32 v184, v216
    v_mov_b32 v185, v217
    v_mov_b32 v186, v218
    v_mov_b32 v187, v219
    v_mov_b32 v188, v220
    v_mov_b32 v189, v221
    v_mov_b32 v190, v222
    v_mov_b32 v191, v223
    v_permlane16_swap_b32 v216, v184
    v_permlane16_swap_b32 v217, v185
    v_permlane16_swap_b32 v218, v186
    v_permlane16_swap_b32 v219, v187
    v_permlane16_swap_b32 v220, v188
    v_permlane16_swap_b32 v221, v189
    v_permlane16_swap_b32 v222, v190
    v_permlane16_swap_b32 v223, v191
    v_add_f32 v216, v216, v184
    v_add_f32 v217, v217, v185
    v_add_f32 v218, v218, v186
    v_add_f32 v219, v219, v187
    v_add_f32 v220, v220, v188
    v_add_f32 v221, v221, v189
    v_add_f32 v222, v222, v190
    v_add_f32 v223, v223, v191
    v_mov_b32 v184, v216
    v_mov_b32 v185, v217
    v_mov_b32 v186, v218
    v_mov_b32 v187, v219
    v_mov_b32 v188, v220
    v_mov_b32 v189, v221
    v_mov_b32 v190, v222
    v_mov_b32 v191, v223
    v_permlane32_swap_b32 v216, v184
    v_permlane32_swap_b32 v217, v185
    v_permlane32_swap_b32 v218, v186
    v_permlane32_swap_b32 v219, v187
    v_permlane32_swap_b32 v220, v188
    v_permlane32_swap_b32 v221, v189
    v_permlane32_swap_b32 v222, v190
    v_permlane32_swap_b32 v223, v191
    v_add_f32 v216, v216, v184
    v_add_f32 v217, v217, v185
    v_add_f32 v218, v218, v186
    v_add_f32 v219, v219, v187
    v_add_f32 v220, v220, v188
    v_add_f32 v221, v221, v189
    v_add_f32 v222, v222, v190
    v_add_f32 v223, v223, v191
    s_and_b32 s46, s45, 15
    s_lshr_b32 s44, s45, 4
    s_lshr_b32 s47, s28, 1
    s_mul_i32 s47, s47, 7
    s_add_u32 s44, s44, s47
    s_mul_i32 s46, s46, 14336
    s_lshl_b32 s44, s44, 9
    s_add_u32 s44, s44, s46
    s_add_u32 s44, s44, 41500672
    v_lshlrev_b32 v224, 1, v176
    s_mov_b64 exec, 0xffff
    buffer_store_dwordx4 v[216:219], v224, s[8:11], s44 offen sc1
    buffer_store_dwordx4 v[220:223], v224, s[8:11], s44 offen offset:16 sc1
    s_mov_b64 exec, -1
    s_branch k2_att_bardone
k2_side5:
    s_cmp_eq_u32 s35, 3
    s_cbranch_scc0 k2_side6
    s_mov_b32 s44, 41780224
    s_cmp_lg_u32 s30, 0
    s_cbranch_scc1 k2_ns3
    s_mov_b64 exec, 1
    v_mov_b32 v226, 0
    v_mov_b32 v227, 1
    buffer_atomic_add v227, v226, s[8:11], s44 offen sc1
    s_mov_b64 exec, -1
k2_ns3:
    s_setprio 1
    s_lshl_b32 s46, s28, 5
    s_add_u32 s46, s46, s29
    s_lshl_b32 s46, s46, 2
    s_add_u32 s46, s46, s30
    s_mul_i32 s44, s46, 7168
    s_lshl_b32 s47, s46, 11
    s_mov_b32 s40, s20
    s_and_b32 s41, s21, 0xffff
    s_branch k2_att_bardone
k2_side6:
    s_cmp_lt_u32 s35, 3
    s_cbranch_scc1 k2_att_bardone
    s_cmp_lg_u32 s35, 11
    s_cbranch_scc1 k2_side7
    s_mov_b32 s40, s14
    s_and_b32 s41, s15, 0xffff
    s_mov_b32 s42, 2097152
    s_mov_b32 s44, s47
    buffer_load_dwordx4 v[184:187], v176, s[40:43], s44 offen offset:1024
k2_side7:
    buffer_load_dwordx4 v[184:187], v176, s[40:43], s44 offen
    s_add_u32 s44, s44, 1024
    s_branch k2_att_bardone
k2_att_tailbar:
    s_waitcnt vmcnt(0)
    s_barrier
    s_branch k2_att_bardone
k2_slow:
    v_mov_b32 v100, 0
    v_mov_b32 v101, 0
    v_mov_b32 v102, 0
    v_mov_b32 v103, 0
    v_mov_b32 v104, 0
    v_mov_b32 v105, 0
    v_mov_b32 v106, 0
    v_mov_b32 v107, 0
    v_mov_b32 v108, 0
    v_mov_b32 v109, 0
    v_mov_b32 v110, 0
    v_mov_b32 v111, 0
    v_mov_b32 v112, 0
    v_mov_b32 v113, 0
    v_mov_b32 v114, 0
    v_mov_b32 v115, 0
    v_mov_b32 v132, 0
    v_mov_b32 v133, 0
    v_mov_b32 v134, 0
    v_mov_b32 v135, 0
    v_mov_b32 v116, 0
    v_mov_b32 v117, 0
    v_mov_b32 v118, 0
    v_mov_b32 v119, 0
    v_mov_b32 v120, 0
    v_mov_b32 v121, 0
    v_mov_b32 v122, 0
    v_mov_b32 v123, 0
    v_mov_b32 v124, 0
    v_mov_b32 v125, 0
    v_mov_b32 v126, 0
    v_mov_b32 v127, 0
    v_mov_b32 v128, 0
    v_mov_b32 v129, 0
    v_mov_b32 v130, 0
    v_mov_b32 v131, 0
    v_mov_b32 v136, 0
    v_mov_b32 v137, 0
    v_mov_b32 v138, 0
    v_mov_b32 v139, 0
    v_mov_b32 v20, 0xff61b1e6
    v_mov_b32 v36, 0xff61b1e6
    s_mov_b32 s33, s38
    s_mov_b32 s35, 0
k2_slow_loop:
    s_barrier
    s_lshl_b32 s34, s30, 12
    s_mov_b32 m0, s34
    s_add_u32 s34, s34, 16384
    buffer_load_dwordx4 v176, s[8:11], s33 offen offset:0 lds
    buffer_load_dwordx4 v176, s[8:11], s33 offen offset:1024 lds
    buffer_load_dwordx4 v176, s[8:11], s33 offen offset:2048 lds
    buffer_load_dwordx4 v176, s[8:11], s33 offen offset:3072 lds
    s_and_b32 s34, s34, 65535
    s_add_u32 s33, s33, 16384
    s_waitcnt vmcnt(0)
    s_barrier
    v_mov_b32 v177, v176
    s_mov_b32 s36, 0
k2_slow_tile:
    ds_read_b128 v[140:143], v177 offset:0
    ds_read_b128 v[144:147], v177 offset:1024
    ds_read_b128 v[156:159], v177 offset:2048
    ds_read_b128 v[160:163], v177 offset:3072
    s_waitcnt lgkmcnt(0)
    v_mfma_f32_32x32x16_bf16 v[52:67], v[140:143], v[4:7], 0
    v_mfma_f32_32x32x16_bf16 v[52:67], v[144:147], v[8:11], v[52:67]
    s_nop 15
    s_nop 3
    v_max3_f32 v180, v52, v53, v54
    v_max3_f32 v180, v180, v55, v56
    v_max3_f32 v180, v180, v57, v58
    v_max3_f32 v180, v180, v59, v60
    v_max3_f32 v180, v180, v61, v62
    v_max3_f32 v180, v180, v63, v64
    v_max3_f32 v180, v180, v65, v66
    v_max_f32 v180, v180, v67
    v_mov_b32 v181, v180
    s_nop 1
    v_permlane32_swap_b32 v180, v181
    s_nop 1
    v_max_f32 v180, v180, v181
    v_max_f32 v180, v180, v20
    v_sub_f32 v181, v20, v180
    v_exp_f32 v181, v181
    v_mov_b32 v20, v180
    v_sub_f32 v52, v52, v180
    v_sub_f32 v53, v53, v180
    v_sub_f32 v54, v54, v180
    v_sub_f32 v55, v55, v180
    v_sub_f32 v56, v56, v180
    v_sub_f32 v57, v57, v180
    v_sub_f32 v58, v58, v180
    v_sub_f32 v59, v59, v180
    v_sub_f32 v60, v60, v180
    v_sub_f32 v61, v61, v180
    v_sub_f32 v62, v62, v180
    v_sub_f32 v63, v63, v180
    v_sub_f32 v64, v64, v180
    v_sub_f32 v65, v65, v180
    v_sub_f32 v66, v66, v180
    v_sub_f32 v67, v67, v180
    v_exp_f32 v52, v52
    v_exp_f32 v53, v53
    v_exp_f32 v54, v54
    v_exp_f32 v55, v55
    v_exp_f32 v56, v56
    v_exp_f32 v57, v57
    v_exp_f32 v58, v58
    v_exp_f32 v59, v59
    v_exp_f32 v60, v60
    v_exp_f32 v61, v61
    v_exp_f32 v62, v62
    v_exp_f32 v63, v63
    v_exp_f32 v64, v64
    v_exp_f32 v65, v65
    v_exp_f32 v66, v66
    v_exp_f32 v67, v67
    v_mul_f32 v100, v100, v181
    v_mul_f32 v101, v101, v181
    v_mul_f32 v102, v102, v181
    v_mul_f32 v103, v103, v181
    v_mul_f32 v104, v104, v181
    v_mul_f32 v105, v105, v181
    v_mul_f32 v106, v106, v181
    v_mul_f32 v107, v107, v181
    v_mul_f32 v108, v108, v181
    v_mul_f32 v109, v109, v181
    v_mul_f32 v110, v110, v181
    v_mul_f32 v111, v111, v181
    v_mul_f32 v112, v112, v181
    v_mul_f32 v113, v113, v181
    v_mul_f32 v114, v114, v181
    v_mul_f32 v115, v115, v181
    v_mul_f32 v132, v132, v181
    v_mul_f32 v133, v133, v181
    v_mul_f32 v134, v134, v181
    v_mul_f32 v135, v135, v181
    v_cvt_pk_bf16_f32 v84, v52, v53
    v_cvt_pk_bf16_f32 v85, v54, v55
    v_cvt_pk_bf16_f32 v86, v56, v57
    v_cvt_pk_bf16_f32 v87, v58, v59
    v_cvt_pk_bf16_f32 v88, v60, v61
    v_cvt_pk_bf16_f32 v89, v62, v63
    v_cvt_pk_bf16_f32 v90, v64, v65
    v_cvt_pk_bf16_f32 v91, v66, v67
    s_nop 1
    v_mfma_f32_32x32x16_bf16 v[100:115], v[156:159], v[84:87], v[100:115]
    v_mfma_f32_16x16x32_bf16 v[132:135], v[172:175], v[84:87], v[132:135]
    v_mfma_f32_32x32x16_bf16 v[100:115], v[160:163], v[88:91], v[100:115]
    v_mfma_f32_16x16x32_bf16 v[132:135], v[172:175], v[88:91], v[132:135]
    s_nop 15
    s_nop 3
    v_mfma_f32_32x32x16_bf16 v[52:67], v[140:143], v[12:15], 0
    v_mfma_f32_32x32x16_bf16 v[52:67], v[144:147], v[16:19], v[52:67]
    s_nop 15
    s_nop 3
    v_max3_f32 v180, v52, v53, v54
    v_max3_f32 v180, v180, v55, v56
    v_max3_f32 v180, v180, v57, v58
    v_max3_f32 v180, v180, v59, v60
    v_max3_f32 v180, v180, v61, v62
    v_max3_f32 v180, v180, v63, v64
    v_max3_f32 v180, v180, v65, v66
    v_max_f32 v180, v180, v67
    v_mov_b32 v181, v180
    s_nop 1
    v_permlane32_swap_b32 v180, v181
    s_nop 1
    v_max_f32 v180, v180, v181
    v_max_f32 v180, v180, v36
    v_sub_f32 v181, v36, v180
    v_exp_f32 v181, v181
    v_mov_b32 v36, v180
    v_sub_f32 v52, v52, v180
    v_sub_f32 v53, v53, v180
    v_sub_f32 v54, v54, v180
    v_sub_f32 v55, v55, v180
    v_sub_f32 v56, v56, v180
    v_sub_f32 v57, v57, v180
    v_sub_f32 v58, v58, v180
    v_sub_f32 v59, v59, v180
    v_sub_f32 v60, v60, v180
    v_sub_f32 v61, v61, v180
    v_sub_f32 v62, v62, v180
    v_sub_f32 v63, v63, v180
    v_sub_f32 v64, v64, v180
    v_sub_f32 v65, v65, v180
    v_sub_f32 v66, v66, v180
    v_sub_f32 v67, v67, v180
    v_exp_f32 v52, v52
    v_exp_f32 v53, v53
    v_exp_f32 v54, v54
    v_exp_f32 v55, v55
    v_exp_f32 v56, v56
    v_exp_f32 v57, v57
    v_exp_f32 v58, v58
    v_exp_f32 v59, v59
    v_exp_f32 v60, v60
    v_exp_f32 v61, v61
    v_exp_f32 v62, v62
    v_exp_f32 v63, v63
    v_exp_f32 v64, v64
    v_exp_f32 v65, v65
    v_exp_f32 v66, v66
    v_exp_f32 v67, v67
    v_mul_f32 v116, v116, v181
    v_mul_f32 v117, v117, v181
    v_mul_f32 v118, v118, v181
    v_mul_f32 v119, v119, v181
    v_mul_f32 v120, v120, v181
    v_mul_f32 v121, v121, v181
    v_mul_f32 v122, v122, v181
    v_mul_f32 v123, v123, v181
    v_mul_f32 v124, v124, v181
    v_mul_f32 v125, v125, v181
    v_mul_f32 v126, v126, v181
    v_mul_f32 v127, v127, v181
    v_mul_f32 v128, v128, v181
    v_mul_f32 v129, v129, v181
    v_mul_f32 v130, v130, v181
    v_mul_f32 v131, v131, v181
    v_mul_f32 v136, v136, v181
    v_mul_f32 v137, v137, v181
    v_mul_f32 v138, v138, v181
    v_mul_f32 v139, v139, v181
    v_cvt_pk_bf16_f32 v84, v52, v53
    v_cvt_pk_bf16_f32 v85, v54, v55
    v_cvt_pk_bf16_f32 v86, v56, v57
    v_cvt_pk_bf16_f32 v87, v58, v59
    v_cvt_pk_bf16_f32 v88, v60, v61
    v_cvt_pk_bf16_f32 v89, v62, v63
    v_cvt_pk_bf16_f32 v90, v64, v65
    v_cvt_pk_bf16_f32 v91, v66, v67
    s_nop 1
    v_mfma_f32_32x32x16_bf16 v[116:131], v[156:159], v[84:87], v[116:131]
    v_mfma_f32_16x16x32_bf16 v[136:139], v[172:175], v[84:87], v[136:139]
    v_mfma_f32_32x32x16_bf16 v[116:131], v[160:163], v[88:91], v[116:131]
    v_mfma_f32_16x16x32_bf16 v[136:139], v[172:175], v[88:91], v[136:139]
    s_nop 15
    s_nop 3
    v_add_u32 v177, 4096, v177
    s_add_u32 s36, s36, 1
    s_cmp_lt_u32 s36, 4
    s_cbranch_scc1 k2_slow_tile
    s_add_u32 s35, s35, 1
    s_cmp_lt_u32 s35, 16
    s_cbranch_scc1 k2_slow_loop
    s_branch k2_att_fin
k2_g2:
    s_setprio 2
    s_lshl_b32 s41, s28, 5
    s_add_u32 s41, s41, s29
    s_mov_b32 s52, s30
    s_lshr_b32 s63, s28, 1
    s_lshl_b32 s63, s63, 2
    s_and_b32 s64, s29, 3
    s_add_u32 s63, s63, s64
    s_lshl_b32 s59, s63, 7
    s_and_b32 s63, s28, 1
    s_lshl_b32 s63, s63, 3
    s_lshr_b32 s64, s29, 2
    s_add_u32 s40, s63, s64
    s_lshl_b32 s58, s40, 6
    s_mov_b32 s57, 1024
    s_mov_b32 s60, 12582912
    v_and_b32 v88, 63, v0
    s_lshr_b32 s53, s52, 1
    s_and_b32 s54, s52, 1
    v_bfe_u32 v92, v88, 2, 2
    v_lshrrev_b32 v93, 4, v88
    v_and_b32 v94, 3, v88
    v_lshrrev_b32 v95, 1, v93
    v_lshl_add_u32 v92, v95, 2, v92
    v_and_b32 v93, 1, v93
    s_mul_i32 s63, s52, 16
    v_add_u32 v92, s63, v92
    v_lshlrev_b32 v93, 5, v93
    v_lshl_add_u32 v93, v94, 3, v93
    v_add_u32 v93, s58, v93
    v_mul_lo_u32 v92, v92, s57
    v_add_lshl_u32 v90, v92, v93, 1
    s_mul_i32 s63, s57, 16
    s_sub_u32 s63, s63, 1024
    v_add_u32 v91, s63, v90
    s_mov_b32 s55, 0
    s_mul_i32 s56, s57, 128
    v_lshlrev_b32 v89, 4, v88
    s_mul_i32 s63, s52, 1
    s_lshr_b32 s64, s59, 5
    s_add_u32 s63, s63, s64
    s_add_u32 s63, s63, 0
    s_mul_i32 s63, s63, 65536
    s_add_u32 s62, s63, s60
    s_mul_i32 s63, s53, 8192
    v_add_u32 v84, s63, v89
    v_lshrrev_b32 v92, 5, v88
    v_mul_u32_u24 v92, 512, v92
    v_bfe_u32 v93, v88, 2, 2
    v_lshl_add_u32 v92, v93, 6, v92
    v_bfe_u32 v93, v88, 4, 1
    v_lshl_add_u32 v92, v93, 5, v92
    v_and_b32 v93, 3, v88
    v_lshl_add_u32 v92, v93, 3, v92
    s_mul_i32 s63, s54, 256
    s_add_u32 s63, s63, 16384
    v_add_u32 v86, s63, v92
    v_add_u32 v85, 49152, v84
    v_add_u32 v87, 49152, v86
    s_mul_i32 s57, s52, 4096
    s_mul_i32 s60, s52, 2048
    s_add_u32 s60, s60, 16384
    v_and_b32 v92, 31, v88
    s_lshl_b32 s63, s53, 6
    s_add_u32 s63, s63, s59
    v_add_u32 v92, s63, v92
    v_lshlrev_b32 v92, 11, v92
    v_lshrrev_b32 v93, 5, v88
    v_lshl_add_u32 v92, v93, 3, v92
    s_lshl_b32 s63, s54, 5
    s_add_u32 s63, s63, s58
    s_lshl_b32 s63, s63, 1
    v_add_u32 v112, s63, v92
    v_add_u32 v113, 65536, v112
    s_waitcnt lgkmcnt(0)
    s_mov_b32 s8, s26
    s_and_b32 s9, s27, 0xffff
    s_mov_b32 s10, 65011712
    s_mov_b32 s11, 0x00020000
    s_mov_b32 s44, s26
    s_and_b32 s45, s27, 0xffff
    s_mov_b32 s46, 65011712
    s_mov_b32 s47, 0x00020000
    s_mov_b32 s48, s16
    s_and_b32 s49, s17, 0xffff
    s_mov_b32 s50, 2097152
    s_mov_b32 s51, 0x00020000
    s_mov_b32 s32, s12
    s_and_b32 s33, s13, 0xffff
    s_mov_b32 s34, 4194304
    s_mov_b32 s35, 0x00020000
    s_mov_b32 s36, s22
    s_and_b32 s37, s23, 0xffff
    s_mov_b32 s38, 2048
    s_mov_b32 s39, 0x00020000
    v_lshlrev_b32 v95, 5, v88
    s_lshl_b32 s66, s40, 3
    s_add_u32 s66, s66, s59
    s_lshl_b32 s63, s30, 1
    s_add_u32 s66, s66, s63
    s_lshl_b32 s63, s66, 11
    v_mov_b32 v160, v95
    s_mov_b32 s67, s63
    buffer_load_dwordx4 v[132:135], v160, s[36:39], 0 offen
    buffer_load_dwordx4 v[136:139], v160, s[36:39], 0 offen offset:16
    buffer_load_dwordx4 v[116:119], v160, s[32:35], s67 offen offset:0
    buffer_load_dwordx4 v[120:123], v160, s[32:35], s67 offen offset:16
    buffer_load_dwordx4 v[124:127], v160, s[32:35], s67 offen offset:2048
    buffer_load_dwordx4 v[128:131], v160, s[32:35], s67 offen offset:2064
    s_add_u32 m0, s57, 0
    s_nop 0
    buffer_load_dwordx4 v89, s[44:47], s62 offen offset:0 lds
    buffer_load_dwordx4 v89, s[44:47], s62 offen offset:1024 lds
    buffer_load_dwordx4 v89, s[44:47], s62 offen offset:2048 lds
    buffer_load_dwordx4 v89, s[44:47], s62 offen offset:3072 lds
    s_add_u32 s62, s62, 4096
    s_add_u32 m0, s60, 0
    s_nop 0
    buffer_load_dwordx4 v90, s[48:51], s55 offen offset:0 lds
    buffer_load_dwordx4 v91, s[48:51], s55 offen offset:1024 lds
    s_add_u32 s55, s55, s56
    s_add_u32 m0, s57, 24576
    s_nop 0
    buffer_load_dwordx4 v89, s[44:47], s62 offen offset:0 lds
    buffer_load_dwordx4 v89, s[44:47], s62 offen offset:1024 lds
    buffer_load_dwordx4 v89, s[44:47], s62 offen offset:2048 lds
    buffer_load_dwordx4 v89, s[44:47], s62 offen offset:3072 lds
    s_add_u32 s62, s62, 4096
    s_add_u32 m0, s60, 24576
    s_nop 0
    buffer_load_dwordx4 v90, s[48:51], s55 offen offset:0 lds
    buffer_load_dwordx4 v91, s[48:51], s55 offen offset:1024 lds
    s_add_u32 s55, s55, s56
    v_mov_b32 v148, 0
    v_mov_b32 v149, 0
    v_mov_b32 v150, 0
    v_mov_b32 v151, 0
    s_waitcnt vmcnt(12)
    v_lshlrev_b32 v140, 16, v132
    v_and_b32 v141, 0xffff0000, v132
    v_lshlrev_b32 v142, 16, v116
    v_and_b32 v143, 0xffff0000, v116
    v_pk_mul_f32 v[142:143], v[142:143], v[140:141]
    v_cvt_pk_bf16_f32 v144, v142, v143
    v_lshlrev_b32 v142, 16, v144
    v_and_b32 v143, 0xffff0000, v144
    v_pk_add_f32 v[148:149], v[148:149], v[142:143]
    v_lshlrev_b32 v142, 16, v124
    v_and_b32 v143, 0xffff0000, v124
    v_pk_mul_f32 v[142:143], v[142:143], v[140:141]
    v_cvt_pk_bf16_f32 v144, v142, v143
    v_lshlrev_b32 v142, 16, v144
    v_and_b32 v143, 0xffff0000, v144
    v_pk_add_f32 v[150:151], v[150:151], v[142:143]
    v_lshlrev_b32 v140, 16, v133
    v_and_b32 v141, 0xffff0000, v133
    v_lshlrev_b32 v142, 16, v117
    v_and_b32 v143, 0xffff0000, v117
    v_pk_mul_f32 v[142:143], v[142:143], v[140:141]
    v_cvt_pk_bf16_f32 v144, v142, v143
    v_lshlrev_b32 v142, 16, v144
    v_and_b32 v143, 0xffff0000, v144
    v_pk_add_f32 v[148:149], v[148:149], v[142:143]
    v_lshlrev_b32 v142, 16, v125
    v_and_b32 v143, 0xffff0000, v125
    v_pk_mul_f32 v[142:143], v[142:143], v[140:141]
    v_cvt_pk_bf16_f32 v144, v142, v143
    v_lshlrev_b32 v142, 16, v144
    v_and_b32 v143, 0xffff0000, v144
    v_pk_add_f32 v[150:151], v[150:151], v[142:143]
    v_lshlrev_b32 v140, 16, v134
    v_and_b32 v141, 0xffff0000, v134
    v_lshlrev_b32 v142, 16, v118
    v_and_b32 v143, 0xffff0000, v118
    v_pk_mul_f32 v[142:143], v[142:143], v[140:141]
    v_cvt_pk_bf16_f32 v144, v142, v143
    v_lshlrev_b32 v142, 16, v144
    v_and_b32 v143, 0xffff0000, v144
    v_pk_add_f32 v[148:149], v[148:149], v[142:143]
    v_lshlrev_b32 v142, 16, v126
    v_and_b32 v143, 0xffff0000, v126
    v_pk_mul_f32 v[142:143], v[142:143], v[140:141]
    v_cvt_pk_bf16_f32 v144, v142, v143
    v_lshlrev_b32 v142, 16, v144
    v_and_b32 v143, 0xffff0000, v144
    v_pk_add_f32 v[150:151], v[150:151], v[142:143]
    v_lshlrev_b32 v140, 16, v135
    v_and_b32 v141, 0xffff0000, v135
    v_lshlrev_b32 v142, 16, v119
    v_and_b32 v143, 0xffff0000, v119
    v_pk_mul_f32 v[142:143], v[142:143], v[140:141]
    v_cvt_pk_bf16_f32 v144, v142, v143
    v_lshlrev_b32 v142, 16, v144
    v_and_b32 v143, 0xffff0000, v144
    v_pk_add_f32 v[148:149], v[148:149], v[142:143]
    v_lshlrev_b32 v142, 16, v127
    v_and_b32 v143, 0xffff0000, v127
    v_pk_mul_f32 v[142:143], v[142:143], v[140:141]
    v_cvt_pk_bf16_f32 v144, v142, v143
    v_lshlrev_b32 v142, 16, v144
    v_and_b32 v143, 0xffff0000, v144
    v_pk_add_f32 v[150:151], v[150:151], v[142:143]
    v_lshlrev_b32 v140, 16, v136
    v_and_b32 v141, 0xffff0000, v136
    v_lshlrev_b32 v142, 16, v120
    v_and_b32 v143, 0xffff0000, v120
    v_pk_mul_f32 v[142:143], v[142:143], v[140:141]
    v_cvt_pk_bf16_f32 v144, v142, v143
    v_lshlrev_b32 v142, 16, v144
    v_and_b32 v143, 0xffff0000, v144
    v_pk_add_f32 v[148:149], v[148:149], v[142:143]
    v_lshlrev_b32 v142, 16, v128
    v_and_b32 v143, 0xffff0000, v128
    v_pk_mul_f32 v[142:143], v[142:143], v[140:141]
    v_cvt_pk_bf16_f32 v144, v142, v143
    v_lshlrev_b32 v142, 16, v144
    v_and_b32 v143, 0xffff0000, v144
    v_pk_add_f32 v[150:151], v[150:151], v[142:143]
    v_lshlrev_b32 v140, 16, v137
    v_and_b32 v141, 0xffff0000, v137
    v_lshlrev_b32 v142, 16, v121
    v_and_b32 v143, 0xffff0000, v121
    v_pk_mul_f32 v[142:143], v[142:143], v[140:141]
    v_cvt_pk_bf16_f32 v144, v142, v143
    v_lshlrev_b32 v142, 16, v144
    v_and_b32 v143, 0xffff0000, v144
    v_pk_add_f32 v[148:149], v[148:149], v[142:143]
    v_lshlrev_b32 v142, 16, v129
    v_and_b32 v143, 0xffff0000, v129
    v_pk_mul_f32 v[142:143], v[142:143], v[140:141]
    v_cvt_pk_bf16_f32 v144, v142, v143
    v_lshlrev_b32 v142, 16, v144
    v_and_b32 v143, 0xffff0000, v144
    v_pk_add_f32 v[150:151], v[150:151], v[142:143]
    v_lshlrev_b32 v140, 16, v138
    v_and_b32 v141, 0xffff0000, v138
    v_lshlrev_b32 v142, 16, v122
    v_and_b32 v143, 0xffff0000, v122
    v_pk_mul_f32 v[142:143], v[142:143], v[140:141]
    v_cvt_pk_bf16_f32 v144, v142, v143
    v_lshlrev_b32 v142, 16, v144
    v_and_b32 v143, 0xffff0000, v144
    v_pk_add_f32 v[148:149], v[148:149], v[142:143]
    v_lshlrev_b32 v142, 16, v130
    v_and_b32 v143, 0xffff0000, v130
    v_pk_mul_f32 v[142:143], v[142:143], v[140:141]
    v_cvt_pk_bf16_f32 v144, v142, v143
    v_lshlrev_b32 v142, 16, v144
    v_and_b32 v143, 0xffff0000, v144
    v_pk_add_f32 v[150:151], v[150:151], v[142:143]
    v_lshlrev_b32 v140, 16, v139
    v_and_b32 v141, 0xffff0000, v139
    v_lshlrev_b32 v142, 16, v123
    v_and_b32 v143, 0xffff0000, v123
    v_pk_mul_f32 v[142:143], v[142:143], v[140:141]
    v_cvt_pk_bf16_f32 v144, v142, v143
    v_lshlrev_b32 v142, 16, v144
    v_and_b32 v143, 0xffff0000, v144
    v_pk_add_f32 v[148:149], v[148:149], v[142:143]
    v_lshlrev_b32 v142, 16, v131
    v_and_b32 v143, 0xffff0000, v131
    v_pk_mul_f32 v[142:143], v[142:143], v[140:141]
    v_cvt_pk_bf16_f32 v144, v142, v143
    v_lshlrev_b32 v142, 16, v144
    v_and_b32 v143, 0xffff0000, v144
    v_pk_add_f32 v[150:151], v[150:151], v[142:143]
    v_add_f32 v148, v148, v149
    v_add_f32 v150, v150, v151
    s_nop 1
    v_add_f32_dpp v148, v148, v148 row_ror:8 row_mask:0xf bank_mask:0xf
    v_add_f32_dpp v150, v150, v150 row_ror:8 row_mask:0xf bank_mask:0xf
    s_nop 0
    v_add_f32_dpp v148, v148, v148 row_ror:4 row_mask:0xf bank_mask:0xf
    v_add_f32_dpp v150, v150, v150 row_ror:4 row_mask:0xf bank_mask:0xf
    s_nop 0
    v_add_f32_dpp v148, v148, v148 row_ror:2 row_mask:0xf bank_mask:0xf
    v_add_f32_dpp v150, v150, v150 row_ror:2 row_mask:0xf bank_mask:0xf
    s_nop 0
    v_add_f32_dpp v148, v148, v148 row_ror:1 row_mask:0xf bank_mask:0xf
    v_add_f32_dpp v150, v150, v150 row_ror:1 row_mask:0xf bank_mask:0xf
    s_nop 0
    v_mov_b32 v140, v148
    v_mov_b32 v141, v150
    s_nop 1
    v_permlane16_swap_b32 v148, v140
    v_permlane16_swap_b32 v150, v141
    s_nop 1
    v_add_f32 v148, v148, v140
    v_add_f32 v150, v150, v141
    v_mov_b32 v140, v148
    v_mov_b32 v141, v150
    s_nop 1
    v_permlane32_swap_b32 v148, v140
    v_permlane32_swap_b32 v150, v141
    s_nop 1
    v_add_f32 v148, v148, v140
    v_add_f32 v150, v150, v141
    v_cvt_pk_bf16_f32 v148, v148, v148
    v_lshlrev_b32 v148, 16, v148
    v_mul_f32 v148, 0xbfb8aa3b, v148
    v_exp_f32 v148, v148
    s_nop 0
    v_add_f32 v148, 1.0, v148
    v_rcp_f32 v148, v148
    s_nop 0
    v_cvt_pk_bf16_f32 v152, v148, v148
    v_lshlrev_b32 v152, 16, v152
    v_sub_f32 v148, 1.0, v152
    v_cvt_pk_bf16_f32 v154, v148, v148
    v_lshlrev_b32 v154, 16, v154
    v_cvt_pk_bf16_f32 v150, v150, v150
    v_lshlrev_b32 v150, 16, v150
    v_mul_f32 v150, 0xbfb8aa3b, v150
    v_exp_f32 v150, v150
    s_nop 0
    v_add_f32 v150, 1.0, v150
    v_rcp_f32 v150, v150
    s_nop 0
    v_cvt_pk_bf16_f32 v153, v150, v150
    v_lshlrev_b32 v153, 16, v153
    v_sub_f32 v150, 1.0, v153
    v_cvt_pk_bf16_f32 v155, v150, v150
    v_lshlrev_b32 v155, 16, v155
    v_mov_b32 v94, 0
    s_lshl_b32 s63, s66, 2
    s_add_u32 s63, s63, 41156608
    s_add_u32 s64, s63, 8192
    s_mov_b64 exec, 1
    buffer_store_dwordx2 v[152:153], v94, s[8:11], s63 offen sc1
    buffer_store_dwordx2 v[154:155], v94, s[8:11], s64 offen sc1
    s_mov_b64 exec, -1
    s_mov_b32 s43, 3
    s_waitcnt vmcnt(8)
    s_barrier
    ds_read_b64_tr_b16 v[68:69], v86 offset:0
    ds_read_b64_tr_b16 v[70:71], v86 offset:1024
    ds_read_b128 v[36:39], v84 offset:0
    ds_read_b128 v[40:43], v84 offset:4096
    ds_read_b64_tr_b16 v[72:73], v86 offset:2048
    ds_read_b64_tr_b16 v[74:75], v86 offset:3072
    ds_read_b128 v[44:47], v84 offset:1024
    ds_read_b128 v[48:51], v84 offset:5120
    s_add_u32 m0, s57, 49152
    s_nop 0
    buffer_load_dwordx4 v89, s[44:47], s62 offen offset:0 lds
    buffer_load_dwordx4 v89, s[44:47], s62 offen offset:1024 lds
    buffer_load_dwordx4 v89, s[44:47], s62 offen offset:2048 lds
    s_waitcnt lgkmcnt(5)
    v_mfma_f32_32x32x16_bf16 v[4:19], v[68:71], v[36:39], 0
    ds_read_b64_tr_b16 v[76:77], v86 offset:4096
    ds_read_b64_tr_b16 v[78:79], v86 offset:5120
    buffer_load_dwordx4 v89, s[44:47], s62 offen offset:3072 lds
    s_add_u32 s62, s62, 4096
    s_waitcnt lgkmcnt(6)
    v_mfma_f32_32x32x16_bf16 v[20:35], v[68:71], v[40:43], 0
    ds_read_b128 v[52:55], v84 offset:2048
    ds_read_b128 v[56:59], v84 offset:6144
    s_waitcnt lgkmcnt(5)
    v_mfma_f32_32x32x16_bf16 v[4:19], v[72:75], v[44:47], v[4:19]
    ds_read_b64_tr_b16 v[80:81], v86 offset:6144
    ds_read_b64_tr_b16 v[82:83], v86 offset:7168
    s_add_u32 m0, s60, 49152
    s_nop 0
    buffer_load_dwordx4 v90, s[48:51], s55 offen offset:0 lds
    s_waitcnt lgkmcnt(6)
    v_mfma_f32_32x32x16_bf16 v[20:35], v[72:75], v[48:51], v[20:35]
    ds_read_b128 v[60:63], v84 offset:3072
    ds_read_b128 v[64:67], v84 offset:7168
    buffer_load_dwordx4 v91, s[48:51], s55 offen offset:1024 lds
    s_add_u32 s55, s55, s56
    s_waitcnt vmcnt(8) lgkmcnt(0)
    v_mfma_f32_32x32x16_bf16 v[4:19], v[76:79], v[52:55], v[4:19]
    s_barrier
    s_mov_b32 s61, 0
g2_loop:
    s_cmp_eq_u32 s61, s43
    s_cbranch_scc1 g2_loop_mid
g2_loop_back:
    v_mfma_f32_32x32x16_bf16 v[20:35], v[76:79], v[56:59], v[20:35]
    ds_read_b64_tr_b16 v[68:69], v86 offset:24576
    ds_read_b64_tr_b16 v[70:71], v86 offset:25600
    s_add_u32 m0, s57, 0
    s_nop 0
    buffer_load_dwordx4 v89, s[44:47], s62 offen offset:0 lds
    v_mfma_f32_32x32x16_bf16 v[4:19], v[80:83], v[60:63], v[4:19]
    ds_read_b128 v[36:39], v84 offset:24576
    ds_read_b128 v[40:43], v84 offset:28672
    buffer_load_dwordx4 v89, s[44:47], s62 offen offset:1024 lds
    v_mfma_f32_32x32x16_bf16 v[20:35], v[80:83], v[64:67], v[20:35]
    ds_read_b64_tr_b16 v[72:73], v86 offset:26624
    ds_read_b64_tr_b16 v[74:75], v86 offset:27648
    ds_read_b128 v[44:47], v84 offset:25600
    ds_read_b128 v[48:51], v84 offset:29696
    buffer_load_dwordx4 v89, s[44:47], s62 offen offset:2048 lds
    s_waitcnt lgkmcnt(5)
    v_mfma_f32_32x32x16_bf16 v[4:19], v[68:71], v[36:39], v[4:19]
    ds_read_b64_tr_b16 v[76:77], v86 offset:28672
    ds_read_b64_tr_b16 v[78:79], v86 offset:29696
    buffer_load_dwordx4 v89, s[44:47], s62 offen offset:3072 lds
    s_add_u32 s62, s62, 4096
    s_waitcnt lgkmcnt(6)
    v_mfma_f32_32x32x16_bf16 v[20:35], v[68:71], v[40:43], v[20:35]
    ds_read_b128 v[52:55], v84 offset:26624
    ds_read_b128 v[56:59], v84 offset:30720
    s_waitcnt lgkmcnt(5)
    v_mfma_f32_32x32x16_bf16 v[4:19], v[72:75], v[44:47], v[4:19]
    ds_read_b64_tr_b16 v[80:81], v86 offset:30720
    ds_read_b64_tr_b16 v[82:83], v86 offset:31744
    s_add_u32 m0, s60, 0
    s_nop 0
    buffer_load_dwordx4 v90, s[48:51], s55 offen offset:0 lds
    s_waitcnt lgkmcnt(6)
    v_mfma_f32_32x32x16_bf16 v[20:35], v[72:75], v[48:51], v[20:35]
    ds_read_b128 v[60:63], v84 offset:27648
    ds_read_b128 v[64:67], v84 offset:31744
    buffer_load_dwordx4 v91, s[48:51], s55 offen offset:1024 lds
    s_add_u32 s55, s55, s56
    s_waitcnt vmcnt(6) lgkmcnt(0)
    v_mfma_f32_32x32x16_bf16 v[4:19], v[76:79], v[52:55], v[4:19]
    s_barrier
    v_mfma_f32_32x32x16_bf16 v[20:35], v[76:79], v[56:59], v[20:35]
    ds_read_b64_tr_b16 v[68:69], v87 offset:0
    ds_read_b64_tr_b16 v[70:71], v87 offset:1024
    s_add_u32 m0, s57, 24576
    s_nop 0
    buffer_load_dwordx4 v89, s[44:47], s62 offen offset:0 lds
    v_mfma_f32_32x32x16_bf16 v[4:19], v[80:83], v[60:63], v[4:19]
    ds_read_b128 v[36:39], v85 offset:0
    ds_read_b128 v[40:43], v85 offset:4096
    buffer_load_dwordx4 v89, s[44:47], s62 offen offset:1024 lds
    v_mfma_f32_32x32x16_bf16 v[20:35], v[80:83], v[64:67], v[20:35]
    ds_read_b64_tr_b16 v[72:73], v87 offset:2048
    ds_read_b64_tr_b16 v[74:75], v87 offset:3072
    ds_read_b128 v[44:47], v85 offset:1024
    ds_read_b128 v[48:51], v85 offset:5120
    buffer_load_dwordx4 v89, s[44:47], s62 offen offset:2048 lds
    s_waitcnt lgkmcnt(5)
    v_mfma_f32_32x32x16_bf16 v[4:19], v[68:71], v[36:39], v[4:19]
    ds_read_b64_tr_b16 v[76:77], v87 offset:4096
    ds_read_b64_tr_b16 v[78:79], v87 offset:5120
    buffer_load_dwordx4 v89, s[44:47], s62 offen offset:3072 lds
    s_add_u32 s62, s62, 4096
    s_waitcnt lgkmcnt(6)
    v_mfma_f32_32x32x16_bf16 v[20:35], v[68:71], v[40:43], v[20:35]
    ds_read_b128 v[52:55], v85 offset:2048
    ds_read_b128 v[56:59], v85 offset:6144
    s_waitcnt lgkmcnt(5)
    v_mfma_f32_32x32x16_bf16 v[4:19], v[72:75], v[44:47], v[4:19]
    ds_read_b64_tr_b16 v[80:81], v87 offset:6144
    ds_read_b64_tr_b16 v[82:83], v87 offset:7168
    s_add_u32 m0, s60, 24576
    s_nop 0
    buffer_load_dwordx4 v90, s[48:51], s55 offen offset:0 lds
    s_waitcnt lgkmcnt(6)
    v_mfma_f32_32x32x16_bf16 v[20:35], v[72:75], v[48:51], v[20:35]
    ds_read_b128 v[60:63], v85 offset:3072
    ds_read_b128 v[64:67], v85 offset:7168
    buffer_load_dwordx4 v91, s[48:51], s55 offen offset:1024 lds
    s_add_u32 s55, s55, s56
    s_waitcnt vmcnt(6) lgkmcnt(0)
    v_mfma_f32_32x32x16_bf16 v[4:19], v[76:79], v[52:55], v[4:19]
    s_barrier
    v_mfma_f32_32x32x16_bf16 v[20:35], v[76:79], v[56:59], v[20:35]
    ds_read_b64_tr_b16 v[68:69], v86 offset:0
    ds_read_b64_tr_b16 v[70:71], v86 offset:1024
    s_add_u32 m0, s57, 49152
    s_nop 0
    buffer_load_dwordx4 v89, s[44:47], s62 offen offset:0 lds
    v_mfma_f32_32x32x16_bf16 v[4:19], v[80:83], v[60:63], v[4:19]
    ds_read_b128 v[36:39], v84 offset:0
    ds_read_b128 v[40:43], v84 offset:4096
    buffer_load_dwordx4 v89, s[44:47], s62 offen offset:1024 lds
    v_mfma_f32_32x32x16_bf16 v[20:35], v[80:83], v[64:67], v[20:35]
    ds_read_b64_tr_b16 v[72:73], v86 offset:2048
    ds_read_b64_tr_b16 v[74:75], v86 offset:3072
    ds_read_b128 v[44:47], v84 offset:1024
    ds_read_b128 v[48:51], v84 offset:5120
    buffer_load_dwordx4 v89, s[44:47], s62 offen offset:2048 lds
    s_waitcnt lgkmcnt(5)
    v_mfma_f32_32x32x16_bf16 v[4:19], v[68:71], v[36:39], v[4:19]
    ds_read_b64_tr_b16 v[76:77], v86 offset:4096
    ds_read_b64_tr_b16 v[78:79], v86 offset:5120
    buffer_load_dwordx4 v89, s[44:47], s62 offen offset:3072 lds
    s_add_u32 s62, s62, 4096
    s_waitcnt lgkmcnt(6)
    v_mfma_f32_32x32x16_bf16 v[20:35], v[68:71], v[40:43], v[20:35]
    ds_read_b128 v[52:55], v84 offset:2048
    ds_read_b128 v[56:59], v84 offset:6144
    s_waitcnt lgkmcnt(5)
    v_mfma_f32_32x32x16_bf16 v[4:19], v[72:75], v[44:47], v[4:19]
    ds_read_b64_tr_b16 v[80:81], v86 offset:6144
    ds_read_b64_tr_b16 v[82:83], v86 offset:7168
    s_add_u32 m0, s60, 49152
    s_nop 0
    buffer_load_dwordx4 v90, s[48:51], s55 offen offset:0 lds
    s_waitcnt lgkmcnt(6)
    v_mfma_f32_32x32x16_bf16 v[20:35], v[72:75], v[48:51], v[20:35]
    ds_read_b128 v[60:63], v84 offset:3072
    ds_read_b128 v[64:67], v84 offset:7168
    buffer_load_dwordx4 v91, s[48:51], s55 offen offset:1024 lds
    s_add_u32 s55, s55, s56
    s_add_u32 s61, s61, 1
    s_cmp_lg_u32 s61, 4
    s_waitcnt vmcnt(6) lgkmcnt(0)
    v_mfma_f32_32x32x16_bf16 v[4:19], v[76:79], v[52:55], v[4:19]
    s_barrier
    s_cbranch_scc1 g2_loop
    v_mfma_f32_32x32x16_bf16 v[20:35], v[76:79], v[56:59], v[20:35]
    ds_read_b64_tr_b16 v[68:69], v86 offset:24576
    ds_read_b64_tr_b16 v[70:71], v86 offset:25600
    s_add_u32 m0, s57, 0
    s_nop 0
    buffer_load_dwordx4 v89, s[44:47], s62 offen offset:0 lds
    v_mfma_f32_32x32x16_bf16 v[4:19], v[80:83], v[60:63], v[4:19]
    ds_read_b128 v[36:39], v84 offset:24576
    ds_read_b128 v[40:43], v84 offset:28672
    buffer_load_dwordx4 v89, s[44:47], s62 offen offset:1024 lds
    v_mfma_f32_32x32x16_bf16 v[20:35], v[80:83], v[64:67], v[20:35]
    ds_read_b64_tr_b16 v[72:73], v86 offset:26624
    ds_read_b64_tr_b16 v[74:75], v86 offset:27648
    ds_read_b128 v[44:47], v84 offset:25600
    ds_read_b128 v[48:51], v84 offset:29696
    buffer_load_dwordx4 v89, s[44:47], s62 offen offset:2048 lds
    s_waitcnt lgkmcnt(5)
    v_mfma_f32_32x32x16_bf16 v[4:19], v[68:71], v[36:39], v[4:19]
    ds_read_b64_tr_b16 v[76:77], v86 offset:28672
    ds_read_b64_tr_b16 v[78:79], v86 offset:29696
    buffer_load_dwordx4 v89, s[44:47], s62 offen offset:3072 lds
    s_add_u32 s62, s62, 4096
    s_waitcnt lgkmcnt(6)
    v_mfma_f32_32x32x16_bf16 v[20:35], v[68:71], v[40:43], v[20:35]
    ds_read_b128 v[52:55], v84 offset:26624
    ds_read_b128 v[56:59], v84 offset:30720
    s_waitcnt lgkmcnt(5)
    v_mfma_f32_32x32x16_bf16 v[4:19], v[72:75], v[44:47], v[4:19]
    ds_read_b64_tr_b16 v[80:81], v86 offset:30720
    ds_read_b64_tr_b16 v[82:83], v86 offset:31744
    s_add_u32 m0, s60, 0
    s_nop 0
    buffer_load_dwordx4 v90, s[48:51], s55 offen offset:0 lds
    s_waitcnt lgkmcnt(6)
    v_mfma_f32_32x32x16_bf16 v[20:35], v[72:75], v[48:51], v[20:35]
    ds_read_b128 v[60:63], v84 offset:27648
    ds_read_b128 v[64:67], v84 offset:31744
    buffer_load_dwordx4 v91, s[48:51], s55 offen offset:1024 lds
    s_add_u32 s55, s55, s56
    s_waitcnt vmcnt(6) lgkmcnt(0)
    v_mfma_f32_32x32x16_bf16 v[4:19], v[76:79], v[52:55], v[4:19]
    s_barrier
    v_mfma_f32_32x32x16_bf16 v[20:35], v[76:79], v[56:59], v[20:35]
    ds_read_b64_tr_b16 v[68:69], v87 offset:0
    ds_read_b64_tr_b16 v[70:71], v87 offset:1024
    v_mfma_f32_32x32x16_bf16 v[4:19], v[80:83], v[60:63], v[4:19]
    ds_read_b128 v[36:39], v85 offset:0
    ds_read_b128 v[40:43], v85 offset:4096
    v_mfma_f32_32x32x16_bf16 v[20:35], v[80:83], v[64:67], v[20:35]
    ds_read_b64_tr_b16 v[72:73], v87 offset:2048
    ds_read_b64_tr_b16 v[74:75], v87 offset:3072
    ds_read_b128 v[44:47], v85 offset:1024
    ds_read_b128 v[48:51], v85 offset:5120
    s_waitcnt lgkmcnt(5)
    v_mfma_f32_32x32x16_bf16 v[4:19], v[68:71], v[36:39], v[4:19]
    ds_read_b64_tr_b16 v[76:77], v87 offset:4096
    ds_read_b64_tr_b16 v[78:79], v87 offset:5120
    s_waitcnt lgkmcnt(6)
    v_mfma_f32_32x32x16_bf16 v[20:35], v[68:71], v[40:43], v[20:35]
    ds_read_b128 v[52:55], v85 offset:2048
    ds_read_b128 v[56:59], v85 offset:6144
    s_waitcnt lgkmcnt(5)
    v_mfma_f32_32x32x16_bf16 v[4:19], v[72:75], v[44:47], v[4:19]
    ds_read_b64_tr_b16 v[80:81], v87 offset:6144
    ds_read_b64_tr_b16 v[82:83], v87 offset:7168
    s_waitcnt lgkmcnt(6)
    v_mfma_f32_32x32x16_bf16 v[20:35], v[72:75], v[48:51], v[20:35]
    ds_read_b128 v[60:63], v85 offset:3072
    ds_read_b128 v[64:67], v85 offset:7168
    s_waitcnt vmcnt(0) lgkmcnt(0)
    v_mfma_f32_32x32x16_bf16 v[4:19], v[76:79], v[52:55], v[4:19]
    s_barrier
    v_mfma_f32_32x32x16_bf16 v[20:35], v[76:79], v[56:59], v[20:35]
    ds_read_b64_tr_b16 v[68:69], v86 offset:0
    ds_read_b64_tr_b16 v[70:71], v86 offset:1024
    v_mfma_f32_32x32x16_bf16 v[4:19], v[80:83], v[60:63], v[4:19]
    ds_read_b128 v[36:39], v84 offset:0
    ds_read_b128 v[40:43], v84 offset:4096
    v_mfma_f32_32x32x16_bf16 v[20:35], v[80:83], v[64:67], v[20:35]
    ds_read_b64_tr_b16 v[72:73], v86 offset:2048
    ds_read_b64_tr_b16 v[74:75], v86 offset:3072
    ds_read_b128 v[44:47], v84 offset:1024
    ds_read_b128 v[48:51], v84 offset:5120
    s_waitcnt lgkmcnt(5)
    v_mfma_f32_32x32x16_bf16 v[4:19], v[68:71], v[36:39], v[4:19]
    ds_read_b64_tr_b16 v[76:77], v86 offset:4096
    ds_read_b64_tr_b16 v[78:79], v86 offset:5120
    s_waitcnt lgkmcnt(6)
    v_mfma_f32_32x32x16_bf16 v[20:35], v[68:71], v[40:43], v[20:35]
    ds_read_b128 v[52:55], v84 offset:2048
    ds_read_b128 v[56:59], v84 offset:6144
    s_waitcnt lgkmcnt(5)
    v_mfma_f32_32x32x16_bf16 v[4:19], v[72:75], v[44:47], v[4:19]
    ds_read_b64_tr_b16 v[80:81], v86 offset:6144
    ds_read_b64_tr_b16 v[82:83], v86 offset:7168
    s_waitcnt lgkmcnt(6)
    v_mfma_f32_32x32x16_bf16 v[20:35], v[72:75], v[48:51], v[20:35]
    ds_read_b128 v[60:63], v84 offset:3072
    ds_read_b128 v[64:67], v84 offset:7168
    s_waitcnt lgkmcnt(5)
    v_mfma_f32_32x32x16_bf16 v[4:19], v[76:79], v[52:55], v[4:19]
    s_waitcnt lgkmcnt(4)
    v_mfma_f32_32x32x16_bf16 v[20:35], v[76:79], v[56:59], v[20:35]
    s_waitcnt lgkmcnt(1)
    v_mfma_f32_32x32x16_bf16 v[4:19], v[80:83], v[60:63], v[4:19]
    s_waitcnt lgkmcnt(0)
    v_mfma_f32_32x32x16_bf16 v[20:35], v[80:83], v[64:67], v[20:35]
    s_branch g2_loop_done
g2_loop_mid:
    buffer_load_dwordx2 v[96:97], v112, s[32:35], 0 offen offset:0
    buffer_load_dwordx2 v[98:99], v112, s[32:35], 0 offen offset:16
    buffer_load_dwordx2 v[100:101], v112, s[32:35], 0 offen offset:32
    buffer_load_dwordx2 v[102:103], v112, s[32:35], 0 offen offset:48
    buffer_load_dwordx2 v[104:105], v113, s[32:35], 0 offen offset:0
    buffer_load_dwordx2 v[106:107], v113, s[32:35], 0 offen offset:16
    buffer_load_dwordx2 v[108:109], v113, s[32:35], 0 offen offset:32
    buffer_load_dwordx2 v[110:111], v113, s[32:35], 0 offen offset:48
    s_branch g2_loop_back
g2_loop_done:
    s_nop 15
    s_lshl_b32 s63, s53, 1
    s_lshr_b32 s64, s59, 5
    s_add_u32 s63, s63, s64
    s_lshl_b32 s63, s63, 6
    s_lshr_b32 s64, s58, 4
    s_add_u32 s63, s63, s64
    s_lshl_b32 s64, s54, 1
    s_add_u32 s63, s63, s64
    s_lshl_b32 s42, s63, 10
    s_add_u32 s42, s42, 16777216
    s_waitcnt vmcnt(0)
    v_mov_b32 v52, 0
    v_mov_b32 v53, 0
    v_lshlrev_b32 v92, 16, v96
    v_and_b32 v93, 0xffff0000, v96
    v_add_f32 v92, v92, v4
    v_add_f32 v93, v93, v5
    v_cvt_pk_bf16_f32 v36, v92, v93
    v_lshlrev_b32 v92, 16, v36
    v_and_b32 v93, 0xffff0000, v36
    v_add_f32 v52, v52, v92
    v_fmac_f32 v53, v92, v92
    v_add_f32 v52, v52, v93
    v_fmac_f32 v53, v93, v93
    v_lshlrev_b32 v92, 16, v97
    v_and_b32 v93, 0xffff0000, v97
    v_add_f32 v92, v92, v6
    v_add_f32 v93, v93, v7
    v_cvt_pk_bf16_f32 v37, v92, v93
    v_lshlrev_b32 v92, 16, v37
    v_and_b32 v93, 0xffff0000, v37
    v_add_f32 v52, v52, v92
    v_fmac_f32 v53, v92, v92
    v_add_f32 v52, v52, v93
    v_fmac_f32 v53, v93, v93
    v_lshlrev_b32 v92, 16, v98
    v_and_b32 v93, 0xffff0000, v98
    v_add_f32 v92, v92, v8
    v_add_f32 v93, v93, v9
    v_cvt_pk_bf16_f32 v38, v92, v93
    v_lshlrev_b32 v92, 16, v38
    v_and_b32 v93, 0xffff0000, v38
    v_add_f32 v52, v52, v92
    v_fmac_f32 v53, v92, v92
    v_add_f32 v52, v52, v93
    v_fmac_f32 v53, v93, v93
    v_lshlrev_b32 v92, 16, v99
    v_and_b32 v93, 0xffff0000, v99
    v_add_f32 v92, v92, v10
    v_add_f32 v93, v93, v11
    v_cvt_pk_bf16_f32 v39, v92, v93
    v_lshlrev_b32 v92, 16, v39
    v_and_b32 v93, 0xffff0000, v39
    v_add_f32 v52, v52, v92
    v_fmac_f32 v53, v92, v92
    v_add_f32 v52, v52, v93
    v_fmac_f32 v53, v93, v93
    v_lshlrev_b32 v92, 16, v100
    v_and_b32 v93, 0xffff0000, v100
    v_add_f32 v92, v92, v12
    v_add_f32 v93, v93, v13
    v_cvt_pk_bf16_f32 v40, v92, v93
    v_lshlrev_b32 v92, 16, v40
    v_and_b32 v93, 0xffff0000, v40
    v_add_f32 v52, v52, v92
    v_fmac_f32 v53, v92, v92
    v_add_f32 v52, v52, v93
    v_fmac_f32 v53, v93, v93
    v_lshlrev_b32 v92, 16, v101
    v_and_b32 v93, 0xffff0000, v101
    v_add_f32 v92, v92, v14
    v_add_f32 v93, v93, v15
    v_cvt_pk_bf16_f32 v41, v92, v93
    v_lshlrev_b32 v92, 16, v41
    v_and_b32 v93, 0xffff0000, v41
    v_add_f32 v52, v52, v92
    v_fmac_f32 v53, v92, v92
    v_add_f32 v52, v52, v93
    v_fmac_f32 v53, v93, v93
    v_lshlrev_b32 v92, 16, v102
    v_and_b32 v93, 0xffff0000, v102
    v_add_f32 v92, v92, v16
    v_add_f32 v93, v93, v17
    v_cvt_pk_bf16_f32 v42, v92, v93
    v_lshlrev_b32 v92, 16, v42
    v_and_b32 v93, 0xffff0000, v42
    v_add_f32 v52, v52, v92
    v_fmac_f32 v53, v92, v92
    v_add_f32 v52, v52, v93
    v_fmac_f32 v53, v93, v93
    v_lshlrev_b32 v92, 16, v103
    v_and_b32 v93, 0xffff0000, v103
    v_add_f32 v92, v92, v18
    v_add_f32 v93, v93, v19
    v_cvt_pk_bf16_f32 v43, v92, v93
    v_lshlrev_b32 v92, 16, v43
    v_and_b32 v93, 0xffff0000, v43
    v_add_f32 v52, v52, v92
    v_fmac_f32 v53, v92, v92
    v_add_f32 v52, v52, v93
    v_fmac_f32 v53, v93, v93
    s_add_u32 s63, s42, 0
    buffer_store_dwordx4 v[36:39], v89, s[8:11], s63 offen sc1
    buffer_store_dwordx4 v[40:43], v89, s[8:11], s63 offen offset:1024 sc1
    v_mov_b32 v54, 0
    v_mov_b32 v55, 0
    v_lshlrev_b32 v92, 16, v104
    v_and_b32 v93, 0xffff0000, v104
    v_add_f32 v92, v92, v20
    v_add_f32 v93, v93, v21
    v_cvt_pk_bf16_f32 v44, v92, v93
    v_lshlrev_b32 v92, 16, v44
    v_and_b32 v93, 0xffff0000, v44
    v_add_f32 v54, v54, v92
    v_fmac_f32 v55, v92, v92
    v_add_f32 v54, v54, v93
    v_fmac_f32 v55, v93, v93
    v_lshlrev_b32 v92, 16, v105
    v_and_b32 v93, 0xffff0000, v105
    v_add_f32 v92, v92, v22
    v_add_f32 v93, v93, v23
    v_cvt_pk_bf16_f32 v45, v92, v93
    v_lshlrev_b32 v92, 16, v45
    v_and_b32 v93, 0xffff0000, v45
    v_add_f32 v54, v54, v92
    v_fmac_f32 v55, v92, v92
    v_add_f32 v54, v54, v93
    v_fmac_f32 v55, v93, v93
    v_lshlrev_b32 v92, 16, v106
    v_and_b32 v93, 0xffff0000, v106
    v_add_f32 v92, v92, v24
    v_add_f32 v93, v93, v25
    v_cvt_pk_bf16_f32 v46, v92, v93
    v_lshlrev_b32 v92, 16, v46
    v_and_b32 v93, 0xffff0000, v46
    v_add_f32 v54, v54, v92
    v_fmac_f32 v55, v92, v92
    v_add_f32 v54, v54, v93
    v_fmac_f32 v55, v93, v93
    v_lshlrev_b32 v92, 16, v107
    v_and_b32 v93, 0xffff0000, v107
    v_add_f32 v92, v92, v26
    v_add_f32 v93, v93, v27
    v_cvt_pk_bf16_f32 v47, v92, v93
    v_lshlrev_b32 v92, 16, v47
    v_and_b32 v93, 0xffff0000, v47
    v_add_f32 v54, v54, v92
    v_fmac_f32 v55, v92, v92
    v_add_f32 v54, v54, v93
    v_fmac_f32 v55, v93, v93
    v_lshlrev_b32 v92, 16, v108
    v_and_b32 v93, 0xffff0000, v108
    v_add_f32 v92, v92, v28
    v_add_f32 v93, v93, v29
    v_cvt_pk_bf16_f32 v48, v92, v93
    v_lshlrev_b32 v92, 16, v48
    v_and_b32 v93, 0xffff0000, v48
    v_add_f32 v54, v54, v92
    v_fmac_f32 v55, v92, v92
    v_add_f32 v54, v54, v93
    v_fmac_f32 v55, v93, v93
    v_lshlrev_b32 v92, 16, v109
    v_and_b32 v93, 0xffff0000, v109
    v_add_f32 v92, v92, v30
    v_add_f32 v93, v93, v31
    v_cvt_pk_bf16_f32 v49, v92, v93
    v_lshlrev_b32 v92, 16, v49
    v_and_b32 v93, 0xffff0000, v49
    v_add_f32 v54, v54, v92
    v_fmac_f32 v55, v92, v92
    v_add_f32 v54, v54, v93
    v_fmac_f32 v55, v93, v93
    v_lshlrev_b32 v92, 16, v110
    v_and_b32 v93, 0xffff0000, v110
    v_add_f32 v92, v92, v32
    v_add_f32 v93, v93, v33
    v_cvt_pk_bf16_f32 v50, v92, v93
    v_lshlrev_b32 v92, 16, v50
    v_and_b32 v93, 0xffff0000, v50
    v_add_f32 v54, v54, v92
    v_fmac_f32 v55, v92, v92
    v_add_f32 v54, v54, v93
    v_fmac_f32 v55, v93, v93
    v_lshlrev_b32 v92, 16, v111
    v_and_b32 v93, 0xffff0000, v111
    v_add_f32 v92, v92, v34
    v_add_f32 v93, v93, v35
    v_cvt_pk_bf16_f32 v51, v92, v93
    v_lshlrev_b32 v92, 16, v51
    v_and_b32 v93, 0xffff0000, v51
    v_add_f32 v54, v54, v92
    v_fmac_f32 v55, v92, v92
    v_add_f32 v54, v54, v93
    v_fmac_f32 v55, v93, v93
    s_add_u32 s63, s42, 65536
    buffer_store_dwordx4 v[44:47], v89, s[8:11], s63 offen sc1
    buffer_store_dwordx4 v[48:51], v89, s[8:11], s63 offen offset:1024 sc1
    v_mov_b32 v92, v52
    s_nop 1
    v_permlane32_swap_b32 v52, v92
    s_nop 1
    v_add_f32 v52, v52, v92
    v_mov_b32 v92, v53
    s_nop 1
    v_permlane32_swap_b32 v53, v92
    s_nop 1
    v_add_f32 v53, v53, v92
    v_mov_b32 v92, v54
    s_nop 1
    v_permlane32_swap_b32 v54, v92
    s_nop 1
    v_add_f32 v54, v54, v92
    v_mov_b32 v92, v55
    s_nop 1
    v_permlane32_swap_b32 v55, v92
    s_nop 1
    v_add_f32 v55, v55, v92
    v_and_b32 v92, 31, v88
    s_lshl_b32 s63, s53, 9
    s_add_u32 s63, s63, 73728
    v_lshl_add_u32 v93, v92, 3, s63
    s_lshl_b32 s64, s54, 10
    v_add_u32 v94, s64, v93
    ds_write_b64 v94, v[52:53] offset:0
    ds_write_b64 v94, v[54:55] offset:256
    s_waitcnt lgkmcnt(0)
    s_barrier
    ds_read_b64 v[60:61], v93 offset:0
    ds_read_b64 v[52:53], v93 offset:1024
    ds_read_b64 v[62:63], v93 offset:256
    ds_read_b64 v[54:55], v93 offset:1280
    s_lshl_b32 s63, s53, 6
    s_add_u32 s63, s63, s59
    s_lshl_b32 s63, s63, 3
    s_lshl_b32 s64, s40, 14
    s_add_u32 s63, s63, s64
    s_add_u32 s63, s63, 40894464
    v_lshlrev_b32 v92, 3, v88
    v_cmp_gt_u32 vcc, 32, v88
    s_waitcnt lgkmcnt(0)
    v_add_f32 v60, v60, v52
    v_add_f32 v61, v61, v53
    v_add_f32 v62, v62, v54
    v_add_f32 v63, v63, v55
    v_cndmask_b32 v60, v62, v60, vcc
    v_cndmask_b32 v61, v63, v61, vcc
    s_cmp_lg_u32 s54, 0
    s_cbranch_scc1 k2_st_done
    buffer_store_dwordx2 v[60:61], v92, s[8:11], s63 offen sc1
k2_st_done:
    s_lshr_b32 s42, s59, 7
    s_lshl_b32 s42, s42, 7
    s_add_u32 s42, s42, 41783296
    s_waitcnt vmcnt(0)
    s_barrier
    s_cmp_lg_u32 s30, 0
    s_cbranch_scc1 k2_ns4
    s_mov_b64 exec, 1
    v_mov_b32 v93, 0
    v_mov_b32 v94, 1
    buffer_atomic_add v94, v93, s[8:11], s42 offen sc1
    s_mov_b64 exec, -1
k2_ns4:
    s_lshr_b32 s38, s2, 4
    s_lshl_b32 s38, s38, 2
    s_add_u32 s38, s38, s30
    s_lshl_b32 s38, s38, 10
    s_cmp_ge_u32 s38, code_end-k2_g3
    s_cbranch_scc1 cpf_g2c_end
    s_getpc_b64 s[36:37]
cpf_g2c:
    s_add_u32 s38, s38, k2_g3-cpf_g2c+0x10000
    s_sub_u32 s36, s36, 0x10000
    s_subb_u32 s37, s37, 0
    v_lshl_add_u32 v96, v88, 4, s38
    v_mov_b32 v97, s37
    v_add_co_u32 v96, vcc, s36, v96
    s_nop 1
    v_addc_co_u32 v97, vcc, 0, v97, vcc
    global_load_dwordx4 v[100:103], v[96:97], off
cpf_g2c_end:
    s_waitcnt vmcnt(0)
    s_cmp_lt_u32 s29, 32
    s_cbranch_scc1 k2_g3
    s_setprio 0
    s_sub_u32 s63, s29, 28
    s_lshl_b32 s63, s63, 3
    s_add_u32 s63, s63, s28
    s_lshl_b32 s63, s63, 2
    s_add_u32 s63, s63, s30
    s_mov_b32 s36, s20
    s_and_b32 s37, s21, 0xffff
    s_mov_b32 s38, 7340032
    s_mov_b32 s39, 0x00020000
    s_mul_i32 s64, s63, 57344
    s_add_u32 s65, s64, 57344
k2_pf4a:
    buffer_load_dwordx4 v[156:159], v89, s[36:39], s64 offen offset:0
    buffer_load_dwordx4 v[156:159], v89, s[36:39], s64 offen offset:1024
    buffer_load_dwordx4 v[156:159], v89, s[36:39], s64 offen offset:2048
    buffer_load_dwordx4 v[156:159], v89, s[36:39], s64 offen offset:3072
    s_add_u32 s64, s64, 4096
    s_waitcnt vmcnt(4)
    s_cmp_lt_u32 s64, s65
    s_cbranch_scc1 k2_pf4a
    s_mov_b32 s36, s14
    s_and_b32 s37, s15, 0xffff
    s_mov_b32 s38, 2097152
    s_mov_b32 s39, 0x00020000
    s_mul_i32 s64, s63, 16384
    s_add_u32 s65, s64, 16384
k2_pf4b:
    buffer_load_dwordx4 v[156:159], v89, s[36:39], s64 offen offset:0
    buffer_load_dwordx4 v[156:159], v89, s[36:39], s64 offen offset:1024
    buffer_load_dwordx4 v[156:159], v89, s[36:39], s64 offen offset:2048
    buffer_load_dwordx4 v[156:159], v89, s[36:39], s64 offen offset:3072
    s_add_u32 s64, s64, 4096
    s_waitcnt vmcnt(4)
    s_cmp_lt_u32 s64, s65
    s_cbranch_scc1 k2_pf4b
    s_waitcnt vmcnt(0)
    s_branch k2_g4
k2_g3:
    s_mov_b32 s52, s30
    s_and_b32 s65, s28, 1
    s_lshl_b32 s65, s65, 3
    s_and_b32 s63, s29, 7
    s_add_u32 s65, s65, s63
    s_lshl_b32 s59, s65, 7
    s_lshr_b32 s63, s28, 1
    s_lshl_b32 s63, s63, 2
    s_lshr_b32 s64, s29, 3
    s_add_u32 s40, s63, s64
    s_mul_i32 s58, s40, 224
    s_mov_b32 s57, 3584
    s_mov_b32 s60, 16777216
    v_and_b32 v232, 63, v0
    s_lshr_b32 s53, s52, 1
    s_and_b32 s54, s52, 1
    v_bfe_u32 v238, v232, 2, 2
    v_lshrrev_b32 v239, 4, v232
    v_and_b32 v240, 3, v232
    s_mul_i32 s63, s52, 16
    v_add_u32 v238, s63, v238
    v_lshlrev_b32 v239, 5, v239
    v_lshl_add_u32 v239, v240, 3, v239
    v_add_u32 v239, s58, v239
    v_mul_lo_u32 v238, v238, s57
    v_add_lshl_u32 v234, v238, v239, 1
    s_mul_i32 s63, s57, 8
    s_sub_u32 s63, s63, 1024
    v_add_u32 v235, s63, v234
    v_add_u32 v236, s63, v235
    v_add_u32 v237, s63, v236
    s_mov_b32 s55, 0
    s_mul_i32 s56, s57, 64
    v_lshlrev_b32 v233, 4, v232
    s_mul_i32 s63, s52, 1
    s_lshr_b32 s64, s59, 5
    s_add_u32 s63, s63, s64
    s_add_u32 s63, s63, 0
    s_mul_i32 s63, s63, 65536
    s_add_u32 s62, s63, s60
    s_mul_i32 s63, s53, 4096
    v_add_u32 v228, s63, v233
    v_lshrrev_b32 v238, 5, v232
    v_mul_u32_u24 v238, 2048, v238
    v_bfe_u32 v239, v232, 2, 2
    v_lshl_add_u32 v238, v239, 6, v238
    v_bfe_u32 v239, v232, 4, 1
    v_lshl_add_u32 v238, v239, 5, v238
    v_and_b32 v239, 3, v232
    v_lshl_add_u32 v238, v239, 3, v238
    s_mul_i32 s63, s54, 1024
    s_add_u32 s63, s63, 8192
    v_add_u32 v230, s63, v238
    v_add_u32 v229, 49152, v228
    v_add_u32 v231, 49152, v230
    s_mul_i32 s57, s52, 2048
    s_mul_i32 s60, s52, 4096
    s_add_u32 s60, s60, 8192
    s_mul_i32 s63, s52, 57344
    v_subrev_u32 v234, s63, v234
    v_add_u32 v235, 3328, v234
    v_add_u32 v236, 30720, v234
    v_add_u32 v237, 29952, v234
    v_add_u32 v234, 4096, v234
    v_xor_b32 v236, 32, v236
    v_xor_b32 v237, 32, v237
    v_cmp_gt_u32 vcc, 48, v232
    v_mov_b32 v238, 0x7f000000
    s_nop 0
    v_cndmask_b32 v235, v238, v235, vcc
    v_cndmask_b32 v237, v238, v237, vcc
    v_and_b32 v238, 15, v232
    v_lshlrev_b32 v238, 4, v238
    v_lshrrev_b32 v239, 4, v232
    v_lshl_add_u32 v238, v239, 9, v238
    s_mul_i32 s63, s53, 4096
    v_add_u32 v228, s63, v238
    v_add_u32 v229, 49152, v228
    v_lshrrev_b32 v240, 1, v239
    v_and_b32 v241, 1, v239
    v_lshl_add_u32 v240, v240, 2, v241
    v_lshlrev_b32 v240, 11, v240
    v_bfe_u32 v241, v232, 2, 2
    v_lshl_add_u32 v240, v241, 6, v240
    v_and_b32 v241, 3, v232
    v_lshl_add_u32 v240, v241, 3, v240
    v_and_b32 v241, 1, v239
    v_lshl_add_u32 v240, v241, 5, v240
    s_mul_i32 s63, s54, 1024
    s_add_u32 s63, s63, 8192
    v_add_u32 v230, s63, v240
    v_xor_b32 v242, 32, v230
    v_add_u32 v231, 49152, v230
    v_add_u32 v243, 49152, v242
    s_lshl_b32 s63, s54, 5
    v_xor_b32 v240, s63, v240
    v_add_u32 v244, 8192, v240
    v_add_u32 v245, 49152, v244
    s_mov_b32 s44, s26
    s_and_b32 s45, s27, 0xffff
    s_mov_b32 s46, 65011712
    s_mov_b32 s47, 0x00020000
    s_mov_b32 s48, s18
    s_and_b32 s49, s19, 0xffff
    s_mov_b32 s50, 7344128
    s_mov_b32 s51, 0x00020000
    s_sub_u32 s48, s48, 4096
    s_subb_u32 s49, s49, 0
    s_add_u32 m0, s60, 0
    s_nop 0
    buffer_load_dwordx4 v234, s[48:51], s55 offen offset:0 lds
    buffer_load_dwordx4 v235, s[48:51], s55 offen offset:1024 lds
    buffer_load_dwordx4 v236, s[48:51], s55 offen offset:2048 lds
    buffer_load_dwordx4 v237, s[48:51], s55 offen offset:3072 lds
    s_add_u32 s55, s55, s56
    s_add_u32 m0, s60, 24576
    s_nop 0
    buffer_load_dwordx4 v234, s[48:51], s55 offen offset:0 lds
    buffer_load_dwordx4 v235, s[48:51], s55 offen offset:1024 lds
    buffer_load_dwordx4 v236, s[48:51], s55 offen offset:2048 lds
    buffer_load_dwordx4 v237, s[48:51], s55 offen offset:3072 lds
    s_add_u32 s55, s55, s56
    s_lshr_b32 s63, s59, 7
    s_lshl_b32 s63, s63, 7
    s_add_u32 s63, s63, 41783296
    s_cmp_lg_u32 s30, 0
    s_cbranch_scc1 k2_pw5
    v_mov_b32 v239, 0
    s_mov_b32 s65, 0
k2_pl6:
    buffer_load_dword v240, v239, s[8:11], s63 offen sc1
    s_waitcnt vmcnt(0)
    v_readfirstlane_b32 s64, v240
    s_nop 3
    s_cmp_ge_u32 s64, 16
    s_cbranch_scc1 k2_pk6
    s_add_u32 s65, s65, 1
    s_sleep 8
    s_cmp_lt_u32 s65, 0x40000
    s_cbranch_scc1 k2_pl6
k2_pk6:
k2_pw5:
    s_barrier
    s_add_u32 m0, s57, 0
    s_nop 0
    buffer_load_dwordx4 v233, s[44:47], s62 offen offset:0 sc1 lds
    buffer_load_dwordx4 v233, s[44:47], s62 offen offset:1024 sc1 lds
    s_add_u32 s62, s62, 2048
    s_add_u32 m0, s57, 24576
    s_nop 0
    buffer_load_dwordx4 v233, s[44:47], s62 offen offset:0 sc1 lds
    buffer_load_dwordx4 v233, s[44:47], s62 offen offset:1024 sc1 lds
    s_add_u32 s62, s62, 2048
    s_setprio 2
    s_waitcnt vmcnt(2)
    s_barrier
    ds_read_b64_tr_b16 v[164:165], v230 offset:0
    ds_read_b64_tr_b16 v[166:167], v230 offset:4096
    ds_read_b128 v[132:135], v228 offset:0
    ds_read_b64_tr_b16 v[168:169], v242 offset:0
    ds_read_b64_tr_b16 v[170:171], v242 offset:4096
    ds_read_b128 v[136:139], v228 offset:256
    ds_read_b64_tr_b16 v[172:173], v230 offset:256
    ds_read_b64_tr_b16 v[174:175], v230 offset:4352
    ds_read_b64_tr_b16 v[176:177], v242 offset:256
    ds_read_b64_tr_b16 v[178:179], v242 offset:4352
    ds_read_b64_tr_b16 v[180:181], v230 offset:512
    ds_read_b64_tr_b16 v[182:183], v230 offset:4608
    ds_read_b64_tr_b16 v[184:185], v242 offset:512
    ds_read_b64_tr_b16 v[186:187], v242 offset:4608
    ds_read_b64_tr_b16 v[188:189], v244 offset:768
    ds_read_b64_tr_b16 v[190:191], v244 offset:4864
    ds_read_b128 v[140:143], v228 offset:2048
    ds_read_b128 v[144:147], v228 offset:2304
    s_add_u32 m0, s57, 49152
    s_nop 0
    buffer_load_dwordx4 v233, s[44:47], s62 offen offset:0 sc1 lds
    buffer_load_dwordx4 v233, s[44:47], s62 offen offset:1024 sc1 lds
    s_add_u32 s62, s62, 2048
    s_add_u32 m0, s60, 49152
    s_nop 0
    buffer_load_dwordx4 v234, s[48:51], s55 offen offset:0 lds
    buffer_load_dwordx4 v235, s[48:51], s55 offen offset:1024 lds
    buffer_load_dwordx4 v236, s[48:51], s55 offen offset:2048 lds
    buffer_load_dwordx4 v237, s[48:51], s55 offen offset:3072 lds
    s_add_u32 s55, s55, s56
    s_waitcnt lgkmcnt(15)
    v_mfma_f32_16x16x32_bf16 v[4:7], v[164:167], v[132:135], 0
    s_waitcnt vmcnt(6) lgkmcnt(0)
    v_mfma_f32_16x16x32_bf16 v[8:11], v[168:171], v[132:135], 0
    s_barrier
    v_mfma_f32_16x16x32_bf16 v[36:39], v[164:167], v[136:139], 0
    ds_read_b64_tr_b16 v[196:197], v230 offset:24576
    s_add_u32 m0, s57, 0
    v_mfma_f32_16x16x32_bf16 v[40:43], v[168:171], v[136:139], 0
    ds_read_b64_tr_b16 v[198:199], v230 offset:28672
    buffer_load_dwordx4 v233, s[44:47], s62 offen offset:0 sc1 lds
    v_mfma_f32_16x16x32_bf16 v[12:15], v[172:175], v[132:135], 0
    ds_read_b128 v[148:151], v228 offset:24576
    v_mfma_f32_16x16x32_bf16 v[44:47], v[172:175], v[136:139], 0
    ds_read_b64_tr_b16 v[200:201], v242 offset:24576
    v_mfma_f32_16x16x32_bf16 v[16:19], v[176:179], v[132:135], 0
    ds_read_b64_tr_b16 v[202:203], v242 offset:28672
    buffer_load_dwordx4 v233, s[44:47], s62 offen offset:1024 sc1 lds
    v_mfma_f32_16x16x32_bf16 v[48:51], v[176:179], v[136:139], 0
    ds_read_b128 v[152:155], v228 offset:24832
    s_add_u32 s62, s62, 2048
    v_mfma_f32_16x16x32_bf16 v[20:23], v[180:183], v[132:135], 0
    ds_read_b64_tr_b16 v[204:205], v230 offset:24832
    s_add_u32 m0, s60, 0
    v_mfma_f32_16x16x32_bf16 v[52:55], v[180:183], v[136:139], 0
    ds_read_b64_tr_b16 v[206:207], v230 offset:28928
    buffer_load_dwordx4 v234, s[48:51], s55 offen offset:0 lds
    v_mfma_f32_16x16x32_bf16 v[24:27], v[184:187], v[132:135], 0
    ds_read_b64_tr_b16 v[208:209], v242 offset:24832
    v_mfma_f32_16x16x32_bf16 v[56:59], v[184:187], v[136:139], 0
    ds_read_b64_tr_b16 v[210:211], v242 offset:28928
    v_mfma_f32_16x16x32_bf16 v[28:31], v[188:191], v[132:135], 0
    ds_read_b64_tr_b16 v[212:213], v230 offset:25088
    buffer_load_dwordx4 v235, s[48:51], s55 offen offset:1024 lds
    v_mfma_f32_16x16x32_bf16 v[60:63], v[188:191], v[136:139], 0
    ds_read_b64_tr_b16 v[214:215], v230 offset:29184
    v_mfma_f32_16x16x32_bf16 v[68:71], v[164:167], v[140:143], 0
    ds_read_b64_tr_b16 v[216:217], v242 offset:25088
    v_mfma_f32_16x16x32_bf16 v[72:75], v[168:171], v[140:143], 0
    ds_read_b64_tr_b16 v[218:219], v242 offset:29184
    buffer_load_dwordx4 v236, s[48:51], s55 offen offset:2048 lds
    v_mfma_f32_16x16x32_bf16 v[76:79], v[172:175], v[140:143], 0
    ds_read_b64_tr_b16 v[220:221], v244 offset:25344
    v_mfma_f32_16x16x32_bf16 v[80:83], v[176:179], v[140:143], 0
    ds_read_b64_tr_b16 v[222:223], v244 offset:29440
    v_mfma_f32_16x16x32_bf16 v[84:87], v[180:183], v[140:143], 0
    ds_read_b128 v[156:159], v228 offset:26624
    buffer_load_dwordx4 v237, s[48:51], s55 offen offset:3072 lds
    v_mfma_f32_16x16x32_bf16 v[88:91], v[184:187], v[140:143], 0
    ds_read_b128 v[160:163], v228 offset:26880
    s_add_u32 s55, s55, s56
    v_mfma_f32_16x16x32_bf16 v[92:95], v[188:191], v[140:143], 0
    v_mfma_f32_16x16x32_bf16 v[100:103], v[164:167], v[144:147], 0
    v_mfma_f32_16x16x32_bf16 v[104:107], v[168:171], v[144:147], 0
    v_mfma_f32_16x16x32_bf16 v[108:111], v[172:175], v[144:147], 0
    v_mfma_f32_16x16x32_bf16 v[112:115], v[176:179], v[144:147], 0
    v_mfma_f32_16x16x32_bf16 v[116:119], v[180:183], v[144:147], 0
    v_mfma_f32_16x16x32_bf16 v[120:123], v[184:187], v[144:147], 0
    v_mfma_f32_16x16x32_bf16 v[124:127], v[188:191], v[144:147], 0
    s_waitcnt lgkmcnt(15)
    v_mfma_f32_16x16x32_bf16 v[4:7], v[196:199], v[148:151], v[4:7]
    s_waitcnt vmcnt(6) lgkmcnt(0)
    v_mfma_f32_16x16x32_bf16 v[8:11], v[200:203], v[148:151], v[8:11]
    s_barrier
    s_mov_b32 s61, 0
g3_loop:
    v_mfma_f32_16x16x32_bf16 v[36:39], v[196:199], v[152:155], v[36:39]
    ds_read_b64_tr_b16 v[164:165], v231 offset:0
    s_add_u32 m0, s57, 24576
    v_mfma_f32_16x16x32_bf16 v[40:43], v[200:203], v[152:155], v[40:43]
    ds_read_b64_tr_b16 v[166:167], v231 offset:4096
    buffer_load_dwordx4 v233, s[44:47], s62 offen offset:0 sc1 lds
    v_mfma_f32_16x16x32_bf16 v[12:15], v[204:207], v[148:151], v[12:15]
    ds_read_b128 v[132:135], v229 offset:0
    v_mfma_f32_16x16x32_bf16 v[44:47], v[204:207], v[152:155], v[44:47]
    ds_read_b64_tr_b16 v[168:169], v243 offset:0
    v_mfma_f32_16x16x32_bf16 v[16:19], v[208:211], v[148:151], v[16:19]
    ds_read_b64_tr_b16 v[170:171], v243 offset:4096
    buffer_load_dwordx4 v233, s[44:47], s62 offen offset:1024 sc1 lds
    v_mfma_f32_16x16x32_bf16 v[48:51], v[208:211], v[152:155], v[48:51]
    ds_read_b128 v[136:139], v229 offset:256
    s_add_u32 s62, s62, 2048
    v_mfma_f32_16x16x32_bf16 v[20:23], v[212:215], v[148:151], v[20:23]
    ds_read_b64_tr_b16 v[172:173], v231 offset:256
    s_add_u32 m0, s60, 24576
    v_mfma_f32_16x16x32_bf16 v[52:55], v[212:215], v[152:155], v[52:55]
    ds_read_b64_tr_b16 v[174:175], v231 offset:4352
    buffer_load_dwordx4 v234, s[48:51], s55 offen offset:0 lds
    v_mfma_f32_16x16x32_bf16 v[24:27], v[216:219], v[148:151], v[24:27]
    ds_read_b64_tr_b16 v[176:177], v243 offset:256
    v_mfma_f32_16x16x32_bf16 v[56:59], v[216:219], v[152:155], v[56:59]
    ds_read_b64_tr_b16 v[178:179], v243 offset:4352
    v_mfma_f32_16x16x32_bf16 v[28:31], v[220:223], v[148:151], v[28:31]
    ds_read_b64_tr_b16 v[180:181], v231 offset:512
    buffer_load_dwordx4 v235, s[48:51], s55 offen offset:1024 lds
    v_mfma_f32_16x16x32_bf16 v[60:63], v[220:223], v[152:155], v[60:63]
    ds_read_b64_tr_b16 v[182:183], v231 offset:4608
    v_mfma_f32_16x16x32_bf16 v[68:71], v[196:199], v[156:159], v[68:71]
    ds_read_b64_tr_b16 v[184:185], v243 offset:512
    v_mfma_f32_16x16x32_bf16 v[72:75], v[200:203], v[156:159], v[72:75]
    ds_read_b64_tr_b16 v[186:187], v243 offset:4608
    buffer_load_dwordx4 v236, s[48:51], s55 offen offset:2048 lds
    v_mfma_f32_16x16x32_bf16 v[76:79], v[204:207], v[156:159], v[76:79]
    ds_read_b64_tr_b16 v[188:189], v245 offset:768
    v_mfma_f32_16x16x32_bf16 v[80:83], v[208:211], v[156:159], v[80:83]
    ds_read_b64_tr_b16 v[190:191], v245 offset:4864
    v_mfma_f32_16x16x32_bf16 v[84:87], v[212:215], v[156:159], v[84:87]
    ds_read_b128 v[140:143], v229 offset:2048
    buffer_load_dwordx4 v237, s[48:51], s55 offen offset:3072 lds
    v_mfma_f32_16x16x32_bf16 v[88:91], v[216:219], v[156:159], v[88:91]
    ds_read_b128 v[144:147], v229 offset:2304
    s_add_u32 s55, s55, s56
    v_mfma_f32_16x16x32_bf16 v[92:95], v[220:223], v[156:159], v[92:95]
    v_mfma_f32_16x16x32_bf16 v[100:103], v[196:199], v[160:163], v[100:103]
    v_mfma_f32_16x16x32_bf16 v[104:107], v[200:203], v[160:163], v[104:107]
    v_mfma_f32_16x16x32_bf16 v[108:111], v[204:207], v[160:163], v[108:111]
    v_mfma_f32_16x16x32_bf16 v[112:115], v[208:211], v[160:163], v[112:115]
    v_mfma_f32_16x16x32_bf16 v[116:119], v[212:215], v[160:163], v[116:119]
    v_mfma_f32_16x16x32_bf16 v[120:123], v[216:219], v[160:163], v[120:123]
    v_mfma_f32_16x16x32_bf16 v[124:127], v[220:223], v[160:163], v[124:127]
    s_waitcnt lgkmcnt(15)
    v_mfma_f32_16x16x32_bf16 v[4:7], v[164:167], v[132:135], v[4:7]
    s_waitcnt vmcnt(6) lgkmcnt(0)
    v_mfma_f32_16x16x32_bf16 v[8:11], v[168:171], v[132:135], v[8:11]
    s_barrier
    v_mfma_f32_16x16x32_bf16 v[36:39], v[164:167], v[136:139], v[36:39]
    ds_read_b64_tr_b16 v[196:197], v230 offset:0
    s_add_u32 m0, s57, 49152
    v_mfma_f32_16x16x32_bf16 v[40:43], v[168:171], v[136:139], v[40:43]
    ds_read_b64_tr_b16 v[198:199], v230 offset:4096
    buffer_load_dwordx4 v233, s[44:47], s62 offen offset:0 sc1 lds
    v_mfma_f32_16x16x32_bf16 v[12:15], v[172:175], v[132:135], v[12:15]
    ds_read_b128 v[148:151], v228 offset:0
    v_mfma_f32_16x16x32_bf16 v[44:47], v[172:175], v[136:139], v[44:47]
    ds_read_b64_tr_b16 v[200:201], v242 offset:0
    v_mfma_f32_16x16x32_bf16 v[16:19], v[176:179], v[132:135], v[16:19]
    ds_read_b64_tr_b16 v[202:203], v242 offset:4096
    buffer_load_dwordx4 v233, s[44:47], s62 offen offset:1024 sc1 lds
    v_mfma_f32_16x16x32_bf16 v[48:51], v[176:179], v[136:139], v[48:51]
    ds_read_b128 v[152:155], v228 offset:256
    s_add_u32 s62, s62, 2048
    v_mfma_f32_16x16x32_bf16 v[20:23], v[180:183], v[132:135], v[20:23]
    ds_read_b64_tr_b16 v[204:205], v230 offset:256
    s_add_u32 m0, s60, 49152
    v_mfma_f32_16x16x32_bf16 v[52:55], v[180:183], v[136:139], v[52:55]
    ds_read_b64_tr_b16 v[206:207], v230 offset:4352
    buffer_load_dwordx4 v234, s[48:51], s55 offen offset:0 lds
    v_mfma_f32_16x16x32_bf16 v[24:27], v[184:187], v[132:135], v[24:27]
    ds_read_b64_tr_b16 v[208:209], v242 offset:256
    v_mfma_f32_16x16x32_bf16 v[56:59], v[184:187], v[136:139], v[56:59]
    ds_read_b64_tr_b16 v[210:211], v242 offset:4352
    v_mfma_f32_16x16x32_bf16 v[28:31], v[188:191], v[132:135], v[28:31]
    ds_read_b64_tr_b16 v[212:213], v230 offset:512
    buffer_load_dwordx4 v235, s[48:51], s55 offen offset:1024 lds
    v_mfma_f32_16x16x32_bf16 v[60:63], v[188:191], v[136:139], v[60:63]
    ds_read_b64_tr_b16 v[214:215], v230 offset:4608
    v_mfma_f32_16x16x32_bf16 v[68:71], v[164:167], v[140:143], v[68:71]
    ds_read_b64_tr_b16 v[216:217], v242 offset:512
    v_mfma_f32_16x16x32_bf16 v[72:75], v[168:171], v[140:143], v[72:75]
    ds_read_b64_tr_b16 v[218:219], v242 offset:4608
    buffer_load_dwordx4 v236, s[48:51], s55 offen offset:2048 lds
    v_mfma_f32_16x16x32_bf16 v[76:79], v[172:175], v[140:143], v[76:79]
    ds_read_b64_tr_b16 v[220:221], v244 offset:768
    v_mfma_f32_16x16x32_bf16 v[80:83], v[176:179], v[140:143], v[80:83]
    ds_read_b64_tr_b16 v[222:223], v244 offset:4864
    v_mfma_f32_16x16x32_bf16 v[84:87], v[180:183], v[140:143], v[84:87]
    ds_read_b128 v[156:159], v228 offset:2048
    buffer_load_dwordx4 v237, s[48:51], s55 offen offset:3072 lds
    v_mfma_f32_16x16x32_bf16 v[88:91], v[184:187], v[140:143], v[88:91]
    ds_read_b128 v[160:163], v228 offset:2304
    s_add_u32 s55, s55, s56
    v_mfma_f32_16x16x32_bf16 v[92:95], v[188:191], v[140:143], v[92:95]
    v_mfma_f32_16x16x32_bf16 v[100:103], v[164:167], v[144:147], v[100:103]
    v_mfma_f32_16x16x32_bf16 v[104:107], v[168:171], v[144:147], v[104:107]
    v_mfma_f32_16x16x32_bf16 v[108:111], v[172:175], v[144:147], v[108:111]
    v_mfma_f32_16x16x32_bf16 v[112:115], v[176:179], v[144:147], v[112:115]
    v_mfma_f32_16x16x32_bf16 v[116:119], v[180:183], v[144:147], v[116:119]
    v_mfma_f32_16x16x32_bf16 v[120:123], v[184:187], v[144:147], v[120:123]
    v_mfma_f32_16x16x32_bf16 v[124:127], v[188:191], v[144:147], v[124:127]
    s_waitcnt lgkmcnt(15)
    v_mfma_f32_16x16x32_bf16 v[4:7], v[196:199], v[148:151], v[4:7]
    s_waitcnt vmcnt(6) lgkmcnt(0)
    v_mfma_f32_16x16x32_bf16 v[8:11], v[200:203], v[148:151], v[8:11]
    s_barrier
    v_mfma_f32_16x16x32_bf16 v[36:39], v[196:199], v[152:155], v[36:39]
    ds_read_b64_tr_b16 v[164:165], v230 offset:24576
    s_add_u32 m0, s57, 0
    v_mfma_f32_16x16x32_bf16 v[40:43], v[200:203], v[152:155], v[40:43]
    ds_read_b64_tr_b16 v[166:167], v230 offset:28672
    buffer_load_dwordx4 v233, s[44:47], s62 offen offset:0 sc1 lds
    v_mfma_f32_16x16x32_bf16 v[12:15], v[204:207], v[148:151], v[12:15]
    ds_read_b128 v[132:135], v228 offset:24576
    v_mfma_f32_16x16x32_bf16 v[44:47], v[204:207], v[152:155], v[44:47]
    ds_read_b64_tr_b16 v[168:169], v242 offset:24576
    v_mfma_f32_16x16x32_bf16 v[16:19], v[208:211], v[148:151], v[16:19]
    ds_read_b64_tr_b16 v[170:171], v242 offset:28672
    buffer_load_dwordx4 v233, s[44:47], s62 offen offset:1024 sc1 lds
    v_mfma_f32_16x16x32_bf16 v[48:51], v[208:211], v[152:155], v[48:51]
    ds_read_b128 v[136:139], v228 offset:24832
    s_add_u32 s62, s62, 2048
    v_mfma_f32_16x16x32_bf16 v[20:23], v[212:215], v[148:151], v[20:23]
    ds_read_b64_tr_b16 v[172:173], v230 offset:24832
    s_add_u32 m0, s60, 0
    v_mfma_f32_16x16x32_bf16 v[52:55], v[212:215], v[152:155], v[52:55]
    ds_read_b64_tr_b16 v[174:175], v230 offset:28928
    buffer_load_dwordx4 v234, s[48:51], s55 offen offset:0 lds
    v_mfma_f32_16x16x32_bf16 v[24:27], v[216:219], v[148:151], v[24:27]
    ds_read_b64_tr_b16 v[176:177], v242 offset:24832
    v_mfma_f32_16x16x32_bf16 v[56:59], v[216:219], v[152:155], v[56:59]
    ds_read_b64_tr_b16 v[178:179], v242 offset:28928
    v_mfma_f32_16x16x32_bf16 v[28:31], v[220:223], v[148:151], v[28:31]
    ds_read_b64_tr_b16 v[180:181], v230 offset:25088
    buffer_load_dwordx4 v235, s[48:51], s55 offen offset:1024 lds
    v_mfma_f32_16x16x32_bf16 v[60:63], v[220:223], v[152:155], v[60:63]
    ds_read_b64_tr_b16 v[182:183], v230 offset:29184
    v_mfma_f32_16x16x32_bf16 v[68:71], v[196:199], v[156:159], v[68:71]
    ds_read_b64_tr_b16 v[184:185], v242 offset:25088
    v_mfma_f32_16x16x32_bf16 v[72:75], v[200:203], v[156:159], v[72:75]
    ds_read_b64_tr_b16 v[186:187], v242 offset:29184
    buffer_load_dwordx4 v236, s[48:51], s55 offen offset:2048 lds
    v_mfma_f32_16x16x32_bf16 v[76:79], v[204:207], v[156:159], v[76:79]
    ds_read_b64_tr_b16 v[188:189], v244 offset:25344
    v_mfma_f32_16x16x32_bf16 v[80:83], v[208:211], v[156:159], v[80:83]
    ds_read_b64_tr_b16 v[190:191], v244 offset:29440
    v_mfma_f32_16x16x32_bf16 v[84:87], v[212:215], v[156:159], v[84:87]
    ds_read_b128 v[140:143], v228 offset:26624
    buffer_load_dwordx4 v237, s[48:51], s55 offen offset:3072 lds
    v_mfma_f32_16x16x32_bf16 v[88:91], v[216:219], v[156:159], v[88:91]
    ds_read_b128 v[144:147], v228 offset:26880
    s_add_u32 s55, s55, s56
    v_mfma_f32_16x16x32_bf16 v[92:95], v[220:223], v[156:159], v[92:95]
    v_mfma_f32_16x16x32_bf16 v[100:103], v[196:199], v[160:163], v[100:103]
    v_mfma_f32_16x16x32_bf16 v[104:107], v[200:203], v[160:163], v[104:107]
    v_mfma_f32_16x16x32_bf16 v[108:111], v[204:207], v[160:163], v[108:111]
    v_mfma_f32_16x16x32_bf16 v[112:115], v[208:211], v[160:163], v[112:115]
    v_mfma_f32_16x16x32_bf16 v[116:119], v[212:215], v[160:163], v[116:119]
    v_mfma_f32_16x16x32_bf16 v[120:123], v[216:219], v[160:163], v[120:123]
    v_mfma_f32_16x16x32_bf16 v[124:127], v[220:223], v[160:163], v[124:127]
    s_waitcnt lgkmcnt(15)
    v_mfma_f32_16x16x32_bf16 v[4:7], v[164:167], v[132:135], v[4:7]
    s_waitcnt vmcnt(6) lgkmcnt(0)
    v_mfma_f32_16x16x32_bf16 v[8:11], v[168:171], v[132:135], v[8:11]
    s_barrier
    v_mfma_f32_16x16x32_bf16 v[36:39], v[164:167], v[136:139], v[36:39]
    ds_read_b64_tr_b16 v[196:197], v231 offset:0
    s_add_u32 m0, s57, 24576
    v_mfma_f32_16x16x32_bf16 v[40:43], v[168:171], v[136:139], v[40:43]
    ds_read_b64_tr_b16 v[198:199], v231 offset:4096
    buffer_load_dwordx4 v233, s[44:47], s62 offen offset:0 sc1 lds
    v_mfma_f32_16x16x32_bf16 v[12:15], v[172:175], v[132:135], v[12:15]
    ds_read_b128 v[148:151], v229 offset:0
    v_mfma_f32_16x16x32_bf16 v[44:47], v[172:175], v[136:139], v[44:47]
    ds_read_b64_tr_b16 v[200:201], v243 offset:0
    v_mfma_f32_16x16x32_bf16 v[16:19], v[176:179], v[132:135], v[16:19]
    ds_read_b64_tr_b16 v[202:203], v243 offset:4096
    buffer_load_dwordx4 v233, s[44:47], s62 offen offset:1024 sc1 lds
    v_mfma_f32_16x16x32_bf16 v[48:51], v[176:179], v[136:139], v[48:51]
    ds_read_b128 v[152:155], v229 offset:256
    s_add_u32 s62, s62, 2048
    v_mfma_f32_16x16x32_bf16 v[20:23], v[180:183], v[132:135], v[20:23]
    ds_read_b64_tr_b16 v[204:205], v231 offset:256
    s_add_u32 m0, s60, 24576
    v_mfma_f32_16x16x32_bf16 v[52:55], v[180:183], v[136:139], v[52:55]
    ds_read_b64_tr_b16 v[206:207], v231 offset:4352
    buffer_load_dwordx4 v234, s[48:51], s55 offen offset:0 lds
    v_mfma_f32_16x16x32_bf16 v[24:27], v[184:187], v[132:135], v[24:27]
    ds_read_b64_tr_b16 v[208:209], v243 offset:256
    v_mfma_f32_16x16x32_bf16 v[56:59], v[184:187], v[136:139], v[56:59]
    ds_read_b64_tr_b16 v[210:211], v243 offset:4352
    v_mfma_f32_16x16x32_bf16 v[28:31], v[188:191], v[132:135], v[28:31]
    ds_read_b64_tr_b16 v[212:213], v231 offset:512
    buffer_load_dwordx4 v235, s[48:51], s55 offen offset:1024 lds
    v_mfma_f32_16x16x32_bf16 v[60:63], v[188:191], v[136:139], v[60:63]
    ds_read_b64_tr_b16 v[214:215], v231 offset:4608
    v_mfma_f32_16x16x32_bf16 v[68:71], v[164:167], v[140:143], v[68:71]
    ds_read_b64_tr_b16 v[216:217], v243 offset:512
    v_mfma_f32_16x16x32_bf16 v[72:75], v[168:171], v[140:143], v[72:75]
    ds_read_b64_tr_b16 v[218:219], v243 offset:4608
    buffer_load_dwordx4 v236, s[48:51], s55 offen offset:2048 lds
    v_mfma_f32_16x16x32_bf16 v[76:79], v[172:175], v[140:143], v[76:79]
    ds_read_b64_tr_b16 v[220:221], v245 offset:768
    v_mfma_f32_16x16x32_bf16 v[80:83], v[176:179], v[140:143], v[80:83]
    ds_read_b64_tr_b16 v[222:223], v245 offset:4864
    v_mfma_f32_16x16x32_bf16 v[84:87], v[180:183], v[140:143], v[84:87]
    ds_read_b128 v[156:159], v229 offset:2048
    buffer_load_dwordx4 v237, s[48:51], s55 offen offset:3072 lds
    v_mfma_f32_16x16x32_bf16 v[88:91], v[184:187], v[140:143], v[88:91]
    ds_read_b128 v[160:163], v229 offset:2304
    s_add_u32 s55, s55, s56
    v_mfma_f32_16x16x32_bf16 v[92:95], v[188:191], v[140:143], v[92:95]
    v_mfma_f32_16x16x32_bf16 v[100:103], v[164:167], v[144:147], v[100:103]
    v_mfma_f32_16x16x32_bf16 v[104:107], v[168:171], v[144:147], v[104:107]
    v_mfma_f32_16x16x32_bf16 v[108:111], v[172:175], v[144:147], v[108:111]
    v_mfma_f32_16x16x32_bf16 v[112:115], v[176:179], v[144:147], v[112:115]
    v_mfma_f32_16x16x32_bf16 v[116:119], v[180:183], v[144:147], v[116:119]
    v_mfma_f32_16x16x32_bf16 v[120:123], v[184:187], v[144:147], v[120:123]
    v_mfma_f32_16x16x32_bf16 v[124:127], v[188:191], v[144:147], v[124:127]
    s_waitcnt lgkmcnt(15)
    v_mfma_f32_16x16x32_bf16 v[4:7], v[196:199], v[148:151], v[4:7]
    s_waitcnt vmcnt(6) lgkmcnt(0)
    v_mfma_f32_16x16x32_bf16 v[8:11], v[200:203], v[148:151], v[8:11]
    s_barrier
    v_mfma_f32_16x16x32_bf16 v[36:39], v[196:199], v[152:155], v[36:39]
    ds_read_b64_tr_b16 v[164:165], v230 offset:0
    s_add_u32 m0, s57, 49152
    v_mfma_f32_16x16x32_bf16 v[40:43], v[200:203], v[152:155], v[40:43]
    ds_read_b64_tr_b16 v[166:167], v230 offset:4096
    buffer_load_dwordx4 v233, s[44:47], s62 offen offset:0 sc1 lds
    v_mfma_f32_16x16x32_bf16 v[12:15], v[204:207], v[148:151], v[12:15]
    ds_read_b128 v[132:135], v228 offset:0
    v_mfma_f32_16x16x32_bf16 v[44:47], v[204:207], v[152:155], v[44:47]
    ds_read_b64_tr_b16 v[168:169], v242 offset:0
    v_mfma_f32_16x16x32_bf16 v[16:19], v[208:211], v[148:151], v[16:19]
    ds_read_b64_tr_b16 v[170:171], v242 offset:4096
    buffer_load_dwordx4 v233, s[44:47], s62 offen offset:1024 sc1 lds
    v_mfma_f32_16x16x32_bf16 v[48:51], v[208:211], v[152:155], v[48:51]
    ds_read_b128 v[136:139], v228 offset:256
    s_add_u32 s62, s62, 2048
    v_mfma_f32_16x16x32_bf16 v[20:23], v[212:215], v[148:151], v[20:23]
    ds_read_b64_tr_b16 v[172:173], v230 offset:256
    s_add_u32 m0, s60, 49152
    v_mfma_f32_16x16x32_bf16 v[52:55], v[212:215], v[152:155], v[52:55]
    ds_read_b64_tr_b16 v[174:175], v230 offset:4352
    buffer_load_dwordx4 v234, s[48:51], s55 offen offset:0 lds
    v_mfma_f32_16x16x32_bf16 v[24:27], v[216:219], v[148:151], v[24:27]
    ds_read_b64_tr_b16 v[176:177], v242 offset:256
    v_mfma_f32_16x16x32_bf16 v[56:59], v[216:219], v[152:155], v[56:59]
    ds_read_b64_tr_b16 v[178:179], v242 offset:4352
    v_mfma_f32_16x16x32_bf16 v[28:31], v[220:223], v[148:151], v[28:31]
    ds_read_b64_tr_b16 v[180:181], v230 offset:512
    buffer_load_dwordx4 v235, s[48:51], s55 offen offset:1024 lds
    v_mfma_f32_16x16x32_bf16 v[60:63], v[220:223], v[152:155], v[60:63]
    ds_read_b64_tr_b16 v[182:183], v230 offset:4608
    v_mfma_f32_16x16x32_bf16 v[68:71], v[196:199], v[156:159], v[68:71]
    ds_read_b64_tr_b16 v[184:185], v242 offset:512
    v_mfma_f32_16x16x32_bf16 v[72:75], v[200:203], v[156:159], v[72:75]
    ds_read_b64_tr_b16 v[186:187], v242 offset:4608
    buffer_load_dwordx4 v236, s[48:51], s55 offen offset:2048 lds
    v_mfma_f32_16x16x32_bf16 v[76:79], v[204:207], v[156:159], v[76:79]
    ds_read_b64_tr_b16 v[188:189], v244 offset:768
    v_mfma_f32_16x16x32_bf16 v[80:83], v[208:211], v[156:159], v[80:83]
    ds_read_b64_tr_b16 v[190:191], v244 offset:4864
    v_mfma_f32_16x16x32_bf16 v[84:87], v[212:215], v[156:159], v[84:87]
    ds_read_b128 v[140:143], v228 offset:2048
    buffer_load_dwordx4 v237, s[48:51], s55 offen offset:3072 lds
    v_mfma_f32_16x16x32_bf16 v[88:91], v[216:219], v[156:159], v[88:91]
    ds_read_b128 v[144:147], v228 offset:2304
    s_add_u32 s55, s55, s56
    v_mfma_f32_16x16x32_bf16 v[92:95], v[220:223], v[156:159], v[92:95]
    v_mfma_f32_16x16x32_bf16 v[100:103], v[196:199], v[160:163], v[100:103]
    v_mfma_f32_16x16x32_bf16 v[104:107], v[200:203], v[160:163], v[104:107]
    v_mfma_f32_16x16x32_bf16 v[108:111], v[204:207], v[160:163], v[108:111]
    v_mfma_f32_16x16x32_bf16 v[112:115], v[208:211], v[160:163], v[112:115]
    v_mfma_f32_16x16x32_bf16 v[116:119], v[212:215], v[160:163], v[116:119]
    v_mfma_f32_16x16x32_bf16 v[120:123], v[216:219], v[160:163], v[120:123]
    v_mfma_f32_16x16x32_bf16 v[124:127], v[220:223], v[160:163], v[124:127]
    s_waitcnt lgkmcnt(15)
    v_mfma_f32_16x16x32_bf16 v[4:7], v[164:167], v[132:135], v[4:7]
    s_waitcnt vmcnt(6) lgkmcnt(0)
    v_mfma_f32_16x16x32_bf16 v[8:11], v[168:171], v[132:135], v[8:11]
    s_barrier
    v_mfma_f32_16x16x32_bf16 v[36:39], v[164:167], v[136:139], v[36:39]
    ds_read_b64_tr_b16 v[196:197], v230 offset:24576
    s_add_u32 m0, s57, 0
    v_mfma_f32_16x16x32_bf16 v[40:43], v[168:171], v[136:139], v[40:43]
    ds_read_b64_tr_b16 v[198:199], v230 offset:28672
    buffer_load_dwordx4 v233, s[44:47], s62 offen offset:0 sc1 lds
    v_mfma_f32_16x16x32_bf16 v[12:15], v[172:175], v[132:135], v[12:15]
    ds_read_b128 v[148:151], v228 offset:24576
    v_mfma_f32_16x16x32_bf16 v[44:47], v[172:175], v[136:139], v[44:47]
    ds_read_b64_tr_b16 v[200:201], v242 offset:24576
    v_mfma_f32_16x16x32_bf16 v[16:19], v[176:179], v[132:135], v[16:19]
    ds_read_b64_tr_b16 v[202:203], v242 offset:28672
    buffer_load_dwordx4 v233, s[44:47], s62 offen offset:1024 sc1 lds
    v_mfma_f32_16x16x32_bf16 v[48:51], v[176:179], v[136:139], v[48:51]
    ds_read_b128 v[152:155], v228 offset:24832
    s_add_u32 s62, s62, 2048
    v_mfma_f32_16x16x32_bf16 v[20:23], v[180:183], v[132:135], v[20:23]
    ds_read_b64_tr_b16 v[204:205], v230 offset:24832
    s_add_u32 m0, s60, 0
    v_mfma_f32_16x16x32_bf16 v[52:55], v[180:183], v[136:139], v[52:55]
    ds_read_b64_tr_b16 v[206:207], v230 offset:28928
    buffer_load_dwordx4 v234, s[48:51], s55 offen offset:0 lds
    v_mfma_f32_16x16x32_bf16 v[24:27], v[184:187], v[132:135], v[24:27]
    ds_read_b64_tr_b16 v[208:209], v242 offset:24832
    v_mfma_f32_16x16x32_bf16 v[56:59], v[184:187], v[136:139], v[56:59]
    ds_read_b64_tr_b16 v[210:211], v242 offset:28928
    v_mfma_f32_16x16x32_bf16 v[28:31], v[188:191], v[132:135], v[28:31]
    ds_read_b64_tr_b16 v[212:213], v230 offset:25088
    buffer_load_dwordx4 v235, s[48:51], s55 offen offset:1024 lds
    v_mfma_f32_16x16x32_bf16 v[60:63], v[188:191], v[136:139], v[60:63]
    ds_read_b64_tr_b16 v[214:215], v230 offset:29184
    v_mfma_f32_16x16x32_bf16 v[68:71], v[164:167], v[140:143], v[68:71]
    ds_read_b64_tr_b16 v[216:217], v242 offset:25088
    v_mfma_f32_16x16x32_bf16 v[72:75], v[168:171], v[140:143], v[72:75]
    ds_read_b64_tr_b16 v[218:219], v242 offset:29184
    buffer_load_dwordx4 v236, s[48:51], s55 offen offset:2048 lds
    v_mfma_f32_16x16x32_bf16 v[76:79], v[172:175], v[140:143], v[76:79]
    ds_read_b64_tr_b16 v[220:221], v244 offset:25344
    v_mfma_f32_16x16x32_bf16 v[80:83], v[176:179], v[140:143], v[80:83]
    ds_read_b64_tr_b16 v[222:223], v244 offset:29440
    v_mfma_f32_16x16x32_bf16 v[84:87], v[180:183], v[140:143], v[84:87]
    ds_read_b128 v[156:159], v228 offset:26624
    buffer_load_dwordx4 v237, s[48:51], s55 offen offset:3072 lds
    v_mfma_f32_16x16x32_bf16 v[88:91], v[184:187], v[140:143], v[88:91]
    ds_read_b128 v[160:163], v228 offset:26880
    s_add_u32 s55, s55, s56
    v_mfma_f32_16x16x32_bf16 v[92:95], v[188:191], v[140:143], v[92:95]
    v_mfma_f32_16x16x32_bf16 v[100:103], v[164:167], v[144:147], v[100:103]
    v_mfma_f32_16x16x32_bf16 v[104:107], v[168:171], v[144:147], v[104:107]
    v_mfma_f32_16x16x32_bf16 v[108:111], v[172:175], v[144:147], v[108:111]
    v_mfma_f32_16x16x32_bf16 v[112:115], v[176:179], v[144:147], v[112:115]
    v_mfma_f32_16x16x32_bf16 v[116:119], v[180:183], v[144:147], v[116:119]
    v_mfma_f32_16x16x32_bf16 v[120:123], v[184:187], v[144:147], v[120:123]
    v_mfma_f32_16x16x32_bf16 v[124:127], v[188:191], v[144:147], v[124:127]
    s_add_u32 s61, s61, 1
    s_cmp_lg_u32 s61, 4
    s_waitcnt lgkmcnt(15)
    v_mfma_f32_16x16x32_bf16 v[4:7], v[196:199], v[148:151], v[4:7]
    s_waitcnt vmcnt(6) lgkmcnt(0)
    v_mfma_f32_16x16x32_bf16 v[8:11], v[200:203], v[148:151], v[8:11]
    s_barrier
    s_cbranch_scc1 g3_loop
    v_mfma_f32_16x16x32_bf16 v[36:39], v[196:199], v[152:155], v[36:39]
    ds_read_b64_tr_b16 v[164:165], v231 offset:0
    s_add_u32 m0, s57, 24576
    v_mfma_f32_16x16x32_bf16 v[40:43], v[200:203], v[152:155], v[40:43]
    ds_read_b64_tr_b16 v[166:167], v231 offset:4096
    buffer_load_dwordx4 v233, s[44:47], s62 offen offset:0 sc1 lds
    v_mfma_f32_16x16x32_bf16 v[12:15], v[204:207], v[148:151], v[12:15]
    ds_read_b128 v[132:135], v229 offset:0
    v_mfma_f32_16x16x32_bf16 v[44:47], v[204:207], v[152:155], v[44:47]
    ds_read_b64_tr_b16 v[168:169], v243 offset:0
    v_mfma_f32_16x16x32_bf16 v[16:19], v[208:211], v[148:151], v[16:19]
    ds_read_b64_tr_b16 v[170:171], v243 offset:4096
    buffer_load_dwordx4 v233, s[44:47], s62 offen offset:1024 sc1 lds
    v_mfma_f32_16x16x32_bf16 v[48:51], v[208:211], v[152:155], v[48:51]
    ds_read_b128 v[136:139], v229 offset:256
    s_add_u32 s62, s62, 2048
    v_mfma_f32_16x16x32_bf16 v[20:23], v[212:215], v[148:151], v[20:23]
    ds_read_b64_tr_b16 v[172:173], v231 offset:256
    s_add_u32 m0, s60, 24576
    v_mfma_f32_16x16x32_bf16 v[52:55], v[212:215], v[152:155], v[52:55]
    ds_read_b64_tr_b16 v[174:175], v231 offset:4352
    buffer_load_dwordx4 v234, s[48:51], s55 offen offset:0 lds
    v_mfma_f32_16x16x32_bf16 v[24:27], v[216:219], v[148:151], v[24:27]
    ds_read_b64_tr_b16 v[176:177], v243 offset:256
    v_mfma_f32_16x16x32_bf16 v[56:59], v[216:219], v[152:155], v[56:59]
    ds_read_b64_tr_b16 v[178:179], v243 offset:4352
    v_mfma_f32_16x16x32_bf16 v[28:31], v[220:223], v[148:151], v[28:31]
    ds_read_b64_tr_b16 v[180:181], v231 offset:512
    buffer_load_dwordx4 v235, s[48:51], s55 offen offset:1024 lds
    v_mfma_f32_16x16x32_bf16 v[60:63], v[220:223], v[152:155], v[60:63]
    ds_read_b64_tr_b16 v[182:183], v231 offset:4608
    v_mfma_f32_16x16x32_bf16 v[68:71], v[196:199], v[156:159], v[68:71]
    ds_read_b64_tr_b16 v[184:185], v243 offset:512
    v_mfma_f32_16x16x32_bf16 v[72:75], v[200:203], v[156:159], v[72:75]
    ds_read_b64_tr_b16 v[186:187], v243 offset:4608
    buffer_load_dwordx4 v236, s[48:51], s55 offen offset:2048 lds
    v_mfma_f32_16x16x32_bf16 v[76:79], v[204:207], v[156:159], v[76:79]
    ds_read_b64_tr_b16 v[188:189], v245 offset:768
    v_mfma_f32_16x16x32_bf16 v[80:83], v[208:211], v[156:159], v[80:83]
    ds_read_b64_tr_b16 v[190:191], v245 offset:4864
    v_mfma_f32_16x16x32_bf16 v[84:87], v[212:215], v[156:159], v[84:87]
    ds_read_b128 v[140:143], v229 offset:2048
    buffer_load_dwordx4 v237, s[48:51], s55 offen offset:3072 lds
    v_mfma_f32_16x16x32_bf16 v[88:91], v[216:219], v[156:159], v[88:91]
    ds_read_b128 v[144:147], v229 offset:2304
    s_add_u32 s55, s55, s56
    v_mfma_f32_16x16x32_bf16 v[92:95], v[220:223], v[156:159], v[92:95]
    v_mfma_f32_16x16x32_bf16 v[100:103], v[196:199], v[160:163], v[100:103]
    v_mfma_f32_16x16x32_bf16 v[104:107], v[200:203], v[160:163], v[104:107]
    v_mfma_f32_16x16x32_bf16 v[108:111], v[204:207], v[160:163], v[108:111]
    v_mfma_f32_16x16x32_bf16 v[112:115], v[208:211], v[160:163], v[112:115]
    v_mfma_f32_16x16x32_bf16 v[116:119], v[212:215], v[160:163], v[116:119]
    v_mfma_f32_16x16x32_bf16 v[120:123], v[216:219], v[160:163], v[120:123]
    v_mfma_f32_16x16x32_bf16 v[124:127], v[220:223], v[160:163], v[124:127]
    s_waitcnt lgkmcnt(15)
    v_mfma_f32_16x16x32_bf16 v[4:7], v[164:167], v[132:135], v[4:7]
    s_waitcnt vmcnt(6) lgkmcnt(0)
    v_mfma_f32_16x16x32_bf16 v[8:11], v[168:171], v[132:135], v[8:11]
    s_barrier
    v_mfma_f32_16x16x32_bf16 v[36:39], v[164:167], v[136:139], v[36:39]
    ds_read_b64_tr_b16 v[196:197], v230 offset:0
    s_add_u32 m0, s57, 49152
    v_mfma_f32_16x16x32_bf16 v[40:43], v[168:171], v[136:139], v[40:43]
    ds_read_b64_tr_b16 v[198:199], v230 offset:4096
    buffer_load_dwordx4 v233, s[44:47], s62 offen offset:0 sc1 lds
    v_mfma_f32_16x16x32_bf16 v[12:15], v[172:175], v[132:135], v[12:15]
    ds_read_b128 v[148:151], v228 offset:0
    v_mfma_f32_16x16x32_bf16 v[44:47], v[172:175], v[136:139], v[44:47]
    ds_read_b64_tr_b16 v[200:201], v242 offset:0
    v_mfma_f32_16x16x32_bf16 v[16:19], v[176:179], v[132:135], v[16:19]
    ds_read_b64_tr_b16 v[202:203], v242 offset:4096
    buffer_load_dwordx4 v233, s[44:47], s62 offen offset:1024 sc1 lds
    v_mfma_f32_16x16x32_bf16 v[48:51], v[176:179], v[136:139], v[48:51]
    ds_read_b128 v[152:155], v228 offset:256
    s_add_u32 s62, s62, 2048
    v_mfma_f32_16x16x32_bf16 v[20:23], v[180:183], v[132:135], v[20:23]
    ds_read_b64_tr_b16 v[204:205], v230 offset:256
    s_add_u32 m0, s60, 49152
    v_mfma_f32_16x16x32_bf16 v[52:55], v[180:183], v[136:139], v[52:55]
    ds_read_b64_tr_b16 v[206:207], v230 offset:4352
    buffer_load_dwordx4 v234, s[48:51], s55 offen offset:0 lds
    v_mfma_f32_16x16x32_bf16 v[24:27], v[184:187], v[132:135], v[24:27]
    ds_read_b64_tr_b16 v[208:209], v242 offset:256
    v_mfma_f32_16x16x32_bf16 v[56:59], v[184:187], v[136:139], v[56:59]
    ds_read_b64_tr_b16 v[210:211], v242 offset:4352
    v_mfma_f32_16x16x32_bf16 v[28:31], v[188:191], v[132:135], v[28:31]
    ds_read_b64_tr_b16 v[212:213], v230 offset:512
    buffer_load_dwordx4 v235, s[48:51], s55 offen offset:1024 lds
    v_mfma_f32_16x16x32_bf16 v[60:63], v[188:191], v[136:139], v[60:63]
    ds_read_b64_tr_b16 v[214:215], v230 offset:4608
    v_mfma_f32_16x16x32_bf16 v[68:71], v[164:167], v[140:143], v[68:71]
    ds_read_b64_tr_b16 v[216:217], v242 offset:512
    v_mfma_f32_16x16x32_bf16 v[72:75], v[168:171], v[140:143], v[72:75]
    ds_read_b64_tr_b16 v[218:219], v242 offset:4608
    buffer_load_dwordx4 v236, s[48:51], s55 offen offset:2048 lds
    v_mfma_f32_16x16x32_bf16 v[76:79], v[172:175], v[140:143], v[76:79]
    ds_read_b64_tr_b16 v[220:221], v244 offset:768
    v_mfma_f32_16x16x32_bf16 v[80:83], v[176:179], v[140:143], v[80:83]
    ds_read_b64_tr_b16 v[222:223], v244 offset:4864
    v_mfma_f32_16x16x32_bf16 v[84:87], v[180:183], v[140:143], v[84:87]
    ds_read_b128 v[156:159], v228 offset:2048
    buffer_load_dwordx4 v237, s[48:51], s55 offen offset:3072 lds
    v_mfma_f32_16x16x32_bf16 v[88:91], v[184:187], v[140:143], v[88:91]
    ds_read_b128 v[160:163], v228 offset:2304
    s_add_u32 s55, s55, s56
    v_mfma_f32_16x16x32_bf16 v[92:95], v[188:191], v[140:143], v[92:95]
    v_mfma_f32_16x16x32_bf16 v[100:103], v[164:167], v[144:147], v[100:103]
    v_mfma_f32_16x16x32_bf16 v[104:107], v[168:171], v[144:147], v[104:107]
    v_mfma_f32_16x16x32_bf16 v[108:111], v[172:175], v[144:147], v[108:111]
    v_mfma_f32_16x16x32_bf16 v[112:115], v[176:179], v[144:147], v[112:115]
    v_mfma_f32_16x16x32_bf16 v[116:119], v[180:183], v[144:147], v[116:119]
    v_mfma_f32_16x16x32_bf16 v[120:123], v[184:187], v[144:147], v[120:123]
    v_mfma_f32_16x16x32_bf16 v[124:127], v[188:191], v[144:147], v[124:127]
    s_waitcnt lgkmcnt(15)
    v_mfma_f32_16x16x32_bf16 v[4:7], v[196:199], v[148:151], v[4:7]
    s_waitcnt vmcnt(6) lgkmcnt(0)
    v_mfma_f32_16x16x32_bf16 v[8:11], v[200:203], v[148:151], v[8:11]
    s_barrier
    v_mfma_f32_16x16x32_bf16 v[36:39], v[196:199], v[152:155], v[36:39]
    ds_read_b64_tr_b16 v[164:165], v230 offset:24576
    s_add_u32 m0, s57, 0
    v_mfma_f32_16x16x32_bf16 v[40:43], v[200:203], v[152:155], v[40:43]
    ds_read_b64_tr_b16 v[166:167], v230 offset:28672
    buffer_load_dwordx4 v233, s[44:47], s62 offen offset:0 sc1 lds
    v_mfma_f32_16x16x32_bf16 v[12:15], v[204:207], v[148:151], v[12:15]
    ds_read_b128 v[132:135], v228 offset:24576
    v_mfma_f32_16x16x32_bf16 v[44:47], v[204:207], v[152:155], v[44:47]
    ds_read_b64_tr_b16 v[168:169], v242 offset:24576
    v_mfma_f32_16x16x32_bf16 v[16:19], v[208:211], v[148:151], v[16:19]
    ds_read_b64_tr_b16 v[170:171], v242 offset:28672
    buffer_load_dwordx4 v233, s[44:47], s62 offen offset:1024 sc1 lds
    v_mfma_f32_16x16x32_bf16 v[48:51], v[208:211], v[152:155], v[48:51]
    ds_read_b128 v[136:139], v228 offset:24832
    s_add_u32 s62, s62, 2048
    v_mfma_f32_16x16x32_bf16 v[20:23], v[212:215], v[148:151], v[20:23]
    ds_read_b64_tr_b16 v[172:173], v230 offset:24832
    s_add_u32 m0, s60, 0
    v_mfma_f32_16x16x32_bf16 v[52:55], v[212:215], v[152:155], v[52:55]
    ds_read_b64_tr_b16 v[174:175], v230 offset:28928
    buffer_load_dwordx4 v234, s[48:51], s55 offen offset:0 lds
    v_mfma_f32_16x16x32_bf16 v[24:27], v[216:219], v[148:151], v[24:27]
    ds_read_b64_tr_b16 v[176:177], v242 offset:24832
    v_mfma_f32_16x16x32_bf16 v[56:59], v[216:219], v[152:155], v[56:59]
    ds_read_b64_tr_b16 v[178:179], v242 offset:28928
    v_mfma_f32_16x16x32_bf16 v[28:31], v[220:223], v[148:151], v[28:31]
    ds_read_b64_tr_b16 v[180:181], v230 offset:25088
    buffer_load_dwordx4 v235, s[48:51], s55 offen offset:1024 lds
    v_mfma_f32_16x16x32_bf16 v[60:63], v[220:223], v[152:155], v[60:63]
    ds_read_b64_tr_b16 v[182:183], v230 offset:29184
    v_mfma_f32_16x16x32_bf16 v[68:71], v[196:199], v[156:159], v[68:71]
    ds_read_b64_tr_b16 v[184:185], v242 offset:25088
    v_mfma_f32_16x16x32_bf16 v[72:75], v[200:203], v[156:159], v[72:75]
    ds_read_b64_tr_b16 v[186:187], v242 offset:29184
    buffer_load_dwordx4 v236, s[48:51], s55 offen offset:2048 lds
    v_mfma_f32_16x16x32_bf16 v[76:79], v[204:207], v[156:159], v[76:79]
    ds_read_b64_tr_b16 v[188:189], v244 offset:25344
    v_mfma_f32_16x16x32_bf16 v[80:83], v[208:211], v[156:159], v[80:83]
    ds_read_b64_tr_b16 v[190:191], v244 offset:29440
    v_mfma_f32_16x16x32_bf16 v[84:87], v[212:215], v[156:159], v[84:87]
    ds_read_b128 v[140:143], v228 offset:26624
    buffer_load_dwordx4 v237, s[48:51], s55 offen offset:3072 lds
    v_mfma_f32_16x16x32_bf16 v[88:91], v[216:219], v[156:159], v[88:91]
    ds_read_b128 v[144:147], v228 offset:26880
    s_add_u32 s55, s55, s56
    v_mfma_f32_16x16x32_bf16 v[92:95], v[220:223], v[156:159], v[92:95]
    v_mfma_f32_16x16x32_bf16 v[100:103], v[196:199], v[160:163], v[100:103]
    v_mfma_f32_16x16x32_bf16 v[104:107], v[200:203], v[160:163], v[104:107]
    v_mfma_f32_16x16x32_bf16 v[108:111], v[204:207], v[160:163], v[108:111]
    v_mfma_f32_16x16x32_bf16 v[112:115], v[208:211], v[160:163], v[112:115]
    v_mfma_f32_16x16x32_bf16 v[116:119], v[212:215], v[160:163], v[116:119]
    v_mfma_f32_16x16x32_bf16 v[120:123], v[216:219], v[160:163], v[120:123]
    v_mfma_f32_16x16x32_bf16 v[124:127], v[220:223], v[160:163], v[124:127]
    s_waitcnt lgkmcnt(15)
    v_mfma_f32_16x16x32_bf16 v[4:7], v[164:167], v[132:135], v[4:7]
    s_waitcnt vmcnt(6) lgkmcnt(0)
    v_mfma_f32_16x16x32_bf16 v[8:11], v[168:171], v[132:135], v[8:11]
    s_barrier
    v_mfma_f32_16x16x32_bf16 v[36:39], v[164:167], v[136:139], v[36:39]
    ds_read_b64_tr_b16 v[196:197], v231 offset:0
    s_add_u32 m0, s57, 24576
    v_mfma_f32_16x16x32_bf16 v[40:43], v[168:171], v[136:139], v[40:43]
    ds_read_b64_tr_b16 v[198:199], v231 offset:4096
    buffer_load_dwordx4 v233, s[44:47], s62 offen offset:0 sc1 lds
    v_mfma_f32_16x16x32_bf16 v[12:15], v[172:175], v[132:135], v[12:15]
    ds_read_b128 v[148:151], v229 offset:0
    v_mfma_f32_16x16x32_bf16 v[44:47], v[172:175], v[136:139], v[44:47]
    ds_read_b64_tr_b16 v[200:201], v243 offset:0
    v_mfma_f32_16x16x32_bf16 v[16:19], v[176:179], v[132:135], v[16:19]
    ds_read_b64_tr_b16 v[202:203], v243 offset:4096
    buffer_load_dwordx4 v233, s[44:47], s62 offen offset:1024 sc1 lds
    v_mfma_f32_16x16x32_bf16 v[48:51], v[176:179], v[136:139], v[48:51]
    ds_read_b128 v[152:155], v229 offset:256
    s_add_u32 s62, s62, 2048
    v_mfma_f32_16x16x32_bf16 v[20:23], v[180:183], v[132:135], v[20:23]
    ds_read_b64_tr_b16 v[204:205], v231 offset:256
    s_add_u32 m0, s60, 24576
    v_mfma_f32_16x16x32_bf16 v[52:55], v[180:183], v[136:139], v[52:55]
    ds_read_b64_tr_b16 v[206:207], v231 offset:4352
    buffer_load_dwordx4 v234, s[48:51], s55 offen offset:0 lds
    v_mfma_f32_16x16x32_bf16 v[24:27], v[184:187], v[132:135], v[24:27]
    ds_read_b64_tr_b16 v[208:209], v243 offset:256
    v_mfma_f32_16x16x32_bf16 v[56:59], v[184:187], v[136:139], v[56:59]
    ds_read_b64_tr_b16 v[210:211], v243 offset:4352
    v_mfma_f32_16x16x32_bf16 v[28:31], v[188:191], v[132:135], v[28:31]
    ds_read_b64_tr_b16 v[212:213], v231 offset:512
    buffer_load_dwordx4 v235, s[48:51], s55 offen offset:1024 lds
    v_mfma_f32_16x16x32_bf16 v[60:63], v[188:191], v[136:139], v[60:63]
    ds_read_b64_tr_b16 v[214:215], v231 offset:4608
    v_mfma_f32_16x16x32_bf16 v[68:71], v[164:167], v[140:143], v[68:71]
    ds_read_b64_tr_b16 v[216:217], v243 offset:512
    v_mfma_f32_16x16x32_bf16 v[72:75], v[168:171], v[140:143], v[72:75]
    ds_read_b64_tr_b16 v[218:219], v243 offset:4608
    buffer_load_dwordx4 v236, s[48:51], s55 offen offset:2048 lds
    v_mfma_f32_16x16x32_bf16 v[76:79], v[172:175], v[140:143], v[76:79]
    ds_read_b64_tr_b16 v[220:221], v245 offset:768
    v_mfma_f32_16x16x32_bf16 v[80:83], v[176:179], v[140:143], v[80:83]
    ds_read_b64_tr_b16 v[222:223], v245 offset:4864
    v_mfma_f32_16x16x32_bf16 v[84:87], v[180:183], v[140:143], v[84:87]
    ds_read_b128 v[156:159], v229 offset:2048
    buffer_load_dwordx4 v237, s[48:51], s55 offen offset:3072 lds
    v_mfma_f32_16x16x32_bf16 v[88:91], v[184:187], v[140:143], v[88:91]
    ds_read_b128 v[160:163], v229 offset:2304
    s_add_u32 s55, s55, s56
    v_mfma_f32_16x16x32_bf16 v[92:95], v[188:191], v[140:143], v[92:95]
    v_mfma_f32_16x16x32_bf16 v[100:103], v[164:167], v[144:147], v[100:103]
    v_mfma_f32_16x16x32_bf16 v[104:107], v[168:171], v[144:147], v[104:107]
    v_mfma_f32_16x16x32_bf16 v[108:111], v[172:175], v[144:147], v[108:111]
    v_mfma_f32_16x16x32_bf16 v[112:115], v[176:179], v[144:147], v[112:115]
    v_mfma_f32_16x16x32_bf16 v[116:119], v[180:183], v[144:147], v[116:119]
    v_mfma_f32_16x16x32_bf16 v[120:123], v[184:187], v[144:147], v[120:123]
    v_mfma_f32_16x16x32_bf16 v[124:127], v[188:191], v[144:147], v[124:127]
    s_waitcnt lgkmcnt(15)
    v_mfma_f32_16x16x32_bf16 v[4:7], v[196:199], v[148:151], v[4:7]
    s_waitcnt vmcnt(6) lgkmcnt(0)
    v_mfma_f32_16x16x32_bf16 v[8:11], v[200:203], v[148:151], v[8:11]
    s_barrier
    v_mfma_f32_16x16x32_bf16 v[36:39], v[196:199], v[152:155], v[36:39]
    ds_read_b64_tr_b16 v[164:165], v230 offset:0
    v_mfma_f32_16x16x32_bf16 v[40:43], v[200:203], v[152:155], v[40:43]
    ds_read_b64_tr_b16 v[166:167], v230 offset:4096
    v_mfma_f32_16x16x32_bf16 v[12:15], v[204:207], v[148:151], v[12:15]
    ds_read_b128 v[132:135], v228 offset:0
    v_mfma_f32_16x16x32_bf16 v[44:47], v[204:207], v[152:155], v[44:47]
    ds_read_b64_tr_b16 v[168:169], v242 offset:0
    v_mfma_f32_16x16x32_bf16 v[16:19], v[208:211], v[148:151], v[16:19]
    ds_read_b64_tr_b16 v[170:171], v242 offset:4096
    v_mfma_f32_16x16x32_bf16 v[48:51], v[208:211], v[152:155], v[48:51]
    ds_read_b128 v[136:139], v228 offset:256
    v_mfma_f32_16x16x32_bf16 v[20:23], v[212:215], v[148:151], v[20:23]
    ds_read_b64_tr_b16 v[172:173], v230 offset:256
    v_mfma_f32_16x16x32_bf16 v[52:55], v[212:215], v[152:155], v[52:55]
    ds_read_b64_tr_b16 v[174:175], v230 offset:4352
    v_mfma_f32_16x16x32_bf16 v[24:27], v[216:219], v[148:151], v[24:27]
    ds_read_b64_tr_b16 v[176:177], v242 offset:256
    v_mfma_f32_16x16x32_bf16 v[56:59], v[216:219], v[152:155], v[56:59]
    ds_read_b64_tr_b16 v[178:179], v242 offset:4352
    v_mfma_f32_16x16x32_bf16 v[28:31], v[220:223], v[148:151], v[28:31]
    ds_read_b64_tr_b16 v[180:181], v230 offset:512
    v_mfma_f32_16x16x32_bf16 v[60:63], v[220:223], v[152:155], v[60:63]
    ds_read_b64_tr_b16 v[182:183], v230 offset:4608
    v_mfma_f32_16x16x32_bf16 v[68:71], v[196:199], v[156:159], v[68:71]
    ds_read_b64_tr_b16 v[184:185], v242 offset:512
    v_mfma_f32_16x16x32_bf16 v[72:75], v[200:203], v[156:159], v[72:75]
    ds_read_b64_tr_b16 v[186:187], v242 offset:4608
    v_mfma_f32_16x16x32_bf16 v[76:79], v[204:207], v[156:159], v[76:79]
    ds_read_b64_tr_b16 v[188:189], v244 offset:768
    v_mfma_f32_16x16x32_bf16 v[80:83], v[208:211], v[156:159], v[80:83]
    ds_read_b64_tr_b16 v[190:191], v244 offset:4864
    v_mfma_f32_16x16x32_bf16 v[84:87], v[212:215], v[156:159], v[84:87]
    ds_read_b128 v[140:143], v228 offset:2048
    v_mfma_f32_16x16x32_bf16 v[88:91], v[216:219], v[156:159], v[88:91]
    ds_read_b128 v[144:147], v228 offset:2304
    v_mfma_f32_16x16x32_bf16 v[92:95], v[220:223], v[156:159], v[92:95]
    v_mfma_f32_16x16x32_bf16 v[100:103], v[196:199], v[160:163], v[100:103]
    v_mfma_f32_16x16x32_bf16 v[104:107], v[200:203], v[160:163], v[104:107]
    v_mfma_f32_16x16x32_bf16 v[108:111], v[204:207], v[160:163], v[108:111]
    v_mfma_f32_16x16x32_bf16 v[112:115], v[208:211], v[160:163], v[112:115]
    v_mfma_f32_16x16x32_bf16 v[116:119], v[212:215], v[160:163], v[116:119]
    v_mfma_f32_16x16x32_bf16 v[120:123], v[216:219], v[160:163], v[120:123]
    v_mfma_f32_16x16x32_bf16 v[124:127], v[220:223], v[160:163], v[124:127]
    s_waitcnt lgkmcnt(15)
    v_mfma_f32_16x16x32_bf16 v[4:7], v[164:167], v[132:135], v[4:7]
    s_waitcnt vmcnt(0) lgkmcnt(0)
    v_mfma_f32_16x16x32_bf16 v[8:11], v[168:171], v[132:135], v[8:11]
    s_barrier
    v_mfma_f32_16x16x32_bf16 v[36:39], v[164:167], v[136:139], v[36:39]
    ds_read_b64_tr_b16 v[196:197], v230 offset:24576
    v_mfma_f32_16x16x32_bf16 v[40:43], v[168:171], v[136:139], v[40:43]
    ds_read_b64_tr_b16 v[198:199], v230 offset:28672
    v_mfma_f32_16x16x32_bf16 v[12:15], v[172:175], v[132:135], v[12:15]
    ds_read_b128 v[148:151], v228 offset:24576
    v_mfma_f32_16x16x32_bf16 v[44:47], v[172:175], v[136:139], v[44:47]
    ds_read_b64_tr_b16 v[200:201], v242 offset:24576
    v_mfma_f32_16x16x32_bf16 v[16:19], v[176:179], v[132:135], v[16:19]
    ds_read_b64_tr_b16 v[202:203], v242 offset:28672
    v_mfma_f32_16x16x32_bf16 v[48:51], v[176:179], v[136:139], v[48:51]
    ds_read_b128 v[152:155], v228 offset:24832
    v_mfma_f32_16x16x32_bf16 v[20:23], v[180:183], v[132:135], v[20:23]
    ds_read_b64_tr_b16 v[204:205], v230 offset:24832
    v_mfma_f32_16x16x32_bf16 v[52:55], v[180:183], v[136:139], v[52:55]
    ds_read_b64_tr_b16 v[206:207], v230 offset:28928
    v_mfma_f32_16x16x32_bf16 v[24:27], v[184:187], v[132:135], v[24:27]
    ds_read_b64_tr_b16 v[208:209], v242 offset:24832
    v_mfma_f32_16x16x32_bf16 v[56:59], v[184:187], v[136:139], v[56:59]
    ds_read_b64_tr_b16 v[210:211], v242 offset:28928
    v_mfma_f32_16x16x32_bf16 v[28:31], v[188:191], v[132:135], v[28:31]
    ds_read_b64_tr_b16 v[212:213], v230 offset:25088
    v_mfma_f32_16x16x32_bf16 v[60:63], v[188:191], v[136:139], v[60:63]
    ds_read_b64_tr_b16 v[214:215], v230 offset:29184
    v_mfma_f32_16x16x32_bf16 v[68:71], v[164:167], v[140:143], v[68:71]
    ds_read_b64_tr_b16 v[216:217], v242 offset:25088
    v_mfma_f32_16x16x32_bf16 v[72:75], v[168:171], v[140:143], v[72:75]
    ds_read_b64_tr_b16 v[218:219], v242 offset:29184
    v_mfma_f32_16x16x32_bf16 v[76:79], v[172:175], v[140:143], v[76:79]
    ds_read_b64_tr_b16 v[220:221], v244 offset:25344
    v_mfma_f32_16x16x32_bf16 v[80:83], v[176:179], v[140:143], v[80:83]
    ds_read_b64_tr_b16 v[222:223], v244 offset:29440
    v_mfma_f32_16x16x32_bf16 v[84:87], v[180:183], v[140:143], v[84:87]
    ds_read_b128 v[156:159], v228 offset:26624
    v_mfma_f32_16x16x32_bf16 v[88:91], v[184:187], v[140:143], v[88:91]
    ds_read_b128 v[160:163], v228 offset:26880
    v_mfma_f32_16x16x32_bf16 v[92:95], v[188:191], v[140:143], v[92:95]
    v_mfma_f32_16x16x32_bf16 v[100:103], v[164:167], v[144:147], v[100:103]
    v_mfma_f32_16x16x32_bf16 v[104:107], v[168:171], v[144:147], v[104:107]
    v_mfma_f32_16x16x32_bf16 v[108:111], v[172:175], v[144:147], v[108:111]
    v_mfma_f32_16x16x32_bf16 v[112:115], v[176:179], v[144:147], v[112:115]
    v_mfma_f32_16x16x32_bf16 v[116:119], v[180:183], v[144:147], v[116:119]
    v_mfma_f32_16x16x32_bf16 v[120:123], v[184:187], v[144:147], v[120:123]
    v_mfma_f32_16x16x32_bf16 v[124:127], v[188:191], v[144:147], v[124:127]
    s_waitcnt lgkmcnt(15)
    v_mfma_f32_16x16x32_bf16 v[4:7], v[196:199], v[148:151], v[4:7]
    s_waitcnt lgkmcnt(13)
    v_mfma_f32_16x16x32_bf16 v[8:11], v[200:203], v[148:151], v[8:11]
    s_waitcnt lgkmcnt(12)
    v_mfma_f32_16x16x32_bf16 v[36:39], v[196:199], v[152:155], v[36:39]
    v_mfma_f32_16x16x32_bf16 v[40:43], v[200:203], v[152:155], v[40:43]
    s_waitcnt lgkmcnt(10)
    v_mfma_f32_16x16x32_bf16 v[12:15], v[204:207], v[148:151], v[12:15]
    v_mfma_f32_16x16x32_bf16 v[44:47], v[204:207], v[152:155], v[44:47]
    s_waitcnt lgkmcnt(8)
    v_mfma_f32_16x16x32_bf16 v[16:19], v[208:211], v[148:151], v[16:19]
    v_mfma_f32_16x16x32_bf16 v[48:51], v[208:211], v[152:155], v[48:51]
    s_waitcnt lgkmcnt(6)
    v_mfma_f32_16x16x32_bf16 v[20:23], v[212:215], v[148:151], v[20:23]
    v_mfma_f32_16x16x32_bf16 v[52:55], v[212:215], v[152:155], v[52:55]
    s_waitcnt lgkmcnt(4)
    v_mfma_f32_16x16x32_bf16 v[24:27], v[216:219], v[148:151], v[24:27]
    v_mfma_f32_16x16x32_bf16 v[56:59], v[216:219], v[152:155], v[56:59]
    s_waitcnt lgkmcnt(2)
    v_mfma_f32_16x16x32_bf16 v[28:31], v[220:223], v[148:151], v[28:31]
    v_mfma_f32_16x16x32_bf16 v[60:63], v[220:223], v[152:155], v[60:63]
    s_waitcnt lgkmcnt(1)
    v_mfma_f32_16x16x32_bf16 v[68:71], v[196:199], v[156:159], v[68:71]
    v_mfma_f32_16x16x32_bf16 v[72:75], v[200:203], v[156:159], v[72:75]
    v_mfma_f32_16x16x32_bf16 v[76:79], v[204:207], v[156:159], v[76:79]
    v_mfma_f32_16x16x32_bf16 v[80:83], v[208:211], v[156:159], v[80:83]
    v_mfma_f32_16x16x32_bf16 v[84:87], v[212:215], v[156:159], v[84:87]
    v_mfma_f32_16x16x32_bf16 v[88:91], v[216:219], v[156:159], v[88:91]
    v_mfma_f32_16x16x32_bf16 v[92:95], v[220:223], v[156:159], v[92:95]
    s_waitcnt lgkmcnt(0)
    v_mfma_f32_16x16x32_bf16 v[100:103], v[196:199], v[160:163], v[100:103]
    v_mfma_f32_16x16x32_bf16 v[104:107], v[200:203], v[160:163], v[104:107]
    v_mfma_f32_16x16x32_bf16 v[108:111], v[204:207], v[160:163], v[108:111]
    v_mfma_f32_16x16x32_bf16 v[112:115], v[208:211], v[160:163], v[112:115]
    v_mfma_f32_16x16x32_bf16 v[116:119], v[212:215], v[160:163], v[116:119]
    v_mfma_f32_16x16x32_bf16 v[120:123], v[216:219], v[160:163], v[120:123]
    v_mfma_f32_16x16x32_bf16 v[124:127], v[220:223], v[160:163], v[124:127]
    s_nop 15
    s_setprio 2
    s_lshr_b32 s38, s2, 4
    s_lshl_b32 s38, s38, 2
    s_add_u32 s38, s38, s30
    s_lshl_b32 s38, s38, 10
    s_cmp_ge_u32 s38, code_end-k2_g4
    s_cbranch_scc1 cpf_g3c_end
    s_getpc_b64 s[36:37]
cpf_g3c:
    s_add_u32 s38, s38, k2_g4-cpf_g3c+0x10000
    s_sub_u32 s36, s36, 0x10000
    s_subb_u32 s37, s37, 0
    v_lshl_add_u32 v220, v232, 4, s38
    v_mov_b32 v221, s37
    v_add_co_u32 v220, vcc, s36, v220
    s_nop 1
    v_addc_co_u32 v221, vcc, 0, v221, vcc
    global_load_dwordx4 v[224:227], v[220:221], off
cpf_g3c_end:
    s_mov_b32 s63, 41780224
    v_mov_b32 v239, 0
    s_mov_b32 s65, 0
k2_pl7:
    buffer_load_dword v240, v239, s[8:11], s63 offen sc1
    s_waitcnt vmcnt(0)
    v_readfirstlane_b32 s64, v240
    s_nop 3
    s_cmp_ge_u32 s64, 256
    s_cbranch_scc1 k2_pk7
    s_add_u32 s65, s65, 1
    s_sleep 8
    s_cmp_lt_u32 s65, 0x40000
    s_cbranch_scc1 k2_pl7
k2_pk7:
    v_lshlrev_b32 v241, 2, v0
    s_lshl_b32 s63, s58, 2
    s_add_u32 s63, s63, 41500672
    buffer_load_dword v196, v241, s[8:11], s63 offen sc1
    s_add_u32 s63, s63, 14336
    buffer_load_dword v197, v241, s[8:11], s63 offen sc1
    s_add_u32 s63, s63, 14336
    buffer_load_dword v198, v241, s[8:11], s63 offen sc1
    s_add_u32 s63, s63, 14336
    buffer_load_dword v199, v241, s[8:11], s63 offen sc1
    s_add_u32 s63, s63, 14336
    buffer_load_dword v200, v241, s[8:11], s63 offen sc1
    s_add_u32 s63, s63, 14336
    buffer_load_dword v201, v241, s[8:11], s63 offen sc1
    s_add_u32 s63, s63, 14336
    buffer_load_dword v202, v241, s[8:11], s63 offen sc1
    s_add_u32 s63, s63, 14336
    buffer_load_dword v203, v241, s[8:11], s63 offen sc1
    s_add_u32 s63, s63, 14336
    buffer_load_dword v204, v241, s[8:11], s63 offen sc1
    s_add_u32 s63, s63, 14336
    buffer_load_dword v205, v241, s[8:11], s63 offen sc1
    s_add_u32 s63, s63, 14336
    buffer_load_dword v206, v241, s[8:11], s63 offen sc1
    s_add_u32 s63, s63, 14336
    buffer_load_dword v207, v241, s[8:11], s63 offen sc1
    s_add_u32 s63, s63, 14336
    buffer_load_dword v208, v241, s[8:11], s63 offen sc1
    s_add_u32 s63, s63, 14336
    buffer_load_dword v209, v241, s[8:11], s63 offen sc1
    s_add_u32 s63, s63, 14336
    buffer_load_dword v210, v241, s[8:11], s63 offen sc1
    s_add_u32 s63, s63, 14336
    buffer_load_dword v211, v241, s[8:11], s63 offen sc1
    s_add_u32 s63, s63, 14336
    v_and_b32 v238, 127, v0
    s_lshl_b32 s63, s59, 2
    s_add_u32 s63, s63, 41164800
    v_lshlrev_b32 v240, 2, v238
    buffer_load_dword v192, v240, s[8:11], s63 offen sc1
    s_lshl_b32 s63, s59, 3
    s_add_u32 s63, s63, 40894464
    v_lshlrev_b32 v240, 3, v238
    buffer_load_dwordx2 v[132:133], v240, s[8:11], s63 offen sc1
    s_add_u32 s63, s63, 16384
    buffer_load_dwordx2 v[134:135], v240, s[8:11], s63 offen sc1
    s_add_u32 s63, s63, 16384
    buffer_load_dwordx2 v[136:137], v240, s[8:11], s63 offen sc1
    s_add_u32 s63, s63, 16384
    buffer_load_dwordx2 v[138:139], v240, s[8:11], s63 offen sc1
    s_add_u32 s63, s63, 16384
    buffer_load_dwordx2 v[140:141], v240, s[8:11], s63 offen sc1
    s_add_u32 s63, s63, 16384
    buffer_load_dwordx2 v[142:143], v240, s[8:11], s63 offen sc1
    s_add_u32 s63, s63, 16384
    buffer_load_dwordx2 v[144:145], v240, s[8:11], s63 offen sc1
    s_add_u32 s63, s63, 16384
    buffer_load_dwordx2 v[146:147], v240, s[8:11], s63 offen sc1
    s_add_u32 s63, s63, 16384
    buffer_load_dwordx2 v[148:149], v240, s[8:11], s63 offen sc1
    s_add_u32 s63, s63, 16384
    buffer_load_dwordx2 v[150:151], v240, s[8:11], s63 offen sc1
    s_add_u32 s63, s63, 16384
    buffer_load_dwordx2 v[152:153], v240, s[8:11], s63 offen sc1
    s_add_u32 s63, s63, 16384
    buffer_load_dwordx2 v[154:155], v240, s[8:11], s63 offen sc1
    s_add_u32 s63, s63, 16384
    buffer_load_dwordx2 v[156:157], v240, s[8:11], s63 offen sc1
    s_add_u32 s63, s63, 16384
    buffer_load_dwordx2 v[158:159], v240, s[8:11], s63 offen sc1
    s_add_u32 s63, s63, 16384
    buffer_load_dwordx2 v[160:161], v240, s[8:11], s63 offen sc1
    s_add_u32 s63, s63, 16384
    buffer_load_dwordx2 v[162:163], v240, s[8:11], s63 offen sc1
    s_add_u32 s63, s63, 16384
    s_waitcnt vmcnt(17)
    v_add_f32 v196, v196, v197
    v_add_f32 v196, v196, v198
    v_add_f32 v196, v196, v199
    v_add_f32 v196, v196, v200
    v_add_f32 v196, v196, v201
    v_add_f32 v196, v196, v202
    v_add_f32 v196, v196, v203
    v_add_f32 v196, v196, v204
    v_add_f32 v196, v196, v205
    v_add_f32 v196, v196, v206
    v_add_f32 v196, v196, v207
    v_add_f32 v196, v196, v208
    v_add_f32 v196, v196, v209
    v_add_f32 v196, v196, v210
    v_add_f32 v196, v196, v211
    v_add_u32 v241, 77824, v241
    ds_write_b32 v241, v196
    s_waitcnt vmcnt(0)
    v_pk_add_f32 v[132:133], v[132:133], v[134:135]
    v_pk_add_f32 v[132:133], v[132:133], v[136:137]
    v_pk_add_f32 v[132:133], v[132:133], v[138:139]
    v_pk_add_f32 v[132:133], v[132:133], v[140:141]
    v_pk_add_f32 v[132:133], v[132:133], v[142:143]
    v_pk_add_f32 v[132:133], v[132:133], v[144:145]
    v_pk_add_f32 v[132:133], v[132:133], v[146:147]
    v_pk_add_f32 v[132:133], v[132:133], v[148:149]
    v_pk_add_f32 v[132:133], v[132:133], v[150:151]
    v_pk_add_f32 v[132:133], v[132:133], v[152:153]
    v_pk_add_f32 v[132:133], v[132:133], v[154:155]
    v_pk_add_f32 v[132:133], v[132:133], v[156:157]
    v_pk_add_f32 v[132:133], v[132:133], v[158:159]
    v_pk_add_f32 v[132:133], v[132:133], v[160:161]
    v_pk_add_f32 v[132:133], v[132:133], v[162:163]
    v_mul_f32 v132, 0x3a800000, v132
    v_mul_f32 v133, 0x3a800000, v133
    v_fma_f32 v239, -v132, v132, v133
    v_max_f32 v239, 0, v239
    v_cvt_pk_bf16_f32 v239, v239, v239
    v_lshlrev_b32 v239, 16, v239
    v_add_f32 v239, 0x3727c5ac, v239
    v_cvt_pk_bf16_f32 v239, v239, v239
    v_lshlrev_b32 v239, 16, v239
    v_sqrt_f32 v239, v239
    s_nop 0
    v_cvt_pk_bf16_f32 v239, v239, v239
    v_lshlrev_b32 v239, 16, v239
    v_rcp_f32 v137, v239
    s_nop 0
    v_cvt_pk_bf16_f32 v136, v132, v132
    v_lshlrev_b32 v136, 16, v136
    v_mul_f32 v239, v137, v137
    v_mul_f32 v239, v239, v137
    v_mul_f32 v214, 0xbdd2d3e8, v239
    v_mul_f32 v215, v137, v192
    v_max_f32 v215, 0xda24260, v215
    v_mul_f32 v213, 0xc0135761, v137
    v_mov_b32 v212, v136
    v_rcp_f32 v215, v215
    s_nop 0
    v_lshlrev_b32 v240, 4, v238
    v_add_u32 v240, 73728, v240
    ds_write_b128 v240, v[212:215]
    v_and_b32 v238, 15, v232
    v_lshrrev_b32 v241, 4, v232
    s_lshl_b32 s63, s53, 10
    s_add_u32 s63, s63, 73728
    v_lshl_add_u32 v239, v238, 4, s63
    v_lshlrev_b32 v238, 4, v238
    v_lshl_add_u32 v238, v241, 9, v238
    s_lshl_b32 s63, s54, 9
    s_add_u32 s63, s63, 77824
    v_lshl_add_u32 v240, v241, 4, s63
    s_lshl_b32 s63, s54, 6
    s_add_u32 s63, s63, 78208
    v_lshl_add_u32 v241, v241, 4, s63
    s_waitcnt lgkmcnt(0)
    s_barrier
    ds_read_b128 v[164:167], v240 offset:0
    ds_read_b128 v[168:171], v240 offset:64
    ds_read_b128 v[172:175], v240 offset:128
    ds_read_b128 v[176:179], v240 offset:192
    ds_read_b128 v[180:183], v240 offset:256
    ds_read_b128 v[184:187], v240 offset:320
    ds_read_b128 v[188:191], v241
    ds_read_b128 v[204:207], v239
    s_lshr_b32 s63, s59, 5
    s_lshl_b32 s64, s53, 1
    s_add_u32 s63, s63, s64
    s_mul_i32 s63, s63, 288
    s_mul_i32 s64, s40, 14
    s_add_u32 s63, s63, s64
    s_add_u32 s63, s63, 64
    s_lshl_b32 s63, s63, 10
    s_add_u32 s63, s63, 20971520
    s_lshl_b32 s64, s54, 3
    s_add_u32 s56, s63, s64
    s_add_u32 s56, s56, 6144
    s_lshl_b32 s64, s54, 13
    s_add_u32 s42, s63, s64
    s_add_u32 s55, s42, 4096
    s_waitcnt lgkmcnt(0)
    v_mov_b32 v196, v204
    v_mov_b32 v197, v204
    v_mov_b32 v198, v205
    v_mov_b32 v199, v205
    v_mov_b32 v200, v206
    v_mov_b32 v201, v206
    v_mov_b32 v202, v207
    v_mov_b32 v203, v207
    ds_read_b128 v[208:211], v239 offset:256
    v_pk_fma_f32 v[4:5], v[164:165], v[196:197], v[4:5] neg_lo:[0,1,0] neg_hi:[0,1,0]
    v_pk_fma_f32 v[6:7], v[166:167], v[196:197], v[6:7] neg_lo:[0,1,0] neg_hi:[0,1,0]
    v_pk_fma_f32 v[8:9], v[168:169], v[196:197], v[8:9] neg_lo:[0,1,0] neg_hi:[0,1,0]
    v_pk_fma_f32 v[10:11], v[170:171], v[196:197], v[10:11] neg_lo:[0,1,0] neg_hi:[0,1,0]
    v_pk_mul_f32 v[140:141], v[4:5], v[4:5]
    v_pk_mul_f32 v[142:143], v[6:7], v[6:7]
    v_pk_mul_f32 v[144:145], v[8:9], v[8:9]
    v_pk_mul_f32 v[146:147], v[10:11], v[10:11]
    v_pk_fma_f32 v[140:141], v[140:141], v[200:201], v[198:199]
    v_pk_fma_f32 v[142:143], v[142:143], v[200:201], v[198:199]
    v_pk_fma_f32 v[144:145], v[144:145], v[200:201], v[198:199]
    v_pk_fma_f32 v[146:147], v[146:147], v[200:201], v[198:199]
    v_pk_mul_f32 v[140:141], v[140:141], v[4:5]
    v_pk_mul_f32 v[142:143], v[142:143], v[6:7]
    v_pk_mul_f32 v[144:145], v[144:145], v[8:9]
    v_pk_mul_f32 v[146:147], v[146:147], v[10:11]
    v_exp_f32 v140, v140
    v_exp_f32 v141, v141
    v_exp_f32 v142, v142
    v_exp_f32 v143, v143
    v_exp_f32 v144, v144
    v_exp_f32 v145, v145
    v_exp_f32 v146, v146
    v_exp_f32 v147, v147
    s_nop 0
    v_pk_fma_f32 v[140:141], v[140:141], v[202:203], v[202:203]
    v_pk_fma_f32 v[142:143], v[142:143], v[202:203], v[202:203]
    v_pk_fma_f32 v[144:145], v[144:145], v[202:203], v[202:203]
    v_pk_fma_f32 v[146:147], v[146:147], v[202:203], v[202:203]
    v_rcp_f32 v140, v140
    v_rcp_f32 v141, v141
    v_rcp_f32 v142, v142
    v_rcp_f32 v143, v143
    v_rcp_f32 v144, v144
    v_rcp_f32 v145, v145
    v_rcp_f32 v146, v146
    v_rcp_f32 v147, v147
    s_nop 0
    v_pk_mul_f32 v[140:141], v[140:141], v[4:5]
    v_pk_mul_f32 v[142:143], v[142:143], v[6:7]
    v_pk_mul_f32 v[144:145], v[144:145], v[8:9]
    v_pk_mul_f32 v[146:147], v[146:147], v[10:11]
    v_cvt_pk_bf16_f32 v148, v140, v141
    v_cvt_pk_bf16_f32 v149, v142, v143
    v_cvt_pk_bf16_f32 v150, v144, v145
    v_cvt_pk_bf16_f32 v151, v146, v147
    buffer_store_dwordx4 v[148:151], v238, s[8:11], s42 offen offset:0 sc1
    v_pk_fma_f32 v[12:13], v[172:173], v[196:197], v[12:13] neg_lo:[0,1,0] neg_hi:[0,1,0]
    v_pk_fma_f32 v[14:15], v[174:175], v[196:197], v[14:15] neg_lo:[0,1,0] neg_hi:[0,1,0]
    v_pk_fma_f32 v[16:17], v[176:177], v[196:197], v[16:17] neg_lo:[0,1,0] neg_hi:[0,1,0]
    v_pk_fma_f32 v[18:19], v[178:179], v[196:197], v[18:19] neg_lo:[0,1,0] neg_hi:[0,1,0]
    v_pk_mul_f32 v[132:133], v[12:13], v[12:13]
    v_pk_mul_f32 v[134:135], v[14:15], v[14:15]
    v_pk_mul_f32 v[136:137], v[16:17], v[16:17]
    v_pk_mul_f32 v[138:139], v[18:19], v[18:19]
    v_pk_fma_f32 v[132:133], v[132:133], v[200:201], v[198:199]
    v_pk_fma_f32 v[134:135], v[134:135], v[200:201], v[198:199]
    v_pk_fma_f32 v[136:137], v[136:137], v[200:201], v[198:199]
    v_pk_fma_f32 v[138:139], v[138:139], v[200:201], v[198:199]
    v_pk_mul_f32 v[132:133], v[132:133], v[12:13]
    v_pk_mul_f32 v[134:135], v[134:135], v[14:15]
    v_pk_mul_f32 v[136:137], v[136:137], v[16:17]
    v_pk_mul_f32 v[138:139], v[138:139], v[18:19]
    v_exp_f32 v132, v132
    v_exp_f32 v133, v133
    v_exp_f32 v134, v134
    v_exp_f32 v135, v135
    v_exp_f32 v136, v136
    v_exp_f32 v137, v137
    v_exp_f32 v138, v138
    v_exp_f32 v139, v139
    s_nop 0
    v_pk_fma_f32 v[132:133], v[132:133], v[202:203], v[202:203]
    v_pk_fma_f32 v[134:135], v[134:135], v[202:203], v[202:203]
    v_pk_fma_f32 v[136:137], v[136:137], v[202:203], v[202:203]
    v_pk_fma_f32 v[138:139], v[138:139], v[202:203], v[202:203]
    v_rcp_f32 v132, v132
    v_rcp_f32 v133, v133
    v_rcp_f32 v134, v134
    v_rcp_f32 v135, v135
    v_rcp_f32 v136, v136
    v_rcp_f32 v137, v137
    v_rcp_f32 v138, v138
    v_rcp_f32 v139, v139
    s_nop 0
    v_pk_mul_f32 v[132:133], v[132:133], v[12:13]
    v_pk_mul_f32 v[134:135], v[134:135], v[14:15]
    v_pk_mul_f32 v[136:137], v[136:137], v[16:17]
    v_pk_mul_f32 v[138:139], v[138:139], v[18:19]
    v_cvt_pk_bf16_f32 v152, v132, v133
    v_cvt_pk_bf16_f32 v153, v134, v135
    v_cvt_pk_bf16_f32 v154, v136, v137
    v_cvt_pk_bf16_f32 v155, v138, v139
    buffer_store_dwordx4 v[152:155], v238, s[8:11], s42 offen offset:2048 sc1
    v_pk_fma_f32 v[20:21], v[180:181], v[196:197], v[20:21] neg_lo:[0,1,0] neg_hi:[0,1,0]
    v_pk_fma_f32 v[22:23], v[182:183], v[196:197], v[22:23] neg_lo:[0,1,0] neg_hi:[0,1,0]
    v_pk_fma_f32 v[24:25], v[184:185], v[196:197], v[24:25] neg_lo:[0,1,0] neg_hi:[0,1,0]
    v_pk_fma_f32 v[26:27], v[186:187], v[196:197], v[26:27] neg_lo:[0,1,0] neg_hi:[0,1,0]
    v_pk_mul_f32 v[140:141], v[20:21], v[20:21]
    v_pk_mul_f32 v[142:143], v[22:23], v[22:23]
    v_pk_mul_f32 v[144:145], v[24:25], v[24:25]
    v_pk_mul_f32 v[146:147], v[26:27], v[26:27]
    v_pk_fma_f32 v[140:141], v[140:141], v[200:201], v[198:199]
    v_pk_fma_f32 v[142:143], v[142:143], v[200:201], v[198:199]
    v_pk_fma_f32 v[144:145], v[144:145], v[200:201], v[198:199]
    v_pk_fma_f32 v[146:147], v[146:147], v[200:201], v[198:199]
    v_pk_mul_f32 v[140:141], v[140:141], v[20:21]
    v_pk_mul_f32 v[142:143], v[142:143], v[22:23]
    v_pk_mul_f32 v[144:145], v[144:145], v[24:25]
    v_pk_mul_f32 v[146:147], v[146:147], v[26:27]
    v_exp_f32 v140, v140
    v_exp_f32 v141, v141
    v_exp_f32 v142, v142
    v_exp_f32 v143, v143
    v_exp_f32 v144, v144
    v_exp_f32 v145, v145
    v_exp_f32 v146, v146
    v_exp_f32 v147, v147
    s_nop 0
    v_pk_fma_f32 v[140:141], v[140:141], v[202:203], v[202:203]
    v_pk_fma_f32 v[142:143], v[142:143], v[202:203], v[202:203]
    v_pk_fma_f32 v[144:145], v[144:145], v[202:203], v[202:203]
    v_pk_fma_f32 v[146:147], v[146:147], v[202:203], v[202:203]
    v_rcp_f32 v140, v140
    v_rcp_f32 v141, v141
    v_rcp_f32 v142, v142
    v_rcp_f32 v143, v143
    v_rcp_f32 v144, v144
    v_rcp_f32 v145, v145
    v_rcp_f32 v146, v146
    v_rcp_f32 v147, v147
    s_nop 0
    v_pk_mul_f32 v[140:141], v[140:141], v[20:21]
    v_pk_mul_f32 v[142:143], v[142:143], v[22:23]
    v_pk_mul_f32 v[144:145], v[144:145], v[24:25]
    v_pk_mul_f32 v[146:147], v[146:147], v[26:27]
    v_cvt_pk_bf16_f32 v148, v140, v141
    v_cvt_pk_bf16_f32 v149, v142, v143
    v_cvt_pk_bf16_f32 v150, v144, v145
    v_cvt_pk_bf16_f32 v151, v146, v147
    buffer_store_dwordx4 v[148:151], v238, s[8:11], s55 offen offset:0 sc1
    v_pk_fma_f32 v[28:29], v[188:189], v[196:197], v[28:29] neg_lo:[0,1,0] neg_hi:[0,1,0]
    v_pk_fma_f32 v[30:31], v[190:191], v[196:197], v[30:31] neg_lo:[0,1,0] neg_hi:[0,1,0]
    v_pk_mul_f32 v[132:133], v[28:29], v[28:29]
    v_pk_mul_f32 v[134:135], v[30:31], v[30:31]
    v_pk_fma_f32 v[132:133], v[132:133], v[200:201], v[198:199]
    v_pk_fma_f32 v[134:135], v[134:135], v[200:201], v[198:199]
    v_pk_mul_f32 v[132:133], v[132:133], v[28:29]
    v_pk_mul_f32 v[134:135], v[134:135], v[30:31]
    v_exp_f32 v132, v132
    v_exp_f32 v133, v133
    v_exp_f32 v134, v134
    v_exp_f32 v135, v135
    s_nop 0
    v_pk_fma_f32 v[132:133], v[132:133], v[202:203], v[202:203]
    v_pk_fma_f32 v[134:135], v[134:135], v[202:203], v[202:203]
    v_rcp_f32 v132, v132
    v_rcp_f32 v133, v133
    v_rcp_f32 v134, v134
    v_rcp_f32 v135, v135
    s_nop 0
    v_pk_mul_f32 v[132:133], v[132:133], v[28:29]
    v_pk_mul_f32 v[134:135], v[134:135], v[30:31]
    v_cvt_pk_bf16_f32 v152, v132, v133
    v_cvt_pk_bf16_f32 v153, v134, v135
    buffer_store_dwordx2 v[152:153], v238, s[8:11], s56 offen offset:0 sc1
    s_waitcnt lgkmcnt(0)
    v_mov_b32 v196, v208
    v_mov_b32 v197, v208
    v_mov_b32 v198, v209
    v_mov_b32 v199, v209
    v_mov_b32 v200, v210
    v_mov_b32 v201, v210
    v_mov_b32 v202, v211
    v_mov_b32 v203, v211
    ds_read_b128 v[204:207], v239 offset:512
    v_pk_fma_f32 v[36:37], v[164:165], v[196:197], v[36:37] neg_lo:[0,1,0] neg_hi:[0,1,0]
    v_pk_fma_f32 v[38:39], v[166:167], v[196:197], v[38:39] neg_lo:[0,1,0] neg_hi:[0,1,0]
    v_pk_fma_f32 v[40:41], v[168:169], v[196:197], v[40:41] neg_lo:[0,1,0] neg_hi:[0,1,0]
    v_pk_fma_f32 v[42:43], v[170:171], v[196:197], v[42:43] neg_lo:[0,1,0] neg_hi:[0,1,0]
    v_pk_mul_f32 v[140:141], v[36:37], v[36:37]
    v_pk_mul_f32 v[142:143], v[38:39], v[38:39]
    v_pk_mul_f32 v[144:145], v[40:41], v[40:41]
    v_pk_mul_f32 v[146:147], v[42:43], v[42:43]
    v_pk_fma_f32 v[140:141], v[140:141], v[200:201], v[198:199]
    v_pk_fma_f32 v[142:143], v[142:143], v[200:201], v[198:199]
    v_pk_fma_f32 v[144:145], v[144:145], v[200:201], v[198:199]
    v_pk_fma_f32 v[146:147], v[146:147], v[200:201], v[198:199]
    v_pk_mul_f32 v[140:141], v[140:141], v[36:37]
    v_pk_mul_f32 v[142:143], v[142:143], v[38:39]
    v_pk_mul_f32 v[144:145], v[144:145], v[40:41]
    v_pk_mul_f32 v[146:147], v[146:147], v[42:43]
    v_exp_f32 v140, v140
    v_exp_f32 v141, v141
    v_exp_f32 v142, v142
    v_exp_f32 v143, v143
    v_exp_f32 v144, v144
    v_exp_f32 v145, v145
    v_exp_f32 v146, v146
    v_exp_f32 v147, v147
    s_nop 0
    v_pk_fma_f32 v[140:141], v[140:141], v[202:203], v[202:203]
    v_pk_fma_f32 v[142:143], v[142:143], v[202:203], v[202:203]
    v_pk_fma_f32 v[144:145], v[144:145], v[202:203], v[202:203]
    v_pk_fma_f32 v[146:147], v[146:147], v[202:203], v[202:203]
    v_rcp_f32 v140, v140
    v_rcp_f32 v141, v141
    v_rcp_f32 v142, v142
    v_rcp_f32 v143, v143
    v_rcp_f32 v144, v144
    v_rcp_f32 v145, v145
    v_rcp_f32 v146, v146
    v_rcp_f32 v147, v147
    s_nop 0
    v_pk_mul_f32 v[140:141], v[140:141], v[36:37]
    v_pk_mul_f32 v[142:143], v[142:143], v[38:39]
    v_pk_mul_f32 v[144:145], v[144:145], v[40:41]
    v_pk_mul_f32 v[146:147], v[146:147], v[42:43]
    v_cvt_pk_bf16_f32 v148, v140, v141
    v_cvt_pk_bf16_f32 v149, v142, v143
    v_cvt_pk_bf16_f32 v150, v144, v145
    v_cvt_pk_bf16_f32 v151, v146, v147
    buffer_store_dwordx4 v[148:151], v238, s[8:11], s42 offen offset:256 sc1
    v_pk_fma_f32 v[44:45], v[172:173], v[196:197], v[44:45] neg_lo:[0,1,0] neg_hi:[0,1,0]
    v_pk_fma_f32 v[46:47], v[174:175], v[196:197], v[46:47] neg_lo:[0,1,0] neg_hi:[0,1,0]
    v_pk_fma_f32 v[48:49], v[176:177], v[196:197], v[48:49] neg_lo:[0,1,0] neg_hi:[0,1,0]
    v_pk_fma_f32 v[50:51], v[178:179], v[196:197], v[50:51] neg_lo:[0,1,0] neg_hi:[0,1,0]
    v_pk_mul_f32 v[132:133], v[44:45], v[44:45]
    v_pk_mul_f32 v[134:135], v[46:47], v[46:47]
    v_pk_mul_f32 v[136:137], v[48:49], v[48:49]
    v_pk_mul_f32 v[138:139], v[50:51], v[50:51]
    v_pk_fma_f32 v[132:133], v[132:133], v[200:201], v[198:199]
    v_pk_fma_f32 v[134:135], v[134:135], v[200:201], v[198:199]
    v_pk_fma_f32 v[136:137], v[136:137], v[200:201], v[198:199]
    v_pk_fma_f32 v[138:139], v[138:139], v[200:201], v[198:199]
    v_pk_mul_f32 v[132:133], v[132:133], v[44:45]
    v_pk_mul_f32 v[134:135], v[134:135], v[46:47]
    v_pk_mul_f32 v[136:137], v[136:137], v[48:49]
    v_pk_mul_f32 v[138:139], v[138:139], v[50:51]
    v_exp_f32 v132, v132
    v_exp_f32 v133, v133
    v_exp_f32 v134, v134
    v_exp_f32 v135, v135
    v_exp_f32 v136, v136
    v_exp_f32 v137, v137
    v_exp_f32 v138, v138
    v_exp_f32 v139, v139
    s_nop 0
    v_pk_fma_f32 v[132:133], v[132:133], v[202:203], v[202:203]
    v_pk_fma_f32 v[134:135], v[134:135], v[202:203], v[202:203]
    v_pk_fma_f32 v[136:137], v[136:137], v[202:203], v[202:203]
    v_pk_fma_f32 v[138:139], v[138:139], v[202:203], v[202:203]
    v_rcp_f32 v132, v132
    v_rcp_f32 v133, v133
    v_rcp_f32 v134, v134
    v_rcp_f32 v135, v135
    v_rcp_f32 v136, v136
    v_rcp_f32 v137, v137
    v_rcp_f32 v138, v138
    v_rcp_f32 v139, v139
    s_nop 0
    v_pk_mul_f32 v[132:133], v[132:133], v[44:45]
    v_pk_mul_f32 v[134:135], v[134:135], v[46:47]
    v_pk_mul_f32 v[136:137], v[136:137], v[48:49]
    v_pk_mul_f32 v[138:139], v[138:139], v[50:51]
    v_cvt_pk_bf16_f32 v152, v132, v133
    v_cvt_pk_bf16_f32 v153, v134, v135
    v_cvt_pk_bf16_f32 v154, v136, v137
    v_cvt_pk_bf16_f32 v155, v138, v139
    buffer_store_dwordx4 v[152:155], v238, s[8:11], s42 offen offset:2304 sc1
    v_pk_fma_f32 v[52:53], v[180:181], v[196:197], v[52:53] neg_lo:[0,1,0] neg_hi:[0,1,0]
    v_pk_fma_f32 v[54:55], v[182:183], v[196:197], v[54:55] neg_lo:[0,1,0] neg_hi:[0,1,0]
    v_pk_fma_f32 v[56:57], v[184:185], v[196:197], v[56:57] neg_lo:[0,1,0] neg_hi:[0,1,0]
    v_pk_fma_f32 v[58:59], v[186:187], v[196:197], v[58:59] neg_lo:[0,1,0] neg_hi:[0,1,0]
    v_pk_mul_f32 v[140:141], v[52:53], v[52:53]
    v_pk_mul_f32 v[142:143], v[54:55], v[54:55]
    v_pk_mul_f32 v[144:145], v[56:57], v[56:57]
    v_pk_mul_f32 v[146:147], v[58:59], v[58:59]
    v_pk_fma_f32 v[140:141], v[140:141], v[200:201], v[198:199]
    v_pk_fma_f32 v[142:143], v[142:143], v[200:201], v[198:199]
    v_pk_fma_f32 v[144:145], v[144:145], v[200:201], v[198:199]
    v_pk_fma_f32 v[146:147], v[146:147], v[200:201], v[198:199]
    v_pk_mul_f32 v[140:141], v[140:141], v[52:53]
    v_pk_mul_f32 v[142:143], v[142:143], v[54:55]
    v_pk_mul_f32 v[144:145], v[144:145], v[56:57]
    v_pk_mul_f32 v[146:147], v[146:147], v[58:59]
    v_exp_f32 v140, v140
    v_exp_f32 v141, v141
    v_exp_f32 v142, v142
    v_exp_f32 v143, v143
    v_exp_f32 v144, v144
    v_exp_f32 v145, v145
    v_exp_f32 v146, v146
    v_exp_f32 v147, v147
    s_nop 0
    v_pk_fma_f32 v[140:141], v[140:141], v[202:203], v[202:203]
    v_pk_fma_f32 v[142:143], v[142:143], v[202:203], v[202:203]
    v_pk_fma_f32 v[144:145], v[144:145], v[202:203], v[202:203]
    v_pk_fma_f32 v[146:147], v[146:147], v[202:203], v[202:203]
    v_rcp_f32 v140, v140
    v_rcp_f32 v141, v141
    v_rcp_f32 v142, v142
    v_rcp_f32 v143, v143
    v_rcp_f32 v144, v144
    v_rcp_f32 v145, v145
    v_rcp_f32 v146, v146
    v_rcp_f32 v147, v147
    s_nop 0
    v_pk_mul_f32 v[140:141], v[140:141], v[52:53]
    v_pk_mul_f32 v[142:143], v[142:143], v[54:55]
    v_pk_mul_f32 v[144:145], v[144:145], v[56:57]
    v_pk_mul_f32 v[146:147], v[146:147], v[58:59]
    v_cvt_pk_bf16_f32 v148, v140, v141
    v_cvt_pk_bf16_f32 v149, v142, v143
    v_cvt_pk_bf16_f32 v150, v144, v145
    v_cvt_pk_bf16_f32 v151, v146, v147
    buffer_store_dwordx4 v[148:151], v238, s[8:11], s55 offen offset:256 sc1
    v_pk_fma_f32 v[60:61], v[188:189], v[196:197], v[60:61] neg_lo:[0,1,0] neg_hi:[0,1,0]
    v_pk_fma_f32 v[62:63], v[190:191], v[196:197], v[62:63] neg_lo:[0,1,0] neg_hi:[0,1,0]
    v_pk_mul_f32 v[132:133], v[60:61], v[60:61]
    v_pk_mul_f32 v[134:135], v[62:63], v[62:63]
    v_pk_fma_f32 v[132:133], v[132:133], v[200:201], v[198:199]
    v_pk_fma_f32 v[134:135], v[134:135], v[200:201], v[198:199]
    v_pk_mul_f32 v[132:133], v[132:133], v[60:61]
    v_pk_mul_f32 v[134:135], v[134:135], v[62:63]
    v_exp_f32 v132, v132
    v_exp_f32 v133, v133
    v_exp_f32 v134, v134
    v_exp_f32 v135, v135
    s_nop 0
    v_pk_fma_f32 v[132:133], v[132:133], v[202:203], v[202:203]
    v_pk_fma_f32 v[134:135], v[134:135], v[202:203], v[202:203]
    v_rcp_f32 v132, v132
    v_rcp_f32 v133, v133
    v_rcp_f32 v134, v134
    v_rcp_f32 v135, v135
    s_nop 0
    v_pk_mul_f32 v[132:133], v[132:133], v[60:61]
    v_pk_mul_f32 v[134:135], v[134:135], v[62:63]
    v_cvt_pk_bf16_f32 v152, v132, v133
    v_cvt_pk_bf16_f32 v153, v134, v135
    buffer_store_dwordx2 v[152:153], v238, s[8:11], s56 offen offset:256 sc1
    s_add_u32 s42, s42, 294912
    s_add_u32 s55, s55, 294912
    s_add_u32 s56, s56, 294912
    s_waitcnt lgkmcnt(0)
    v_mov_b32 v196, v204
    v_mov_b32 v197, v204
    v_mov_b32 v198, v205
    v_mov_b32 v199, v205
    v_mov_b32 v200, v206
    v_mov_b32 v201, v206
    v_mov_b32 v202, v207
    v_mov_b32 v203, v207
    ds_read_b128 v[208:211], v239 offset:768
    v_pk_fma_f32 v[68:69], v[164:165], v[196:197], v[68:69] neg_lo:[0,1,0] neg_hi:[0,1,0]
    v_pk_fma_f32 v[70:71], v[166:167], v[196:197], v[70:71] neg_lo:[0,1,0] neg_hi:[0,1,0]
    v_pk_fma_f32 v[72:73], v[168:169], v[196:197], v[72:73] neg_lo:[0,1,0] neg_hi:[0,1,0]
    v_pk_fma_f32 v[74:75], v[170:171], v[196:197], v[74:75] neg_lo:[0,1,0] neg_hi:[0,1,0]
    v_pk_mul_f32 v[140:141], v[68:69], v[68:69]
    v_pk_mul_f32 v[142:143], v[70:71], v[70:71]
    v_pk_mul_f32 v[144:145], v[72:73], v[72:73]
    v_pk_mul_f32 v[146:147], v[74:75], v[74:75]
    v_pk_fma_f32 v[140:141], v[140:141], v[200:201], v[198:199]
    v_pk_fma_f32 v[142:143], v[142:143], v[200:201], v[198:199]
    v_pk_fma_f32 v[144:145], v[144:145], v[200:201], v[198:199]
    v_pk_fma_f32 v[146:147], v[146:147], v[200:201], v[198:199]
    v_pk_mul_f32 v[140:141], v[140:141], v[68:69]
    v_pk_mul_f32 v[142:143], v[142:143], v[70:71]
    v_pk_mul_f32 v[144:145], v[144:145], v[72:73]
    v_pk_mul_f32 v[146:147], v[146:147], v[74:75]
    v_exp_f32 v140, v140
    v_exp_f32 v141, v141
    v_exp_f32 v142, v142
    v_exp_f32 v143, v143
    v_exp_f32 v144, v144
    v_exp_f32 v145, v145
    v_exp_f32 v146, v146
    v_exp_f32 v147, v147
    s_nop 0
    v_pk_fma_f32 v[140:141], v[140:141], v[202:203], v[202:203]
    v_pk_fma_f32 v[142:143], v[142:143], v[202:203], v[202:203]
    v_pk_fma_f32 v[144:145], v[144:145], v[202:203], v[202:203]
    v_pk_fma_f32 v[146:147], v[146:147], v[202:203], v[202:203]
    v_rcp_f32 v140, v140
    v_rcp_f32 v141, v141
    v_rcp_f32 v142, v142
    v_rcp_f32 v143, v143
    v_rcp_f32 v144, v144
    v_rcp_f32 v145, v145
    v_rcp_f32 v146, v146
    v_rcp_f32 v147, v147
    s_nop 0
    v_pk_mul_f32 v[140:141], v[140:141], v[68:69]
    v_pk_mul_f32 v[142:143], v[142:143], v[70:71]
    v_pk_mul_f32 v[144:145], v[144:145], v[72:73]
    v_pk_mul_f32 v[146:147], v[146:147], v[74:75]
    v_cvt_pk_bf16_f32 v148, v140, v141
    v_cvt_pk_bf16_f32 v149, v142, v143
    v_cvt_pk_bf16_f32 v150, v144, v145
    v_cvt_pk_bf16_f32 v151, v146, v147
    buffer_store_dwordx4 v[148:151], v238, s[8:11], s42 offen offset:0 sc1
    v_pk_fma_f32 v[76:77], v[172:173], v[196:197], v[76:77] neg_lo:[0,1,0] neg_hi:[0,1,0]
    v_pk_fma_f32 v[78:79], v[174:175], v[196:197], v[78:79] neg_lo:[0,1,0] neg_hi:[0,1,0]
    v_pk_fma_f32 v[80:81], v[176:177], v[196:197], v[80:81] neg_lo:[0,1,0] neg_hi:[0,1,0]
    v_pk_fma_f32 v[82:83], v[178:179], v[196:197], v[82:83] neg_lo:[0,1,0] neg_hi:[0,1,0]
    v_pk_mul_f32 v[132:133], v[76:77], v[76:77]
    v_pk_mul_f32 v[134:135], v[78:79], v[78:79]
    v_pk_mul_f32 v[136:137], v[80:81], v[80:81]
    v_pk_mul_f32 v[138:139], v[82:83], v[82:83]
    v_pk_fma_f32 v[132:133], v[132:133], v[200:201], v[198:199]
    v_pk_fma_f32 v[134:135], v[134:135], v[200:201], v[198:199]
    v_pk_fma_f32 v[136:137], v[136:137], v[200:201], v[198:199]
    v_pk_fma_f32 v[138:139], v[138:139], v[200:201], v[198:199]
    v_pk_mul_f32 v[132:133], v[132:133], v[76:77]
    v_pk_mul_f32 v[134:135], v[134:135], v[78:79]
    v_pk_mul_f32 v[136:137], v[136:137], v[80:81]
    v_pk_mul_f32 v[138:139], v[138:139], v[82:83]
    v_exp_f32 v132, v132
    v_exp_f32 v133, v133
    v_exp_f32 v134, v134
    v_exp_f32 v135, v135
    v_exp_f32 v136, v136
    v_exp_f32 v137, v137
    v_exp_f32 v138, v138
    v_exp_f32 v139, v139
    s_nop 0
    v_pk_fma_f32 v[132:133], v[132:133], v[202:203], v[202:203]
    v_pk_fma_f32 v[134:135], v[134:135], v[202:203], v[202:203]
    v_pk_fma_f32 v[136:137], v[136:137], v[202:203], v[202:203]
    v_pk_fma_f32 v[138:139], v[138:139], v[202:203], v[202:203]
    v_rcp_f32 v132, v132
    v_rcp_f32 v133, v133
    v_rcp_f32 v134, v134
    v_rcp_f32 v135, v135
    v_rcp_f32 v136, v136
    v_rcp_f32 v137, v137
    v_rcp_f32 v138, v138
    v_rcp_f32 v139, v139
    s_nop 0
    v_pk_mul_f32 v[132:133], v[132:133], v[76:77]
    v_pk_mul_f32 v[134:135], v[134:135], v[78:79]
    v_pk_mul_f32 v[136:137], v[136:137], v[80:81]
    v_pk_mul_f32 v[138:139], v[138:139], v[82:83]
    v_cvt_pk_bf16_f32 v152, v132, v133
    v_cvt_pk_bf16_f32 v153, v134, v135
    v_cvt_pk_bf16_f32 v154, v136, v137
    v_cvt_pk_bf16_f32 v155, v138, v139
    buffer_store_dwordx4 v[152:155], v238, s[8:11], s42 offen offset:2048 sc1
    v_pk_fma_f32 v[84:85], v[180:181], v[196:197], v[84:85] neg_lo:[0,1,0] neg_hi:[0,1,0]
    v_pk_fma_f32 v[86:87], v[182:183], v[196:197], v[86:87] neg_lo:[0,1,0] neg_hi:[0,1,0]
    v_pk_fma_f32 v[88:89], v[184:185], v[196:197], v[88:89] neg_lo:[0,1,0] neg_hi:[0,1,0]
    v_pk_fma_f32 v[90:91], v[186:187], v[196:197], v[90:91] neg_lo:[0,1,0] neg_hi:[0,1,0]
    v_pk_mul_f32 v[140:141], v[84:85], v[84:85]
    v_pk_mul_f32 v[142:143], v[86:87], v[86:87]
    v_pk_mul_f32 v[144:145], v[88:89], v[88:89]
    v_pk_mul_f32 v[146:147], v[90:91], v[90:91]
    v_pk_fma_f32 v[140:141], v[140:141], v[200:201], v[198:199]
    v_pk_fma_f32 v[142:143], v[142:143], v[200:201], v[198:199]
    v_pk_fma_f32 v[144:145], v[144:145], v[200:201], v[198:199]
    v_pk_fma_f32 v[146:147], v[146:147], v[200:201], v[198:199]
    v_pk_mul_f32 v[140:141], v[140:141], v[84:85]
    v_pk_mul_f32 v[142:143], v[142:143], v[86:87]
    v_pk_mul_f32 v[144:145], v[144:145], v[88:89]
    v_pk_mul_f32 v[146:147], v[146:147], v[90:91]
    v_exp_f32 v140, v140
    v_exp_f32 v141, v141
    v_exp_f32 v142, v142
    v_exp_f32 v143, v143
    v_exp_f32 v144, v144
    v_exp_f32 v145, v145
    v_exp_f32 v146, v146
    v_exp_f32 v147, v147
    s_nop 0
    v_pk_fma_f32 v[140:141], v[140:141], v[202:203], v[202:203]
    v_pk_fma_f32 v[142:143], v[142:143], v[202:203], v[202:203]
    v_pk_fma_f32 v[144:145], v[144:145], v[202:203], v[202:203]
    v_pk_fma_f32 v[146:147], v[146:147], v[202:203], v[202:203]
    v_rcp_f32 v140, v140
    v_rcp_f32 v141, v141
    v_rcp_f32 v142, v142
    v_rcp_f32 v143, v143
    v_rcp_f32 v144, v144
    v_rcp_f32 v145, v145
    v_rcp_f32 v146, v146
    v_rcp_f32 v147, v147
    s_nop 0
    v_pk_mul_f32 v[140:141], v[140:141], v[84:85]
    v_pk_mul_f32 v[142:143], v[142:143], v[86:87]
    v_pk_mul_f32 v[144:145], v[144:145], v[88:89]
    v_pk_mul_f32 v[146:147], v[146:147], v[90:91]
    v_cvt_pk_bf16_f32 v148, v140, v141
    v_cvt_pk_bf16_f32 v149, v142, v143
    v_cvt_pk_bf16_f32 v150, v144, v145
    v_cvt_pk_bf16_f32 v151, v146, v147
    buffer_store_dwordx4 v[148:151], v238, s[8:11], s55 offen offset:0 sc1
    v_pk_fma_f32 v[92:93], v[188:189], v[196:197], v[92:93] neg_lo:[0,1,0] neg_hi:[0,1,0]
    v_pk_fma_f32 v[94:95], v[190:191], v[196:197], v[94:95] neg_lo:[0,1,0] neg_hi:[0,1,0]
    v_pk_mul_f32 v[132:133], v[92:93], v[92:93]
    v_pk_mul_f32 v[134:135], v[94:95], v[94:95]
    v_pk_fma_f32 v[132:133], v[132:133], v[200:201], v[198:199]
    v_pk_fma_f32 v[134:135], v[134:135], v[200:201], v[198:199]
    v_pk_mul_f32 v[132:133], v[132:133], v[92:93]
    v_pk_mul_f32 v[134:135], v[134:135], v[94:95]
    v_exp_f32 v132, v132
    v_exp_f32 v133, v133
    v_exp_f32 v134, v134
    v_exp_f32 v135, v135
    s_nop 0
    v_pk_fma_f32 v[132:133], v[132:133], v[202:203], v[202:203]
    v_pk_fma_f32 v[134:135], v[134:135], v[202:203], v[202:203]
    v_rcp_f32 v132, v132
    v_rcp_f32 v133, v133
    v_rcp_f32 v134, v134
    v_rcp_f32 v135, v135
    s_nop 0
    v_pk_mul_f32 v[132:133], v[132:133], v[92:93]
    v_pk_mul_f32 v[134:135], v[134:135], v[94:95]
    v_cvt_pk_bf16_f32 v152, v132, v133
    v_cvt_pk_bf16_f32 v153, v134, v135
    buffer_store_dwordx2 v[152:153], v238, s[8:11], s56 offen offset:0 sc1
    s_waitcnt lgkmcnt(0)
    v_mov_b32 v196, v208
    v_mov_b32 v197, v208
    v_mov_b32 v198, v209
    v_mov_b32 v199, v209
    v_mov_b32 v200, v210
    v_mov_b32 v201, v210
    v_mov_b32 v202, v211
    v_mov_b32 v203, v211
    v_pk_fma_f32 v[100:101], v[164:165], v[196:197], v[100:101] neg_lo:[0,1,0] neg_hi:[0,1,0]
    v_pk_fma_f32 v[102:103], v[166:167], v[196:197], v[102:103] neg_lo:[0,1,0] neg_hi:[0,1,0]
    v_pk_fma_f32 v[104:105], v[168:169], v[196:197], v[104:105] neg_lo:[0,1,0] neg_hi:[0,1,0]
    v_pk_fma_f32 v[106:107], v[170:171], v[196:197], v[106:107] neg_lo:[0,1,0] neg_hi:[0,1,0]
    v_pk_mul_f32 v[140:141], v[100:101], v[100:101]
    v_pk_mul_f32 v[142:143], v[102:103], v[102:103]
    v_pk_mul_f32 v[144:145], v[104:105], v[104:105]
    v_pk_mul_f32 v[146:147], v[106:107], v[106:107]
    v_pk_fma_f32 v[140:141], v[140:141], v[200:201], v[198:199]
    v_pk_fma_f32 v[142:143], v[142:143], v[200:201], v[198:199]
    v_pk_fma_f32 v[144:145], v[144:145], v[200:201], v[198:199]
    v_pk_fma_f32 v[146:147], v[146:147], v[200:201], v[198:199]
    v_pk_mul_f32 v[140:141], v[140:141], v[100:101]
    v_pk_mul_f32 v[142:143], v[142:143], v[102:103]
    v_pk_mul_f32 v[144:145], v[144:145], v[104:105]
    v_pk_mul_f32 v[146:147], v[146:147], v[106:107]
    v_exp_f32 v140, v140
    v_exp_f32 v141, v141
    v_exp_f32 v142, v142
    v_exp_f32 v143, v143
    v_exp_f32 v144, v144
    v_exp_f32 v145, v145
    v_exp_f32 v146, v146
    v_exp_f32 v147, v147
    s_nop 0
    v_pk_fma_f32 v[140:141], v[140:141], v[202:203], v[202:203]
    v_pk_fma_f32 v[142:143], v[142:143], v[202:203], v[202:203]
    v_pk_fma_f32 v[144:145], v[144:145], v[202:203], v[202:203]
    v_pk_fma_f32 v[146:147], v[146:147], v[202:203], v[202:203]
    v_rcp_f32 v140, v140
    v_rcp_f32 v141, v141
    v_rcp_f32 v142, v142
    v_rcp_f32 v143, v143
    v_rcp_f32 v144, v144
    v_rcp_f32 v145, v145
    v_rcp_f32 v146, v146
    v_rcp_f32 v147, v147
    s_nop 0
    v_pk_mul_f32 v[140:141], v[140:141], v[100:101]
    v_pk_mul_f32 v[142:143], v[142:143], v[102:103]
    v_pk_mul_f32 v[144:145], v[144:145], v[104:105]
    v_pk_mul_f32 v[146:147], v[146:147], v[106:107]
    v_cvt_pk_bf16_f32 v148, v140, v141
    v_cvt_pk_bf16_f32 v149, v142, v143
    v_cvt_pk_bf16_f32 v150, v144, v145
    v_cvt_pk_bf16_f32 v151, v146, v147
    buffer_store_dwordx4 v[148:151], v238, s[8:11], s42 offen offset:256 sc1
    v_pk_fma_f32 v[108:109], v[172:173], v[196:197], v[108:109] neg_lo:[0,1,0] neg_hi:[0,1,0]
    v_pk_fma_f32 v[110:111], v[174:175], v[196:197], v[110:111] neg_lo:[0,1,0] neg_hi:[0,1,0]
    v_pk_fma_f32 v[112:113], v[176:177], v[196:197], v[112:113] neg_lo:[0,1,0] neg_hi:[0,1,0]
    v_pk_fma_f32 v[114:115], v[178:179], v[196:197], v[114:115] neg_lo:[0,1,0] neg_hi:[0,1,0]
    v_pk_mul_f32 v[132:133], v[108:109], v[108:109]
    v_pk_mul_f32 v[134:135], v[110:111], v[110:111]
    v_pk_mul_f32 v[136:137], v[112:113], v[112:113]
    v_pk_mul_f32 v[138:139], v[114:115], v[114:115]
    v_pk_fma_f32 v[132:133], v[132:133], v[200:201], v[198:199]
    v_pk_fma_f32 v[134:135], v[134:135], v[200:201], v[198:199]
    v_pk_fma_f32 v[136:137], v[136:137], v[200:201], v[198:199]
    v_pk_fma_f32 v[138:139], v[138:139], v[200:201], v[198:199]
    v_pk_mul_f32 v[132:133], v[132:133], v[108:109]
    v_pk_mul_f32 v[134:135], v[134:135], v[110:111]
    v_pk_mul_f32 v[136:137], v[136:137], v[112:113]
    v_pk_mul_f32 v[138:139], v[138:139], v[114:115]
    v_exp_f32 v132, v132
    v_exp_f32 v133, v133
    v_exp_f32 v134, v134
    v_exp_f32 v135, v135
    v_exp_f32 v136, v136
    v_exp_f32 v137, v137
    v_exp_f32 v138, v138
    v_exp_f32 v139, v139
    s_nop 0
    v_pk_fma_f32 v[132:133], v[132:133], v[202:203], v[202:203]
    v_pk_fma_f32 v[134:135], v[134:135], v[202:203], v[202:203]
    v_pk_fma_f32 v[136:137], v[136:137], v[202:203], v[202:203]
    v_pk_fma_f32 v[138:139], v[138:139], v[202:203], v[202:203]
    v_rcp_f32 v132, v132
    v_rcp_f32 v133, v133
    v_rcp_f32 v134, v134
    v_rcp_f32 v135, v135
    v_rcp_f32 v136, v136
    v_rcp_f32 v137, v137
    v_rcp_f32 v138, v138
    v_rcp_f32 v139, v139
    s_nop 0
    v_pk_mul_f32 v[132:133], v[132:133], v[108:109]
    v_pk_mul_f32 v[134:135], v[134:135], v[110:111]
    v_pk_mul_f32 v[136:137], v[136:137], v[112:113]
    v_pk_mul_f32 v[138:139], v[138:139], v[114:115]
    v_cvt_pk_bf16_f32 v152, v132, v133
    v_cvt_pk_bf16_f32 v153, v134, v135
    v_cvt_pk_bf16_f32 v154, v136, v137
    v_cvt_pk_bf16_f32 v155, v138, v139
    buffer_store_dwordx4 v[152:155], v238, s[8:11], s42 offen offset:2304 sc1
    v_pk_fma_f32 v[116:117], v[180:181], v[196:197], v[116:117] neg_lo:[0,1,0] neg_hi:[0,1,0]
    v_pk_fma_f32 v[118:119], v[182:183], v[196:197], v[118:119] neg_lo:[0,1,0] neg_hi:[0,1,0]
    v_pk_fma_f32 v[120:121], v[184:185], v[196:197], v[120:121] neg_lo:[0,1,0] neg_hi:[0,1,0]
    v_pk_fma_f32 v[122:123], v[186:187], v[196:197], v[122:123] neg_lo:[0,1,0] neg_hi:[0,1,0]
    v_pk_mul_f32 v[140:141], v[116:117], v[116:117]
    v_pk_mul_f32 v[142:143], v[118:119], v[118:119]
    v_pk_mul_f32 v[144:145], v[120:121], v[120:121]
    v_pk_mul_f32 v[146:147], v[122:123], v[122:123]
    v_pk_fma_f32 v[140:141], v[140:141], v[200:201], v[198:199]
    v_pk_fma_f32 v[142:143], v[142:143], v[200:201], v[198:199]
    v_pk_fma_f32 v[144:145], v[144:145], v[200:201], v[198:199]
    v_pk_fma_f32 v[146:147], v[146:147], v[200:201], v[198:199]
    v_pk_mul_f32 v[140:141], v[140:141], v[116:117]
    v_pk_mul_f32 v[142:143], v[142:143], v[118:119]
    v_pk_mul_f32 v[144:145], v[144:145], v[120:121]
    v_pk_mul_f32 v[146:147], v[146:147], v[122:123]
    v_exp_f32 v140, v140
    v_exp_f32 v141, v141
    v_exp_f32 v142, v142
    v_exp_f32 v143, v143
    v_exp_f32 v144, v144
    v_exp_f32 v145, v145
    v_exp_f32 v146, v146
    v_exp_f32 v147, v147
    s_nop 0
    v_pk_fma_f32 v[140:141], v[140:141], v[202:203], v[202:203]
    v_pk_fma_f32 v[142:143], v[142:143], v[202:203], v[202:203]
    v_pk_fma_f32 v[144:145], v[144:145], v[202:203], v[202:203]
    v_pk_fma_f32 v[146:147], v[146:147], v[202:203], v[202:203]
    v_rcp_f32 v140, v140
    v_rcp_f32 v141, v141
    v_rcp_f32 v142, v142
    v_rcp_f32 v143, v143
    v_rcp_f32 v144, v144
    v_rcp_f32 v145, v145
    v_rcp_f32 v146, v146
    v_rcp_f32 v147, v147
    s_nop 0
    v_pk_mul_f32 v[140:141], v[140:141], v[116:117]
    v_pk_mul_f32 v[142:143], v[142:143], v[118:119]
    v_pk_mul_f32 v[144:145], v[144:145], v[120:121]
    v_pk_mul_f32 v[146:147], v[146:147], v[122:123]
    v_cvt_pk_bf16_f32 v148, v140, v141
    v_cvt_pk_bf16_f32 v149, v142, v143
    v_cvt_pk_bf16_f32 v150, v144, v145
    v_cvt_pk_bf16_f32 v151, v146, v147
    buffer_store_dwordx4 v[148:151], v238, s[8:11], s55 offen offset:256 sc1
    v_pk_fma_f32 v[124:125], v[188:189], v[196:197], v[124:125] neg_lo:[0,1,0] neg_hi:[0,1,0]
    v_pk_fma_f32 v[126:127], v[190:191], v[196:197], v[126:127] neg_lo:[0,1,0] neg_hi:[0,1,0]
    v_pk_mul_f32 v[132:133], v[124:125], v[124:125]
    v_pk_mul_f32 v[134:135], v[126:127], v[126:127]
    v_pk_fma_f32 v[132:133], v[132:133], v[200:201], v[198:199]
    v_pk_fma_f32 v[134:135], v[134:135], v[200:201], v[198:199]
    v_pk_mul_f32 v[132:133], v[132:133], v[124:125]
    v_pk_mul_f32 v[134:135], v[134:135], v[126:127]
    v_exp_f32 v132, v132
    v_exp_f32 v133, v133
    v_exp_f32 v134, v134
    v_exp_f32 v135, v135
    s_nop 0
    v_pk_fma_f32 v[132:133], v[132:133], v[202:203], v[202:203]
    v_pk_fma_f32 v[134:135], v[134:135], v[202:203], v[202:203]
    v_rcp_f32 v132, v132
    v_rcp_f32 v133, v133
    v_rcp_f32 v134, v134
    v_rcp_f32 v135, v135
    s_nop 0
    v_pk_mul_f32 v[132:133], v[132:133], v[124:125]
    v_pk_mul_f32 v[134:135], v[134:135], v[126:127]
    v_cvt_pk_bf16_f32 v152, v132, v133
    v_cvt_pk_bf16_f32 v153, v134, v135
    buffer_store_dwordx2 v[152:153], v238, s[8:11], s56 offen offset:256 sc1
    s_add_u32 s42, s42, 294912
    s_add_u32 s55, s55, 294912
    s_add_u32 s56, s56, 294912
    s_lshr_b32 s64, s59, 5
    s_lshr_b32 s65, s28, 1
    s_add_u32 s64, s64, s65
    s_lshr_b32 s63, s64, 0
    s_lshl_b32 s63, s63, 7
    s_add_u32 s63, s63, 41787392
    s_waitcnt vmcnt(0)
    s_barrier
    s_cmp_lg_u32 s30, 0
    s_cbranch_scc1 k2_ns8
    s_mov_b64 exec, 1
    v_mov_b32 v239, 0
    v_mov_b32 v240, 1
    buffer_atomic_add v240, v239, s[8:11], s63 offen sc1
    s_mov_b64 exec, -1
k2_ns8:
k2_g4:
    s_setprio 0
    s_mov_b32 s52, s30
    s_lshr_b32 s67, s28, 1
    s_and_b32 s64, s28, 1
    s_lshl_b32 s68, s64, 5
    s_add_u32 s68, s68, s29
    s_lshl_b32 s64, s64, 2
    s_and_b32 s65, s29, 3
    s_add_u32 s64, s64, s65
    s_lshl_b32 s59, s64, 8
    s_lshr_b32 s65, s29, 2
    s_lshl_b32 s58, s65, 7
    s_mov_b32 s57, 1024
    s_mul_i32 s60, s67, 57344
    s_add_u32 s60, s60, 21037056
    v_and_b32 v232, 63, v0
    s_lshr_b32 s53, s52, 1
    s_and_b32 s54, s52, 1
    v_bfe_u32 v236, v232, 2, 2
    v_lshrrev_b32 v237, 4, v232
    v_and_b32 v238, 3, v232
    s_mul_i32 s64, s52, 8
    v_add_u32 v236, s64, v236
    v_lshlrev_b32 v237, 5, v237
    v_lshl_add_u32 v237, v238, 3, v237
    v_add_u32 v237, s58, v237
    v_mul_lo_u32 v236, v236, s57
    v_add_lshl_u32 v234, v236, v237, 1
    s_mul_i32 s64, s57, 8
    s_sub_u32 s64, s64, 1024
    v_add_u32 v235, s64, v234
    s_mov_b32 s55, 0
    s_mul_i32 s56, s57, 64
    v_lshlrev_b32 v233, 4, v232
    s_mul_i32 s64, s52, 2
    s_lshr_b32 s65, s59, 5
    s_add_u32 s64, s64, s65
    s_add_u32 s64, s64, 0
    s_add_u32 s65, s64, s67
    s_and_b32 s65, s65, 3
    s_andn2_b32 s64, s64, 3
    s_or_b32 s64, s64, s65
    s_mul_i32 s64, s64, 294912
    s_add_u32 s62, s64, s60
    s_mul_i32 s64, s52, 2
    s_lshr_b32 s65, s59, 5
    s_add_u32 s64, s64, s65
    s_add_u32 s64, s64, 1
    s_add_u32 s65, s64, s67
    s_and_b32 s65, s65, 3
    s_andn2_b32 s64, s64, 3
    s_or_b32 s64, s64, s65
    s_mul_i32 s64, s64, 294912
    s_add_u32 s63, s64, s60
    s_sub_u32 s63, s63, 2048
    s_mul_i32 s64, s53, 8192
    v_add_u32 v228, s64, v233
    v_lshrrev_b32 v236, 5, v232
    v_mul_u32_u24 v236, 1024, v236
    v_bfe_u32 v237, v232, 2, 2
    v_lshl_add_u32 v236, v237, 6, v236
    v_bfe_u32 v237, v232, 4, 1
    v_lshl_add_u32 v236, v237, 5, v236
    v_and_b32 v237, 3, v232
    v_lshl_add_u32 v236, v237, 3, v236
    s_mul_i32 s64, s54, 512
    s_add_u32 s64, s64, 16384
    v_add_u32 v230, s64, v236
    v_add_u32 v229, 49152, v228
    v_add_u32 v231, 49152, v230
    s_mul_i32 s57, s52, 4096
    s_mul_i32 s60, s52, 2048
    s_add_u32 s60, s60, 16384
    v_xor_b32 v235, 32, v235
    v_and_b32 v236, 15, v232
    v_lshlrev_b32 v236, 4, v236
    v_lshrrev_b32 v237, 4, v232
    v_lshl_add_u32 v236, v237, 9, v236
    s_mul_i32 s64, s53, 8192
    v_add_u32 v228, s64, v236
    v_add_u32 v229, 49152, v228
    v_mov_b32 v238, v237
    v_lshlrev_b32 v238, 10, v238
    v_bfe_u32 v239, v232, 2, 2
    v_lshl_add_u32 v238, v239, 6, v238
    v_and_b32 v239, 3, v232
    v_lshl_add_u32 v238, v239, 3, v238
    v_and_b32 v239, 1, v237
    v_lshl_add_u32 v238, v239, 5, v238
    s_mul_i32 s64, s54, 512
    s_add_u32 s64, s64, 16384
    v_add_u32 v230, s64, v238
    v_xor_b32 v240, 32, v230
    v_add_u32 v231, 49152, v230
    v_add_u32 v241, 49152, v240
    s_mul_i32 s55, s67, 1835008
    s_mov_b32 s44, s26
    s_and_b32 s45, s27, 0xffff
    s_mov_b32 s46, 65011712
    s_mov_b32 s47, 0x00020000
    s_mov_b32 s48, s20
    s_and_b32 s49, s21, 0xffff
    s_mov_b32 s50, 7340032
    s_mov_b32 s51, 0x00020000
    s_mov_b32 s32, s24
    s_and_b32 s33, s25, 0xffff
    s_mov_b32 s34, 4194304
    s_mov_b32 s35, 0x00020000
    s_and_b32 s15, s15, 0xffff
    s_lshl_b32 s70, s68, 7
    s_add_u32 s70, s70, 41762816
    s_add_u32 m0, s60, 0
    s_nop 0
    buffer_load_dwordx4 v234, s[48:51], s55 offen offset:0 lds
    buffer_load_dwordx4 v235, s[48:51], s55 offen offset:1024 lds
    s_add_u32 s55, s55, s56
    s_add_u32 m0, s60, 24576
    s_nop 0
    buffer_load_dwordx4 v234, s[48:51], s55 offen offset:0 lds
    buffer_load_dwordx4 v235, s[48:51], s55 offen offset:1024 lds
    s_add_u32 s55, s55, s56
    s_cmp_lg_u32 s30, 0
    s_cbranch_scc1 k2_cw
    s_lshr_b32 s69, s59, 5
    s_add_u32 s69, s69, s67
    s_add_u32 s69, s69, 0
    s_lshr_b32 s64, s69, 0
    s_lshl_b32 s64, s64, 7
    s_add_u32 s64, s64, 41787392
    v_mov_b32 v237, 0
    s_mov_b32 s66, 0
k2_pl9:
    buffer_load_dword v238, v237, s[8:11], s64 offen sc1
    s_waitcnt vmcnt(0)
    v_readfirstlane_b32 s65, v238
    s_nop 3
    s_cmp_ge_u32 s65, 4
    s_cbranch_scc1 k2_pk9
    s_add_u32 s66, s66, 1
    s_sleep 8
    s_cmp_lt_u32 s66, 0x40000
    s_cbranch_scc1 k2_pl9
k2_pk9:
    s_lshr_b32 s69, s59, 5
    s_add_u32 s69, s69, s67
    s_add_u32 s69, s69, 4
    s_lshr_b32 s64, s69, 0
    s_lshl_b32 s64, s64, 7
    s_add_u32 s64, s64, 41787392
    v_mov_b32 v237, 0
    s_mov_b32 s66, 0
k2_pl10:
    buffer_load_dword v238, v237, s[8:11], s64 offen sc1
    s_waitcnt vmcnt(0)
    v_readfirstlane_b32 s65, v238
    s_nop 3
    s_cmp_ge_u32 s65, 4
    s_cbranch_scc1 k2_pk10
    s_add_u32 s66, s66, 1
    s_sleep 8
    s_cmp_lt_u32 s66, 0x40000
    s_cbranch_scc1 k2_pl10
k2_pk10:
k2_cw:
    s_barrier
    s_add_u32 m0, s57, 0
    s_nop 0
    buffer_load_dwordx4 v233, s[44:47], s62 offen offset:0 sc1 lds
    buffer_load_dwordx4 v233, s[44:47], s62 offen offset:1024 sc1 lds
    s_add_u32 s62, s62, 2048
    buffer_load_dwordx4 v233, s[44:47], s63 offen offset:2048 sc1 lds
    buffer_load_dwordx4 v233, s[44:47], s63 offen offset:3072 sc1 lds
    s_add_u32 s63, s63, 2048
    s_add_u32 m0, s57, 24576
    s_nop 0
    buffer_load_dwordx4 v233, s[44:47], s62 offen offset:0 sc1 lds
    buffer_load_dwordx4 v233, s[44:47], s62 offen offset:1024 sc1 lds
    s_add_u32 s62, s62, 2048
    buffer_load_dwordx4 v233, s[44:47], s63 offen offset:2048 sc1 lds
    buffer_load_dwordx4 v233, s[44:47], s63 offen offset:3072 sc1 lds
    s_add_u32 s63, s63, 2048
    s_mov_b32 s43, 3
    s_waitcnt vmcnt(4)
    s_barrier
    ds_read_b64_tr_b16 v[196:197], v230 offset:0
    ds_read_b64_tr_b16 v[198:199], v230 offset:4096
    ds_read_b128 v[132:135], v228 offset:0
    ds_read_b64_tr_b16 v[200:201], v240 offset:0
    ds_read_b64_tr_b16 v[202:203], v240 offset:4096
    ds_read_b128 v[136:139], v228 offset:256
    ds_read_b64_tr_b16 v[204:205], v230 offset:256
    ds_read_b64_tr_b16 v[206:207], v230 offset:4352
    ds_read_b64_tr_b16 v[208:209], v240 offset:256
    ds_read_b64_tr_b16 v[210:211], v240 offset:4352
    ds_read_b128 v[140:143], v228 offset:2048
    ds_read_b128 v[144:147], v228 offset:2304
    ds_read_b128 v[148:151], v228 offset:4096
    ds_read_b128 v[152:155], v228 offset:4352
    ds_read_b128 v[156:159], v228 offset:6144
    ds_read_b128 v[160:163], v228 offset:6400
    s_add_u32 m0, s57, 49152
    s_nop 0
    buffer_load_dwordx4 v233, s[44:47], s62 offen offset:0 sc1 lds
    buffer_load_dwordx4 v233, s[44:47], s62 offen offset:1024 sc1 lds
    s_add_u32 s62, s62, 2048
    buffer_load_dwordx4 v233, s[44:47], s63 offen offset:2048 sc1 lds
    buffer_load_dwordx4 v233, s[44:47], s63 offen offset:3072 sc1 lds
    s_add_u32 s63, s63, 2048
    s_add_u32 m0, s60, 49152
    s_nop 0
    buffer_load_dwordx4 v234, s[48:51], s55 offen offset:0 lds
    buffer_load_dwordx4 v235, s[48:51], s55 offen offset:1024 lds
    s_add_u32 s55, s55, s56
    s_waitcnt lgkmcnt(13)
    v_mfma_f32_16x16x32_bf16 v[4:7], v[196:199], v[132:135], 0
    s_waitcnt vmcnt(6) lgkmcnt(0)
    v_mfma_f32_16x16x32_bf16 v[8:11], v[200:203], v[132:135], 0
    s_barrier
    v_mfma_f32_16x16x32_bf16 v[20:23], v[196:199], v[136:139], 0
    ds_read_b64_tr_b16 v[212:213], v230 offset:24576
    s_add_u32 m0, s57, 0
    v_mfma_f32_16x16x32_bf16 v[24:27], v[200:203], v[136:139], 0
    ds_read_b64_tr_b16 v[214:215], v230 offset:28672
    buffer_load_dwordx4 v233, s[44:47], s62 offen offset:0 sc1 lds
    v_mfma_f32_16x16x32_bf16 v[12:15], v[204:207], v[132:135], 0
    ds_read_b128 v[164:167], v228 offset:24576
    v_mfma_f32_16x16x32_bf16 v[28:31], v[204:207], v[136:139], 0
    ds_read_b64_tr_b16 v[216:217], v240 offset:24576
    v_mfma_f32_16x16x32_bf16 v[16:19], v[208:211], v[132:135], 0
    ds_read_b64_tr_b16 v[218:219], v240 offset:28672
    buffer_load_dwordx4 v233, s[44:47], s62 offen offset:1024 sc1 lds
    v_mfma_f32_16x16x32_bf16 v[32:35], v[208:211], v[136:139], 0
    ds_read_b128 v[168:171], v228 offset:24832
    s_add_u32 s62, s62, 2048
    v_mfma_f32_16x16x32_bf16 v[36:39], v[196:199], v[140:143], 0
    ds_read_b64_tr_b16 v[220:221], v230 offset:24832
    v_mfma_f32_16x16x32_bf16 v[40:43], v[200:203], v[140:143], 0
    ds_read_b64_tr_b16 v[222:223], v230 offset:28928
    buffer_load_dwordx4 v233, s[44:47], s63 offen offset:2048 sc1 lds
    v_mfma_f32_16x16x32_bf16 v[44:47], v[204:207], v[140:143], 0
    ds_read_b64_tr_b16 v[224:225], v240 offset:24832
    v_mfma_f32_16x16x32_bf16 v[48:51], v[208:211], v[140:143], 0
    ds_read_b64_tr_b16 v[226:227], v240 offset:28928
    v_mfma_f32_16x16x32_bf16 v[52:55], v[196:199], v[144:147], 0
    ds_read_b128 v[172:175], v228 offset:26624
    buffer_load_dwordx4 v233, s[44:47], s63 offen offset:3072 sc1 lds
    v_mfma_f32_16x16x32_bf16 v[56:59], v[200:203], v[144:147], 0
    ds_read_b128 v[176:179], v228 offset:26880
    s_add_u32 s63, s63, 2048
    v_mfma_f32_16x16x32_bf16 v[60:63], v[204:207], v[144:147], 0
    ds_read_b128 v[180:183], v228 offset:28672
    s_add_u32 m0, s60, 0
    v_mfma_f32_16x16x32_bf16 v[64:67], v[208:211], v[144:147], 0
    ds_read_b128 v[184:187], v228 offset:28928
    buffer_load_dwordx4 v234, s[48:51], s55 offen offset:0 lds
    v_mfma_f32_16x16x32_bf16 v[68:71], v[196:199], v[148:151], 0
    ds_read_b128 v[188:191], v228 offset:30720
    v_mfma_f32_16x16x32_bf16 v[72:75], v[200:203], v[148:151], 0
    ds_read_b128 v[192:195], v228 offset:30976
    v_mfma_f32_16x16x32_bf16 v[76:79], v[204:207], v[148:151], 0
    buffer_load_dwordx4 v235, s[48:51], s55 offen offset:1024 lds
    v_mfma_f32_16x16x32_bf16 v[80:83], v[208:211], v[148:151], 0
    s_add_u32 s55, s55, s56
    v_mfma_f32_16x16x32_bf16 v[84:87], v[196:199], v[152:155], 0
    v_mfma_f32_16x16x32_bf16 v[88:91], v[200:203], v[152:155], 0
    v_mfma_f32_16x16x32_bf16 v[92:95], v[204:207], v[152:155], 0
    v_mfma_f32_16x16x32_bf16 v[96:99], v[208:211], v[152:155], 0
    v_mfma_f32_16x16x32_bf16 v[100:103], v[196:199], v[156:159], 0
    v_mfma_f32_16x16x32_bf16 v[104:107], v[200:203], v[156:159], 0
    v_mfma_f32_16x16x32_bf16 v[108:111], v[204:207], v[156:159], 0
    v_mfma_f32_16x16x32_bf16 v[112:115], v[208:211], v[156:159], 0
    v_mfma_f32_16x16x32_bf16 v[116:119], v[196:199], v[160:163], 0
    v_mfma_f32_16x16x32_bf16 v[120:123], v[200:203], v[160:163], 0
    v_mfma_f32_16x16x32_bf16 v[124:127], v[204:207], v[160:163], 0
    v_mfma_f32_16x16x32_bf16 v[128:131], v[208:211], v[160:163], 0
    s_waitcnt lgkmcnt(13)
    v_mfma_f32_16x16x32_bf16 v[4:7], v[212:215], v[164:167], v[4:7]
    s_waitcnt vmcnt(6) lgkmcnt(0)
    v_mfma_f32_16x16x32_bf16 v[8:11], v[216:219], v[164:167], v[8:11]
    s_barrier
    s_mov_b32 s61, 0
g4_loop:
    s_cmp_eq_u32 s61, s43
    s_cbranch_scc1 g4_loop_mid
g4_loop_back:
    v_mfma_f32_16x16x32_bf16 v[20:23], v[212:215], v[168:171], v[20:23]
    ds_read_b64_tr_b16 v[196:197], v231 offset:0
    s_add_u32 m0, s57, 24576
    v_mfma_f32_16x16x32_bf16 v[24:27], v[216:219], v[168:171], v[24:27]
    ds_read_b64_tr_b16 v[198:199], v231 offset:4096
    buffer_load_dwordx4 v233, s[44:47], s62 offen offset:0 sc1 lds
    v_mfma_f32_16x16x32_bf16 v[12:15], v[220:223], v[164:167], v[12:15]
    ds_read_b128 v[132:135], v229 offset:0
    v_mfma_f32_16x16x32_bf16 v[28:31], v[220:223], v[168:171], v[28:31]
    ds_read_b64_tr_b16 v[200:201], v241 offset:0
    v_mfma_f32_16x16x32_bf16 v[16:19], v[224:227], v[164:167], v[16:19]
    ds_read_b64_tr_b16 v[202:203], v241 offset:4096
    buffer_load_dwordx4 v233, s[44:47], s62 offen offset:1024 sc1 lds
    v_mfma_f32_16x16x32_bf16 v[32:35], v[224:227], v[168:171], v[32:35]
    ds_read_b128 v[136:139], v229 offset:256
    s_add_u32 s62, s62, 2048
    v_mfma_f32_16x16x32_bf16 v[36:39], v[212:215], v[172:175], v[36:39]
    ds_read_b64_tr_b16 v[204:205], v231 offset:256
    v_mfma_f32_16x16x32_bf16 v[40:43], v[216:219], v[172:175], v[40:43]
    ds_read_b64_tr_b16 v[206:207], v231 offset:4352
    buffer_load_dwordx4 v233, s[44:47], s63 offen offset:2048 sc1 lds
    v_mfma_f32_16x16x32_bf16 v[44:47], v[220:223], v[172:175], v[44:47]
    ds_read_b64_tr_b16 v[208:209], v241 offset:256
    v_mfma_f32_16x16x32_bf16 v[48:51], v[224:227], v[172:175], v[48:51]
    ds_read_b64_tr_b16 v[210:211], v241 offset:4352
    v_mfma_f32_16x16x32_bf16 v[52:55], v[212:215], v[176:179], v[52:55]
    ds_read_b128 v[140:143], v229 offset:2048
    buffer_load_dwordx4 v233, s[44:47], s63 offen offset:3072 sc1 lds
    v_mfma_f32_16x16x32_bf16 v[56:59], v[216:219], v[176:179], v[56:59]
    ds_read_b128 v[144:147], v229 offset:2304
    s_add_u32 s63, s63, 2048
    v_mfma_f32_16x16x32_bf16 v[60:63], v[220:223], v[176:179], v[60:63]
    ds_read_b128 v[148:151], v229 offset:4096
    s_add_u32 m0, s60, 24576
    v_mfma_f32_16x16x32_bf16 v[64:67], v[224:227], v[176:179], v[64:67]
    ds_read_b128 v[152:155], v229 offset:4352
    buffer_load_dwordx4 v234, s[48:51], s55 offen offset:0 lds
    v_mfma_f32_16x16x32_bf16 v[68:71], v[212:215], v[180:183], v[68:71]
    ds_read_b128 v[156:159], v229 offset:6144
    v_mfma_f32_16x16x32_bf16 v[72:75], v[216:219], v[180:183], v[72:75]
    ds_read_b128 v[160:163], v229 offset:6400
    v_mfma_f32_16x16x32_bf16 v[76:79], v[220:223], v[180:183], v[76:79]
    buffer_load_dwordx4 v235, s[48:51], s55 offen offset:1024 lds
    v_mfma_f32_16x16x32_bf16 v[80:83], v[224:227], v[180:183], v[80:83]
    s_add_u32 s55, s55, s56
    v_mfma_f32_16x16x32_bf16 v[84:87], v[212:215], v[184:187], v[84:87]
    v_mfma_f32_16x16x32_bf16 v[88:91], v[216:219], v[184:187], v[88:91]
    v_mfma_f32_16x16x32_bf16 v[92:95], v[220:223], v[184:187], v[92:95]
    v_mfma_f32_16x16x32_bf16 v[96:99], v[224:227], v[184:187], v[96:99]
    v_mfma_f32_16x16x32_bf16 v[100:103], v[212:215], v[188:191], v[100:103]
    v_mfma_f32_16x16x32_bf16 v[104:107], v[216:219], v[188:191], v[104:107]
    v_mfma_f32_16x16x32_bf16 v[108:111], v[220:223], v[188:191], v[108:111]
    v_mfma_f32_16x16x32_bf16 v[112:115], v[224:227], v[188:191], v[112:115]
    v_mfma_f32_16x16x32_bf16 v[116:119], v[212:215], v[192:195], v[116:119]
    v_mfma_f32_16x16x32_bf16 v[120:123], v[216:219], v[192:195], v[120:123]
    v_mfma_f32_16x16x32_bf16 v[124:127], v[220:223], v[192:195], v[124:127]
    v_mfma_f32_16x16x32_bf16 v[128:131], v[224:227], v[192:195], v[128:131]
    s_waitcnt lgkmcnt(13)
    v_mfma_f32_16x16x32_bf16 v[4:7], v[196:199], v[132:135], v[4:7]
    s_waitcnt vmcnt(6) lgkmcnt(0)
    v_mfma_f32_16x16x32_bf16 v[8:11], v[200:203], v[132:135], v[8:11]
    s_barrier
    v_mfma_f32_16x16x32_bf16 v[20:23], v[196:199], v[136:139], v[20:23]
    ds_read_b64_tr_b16 v[212:213], v230 offset:0
    s_add_u32 m0, s57, 49152
    v_mfma_f32_16x16x32_bf16 v[24:27], v[200:203], v[136:139], v[24:27]
    ds_read_b64_tr_b16 v[214:215], v230 offset:4096
    buffer_load_dwordx4 v233, s[44:47], s62 offen offset:0 sc1 lds
    v_mfma_f32_16x16x32_bf16 v[12:15], v[204:207], v[132:135], v[12:15]
    ds_read_b128 v[164:167], v228 offset:0
    v_mfma_f32_16x16x32_bf16 v[28:31], v[204:207], v[136:139], v[28:31]
    ds_read_b64_tr_b16 v[216:217], v240 offset:0
    v_mfma_f32_16x16x32_bf16 v[16:19], v[208:211], v[132:135], v[16:19]
    ds_read_b64_tr_b16 v[218:219], v240 offset:4096
    buffer_load_dwordx4 v233, s[44:47], s62 offen offset:1024 sc1 lds
    v_mfma_f32_16x16x32_bf16 v[32:35], v[208:211], v[136:139], v[32:35]
    ds_read_b128 v[168:171], v228 offset:256
    s_add_u32 s62, s62, 2048
    v_mfma_f32_16x16x32_bf16 v[36:39], v[196:199], v[140:143], v[36:39]
    ds_read_b64_tr_b16 v[220:221], v230 offset:256
    v_mfma_f32_16x16x32_bf16 v[40:43], v[200:203], v[140:143], v[40:43]
    ds_read_b64_tr_b16 v[222:223], v230 offset:4352
    buffer_load_dwordx4 v233, s[44:47], s63 offen offset:2048 sc1 lds
    v_mfma_f32_16x16x32_bf16 v[44:47], v[204:207], v[140:143], v[44:47]
    ds_read_b64_tr_b16 v[224:225], v240 offset:256
    v_mfma_f32_16x16x32_bf16 v[48:51], v[208:211], v[140:143], v[48:51]
    ds_read_b64_tr_b16 v[226:227], v240 offset:4352
    v_mfma_f32_16x16x32_bf16 v[52:55], v[196:199], v[144:147], v[52:55]
    ds_read_b128 v[172:175], v228 offset:2048
    buffer_load_dwordx4 v233, s[44:47], s63 offen offset:3072 sc1 lds
    v_mfma_f32_16x16x32_bf16 v[56:59], v[200:203], v[144:147], v[56:59]
    ds_read_b128 v[176:179], v228 offset:2304
    s_add_u32 s63, s63, 2048
    v_mfma_f32_16x16x32_bf16 v[60:63], v[204:207], v[144:147], v[60:63]
    ds_read_b128 v[180:183], v228 offset:4096
    s_add_u32 m0, s60, 49152
    v_mfma_f32_16x16x32_bf16 v[64:67], v[208:211], v[144:147], v[64:67]
    ds_read_b128 v[184:187], v228 offset:4352
    buffer_load_dwordx4 v234, s[48:51], s55 offen offset:0 lds
    v_mfma_f32_16x16x32_bf16 v[68:71], v[196:199], v[148:151], v[68:71]
    ds_read_b128 v[188:191], v228 offset:6144
    v_mfma_f32_16x16x32_bf16 v[72:75], v[200:203], v[148:151], v[72:75]
    ds_read_b128 v[192:195], v228 offset:6400
    v_mfma_f32_16x16x32_bf16 v[76:79], v[204:207], v[148:151], v[76:79]
    buffer_load_dwordx4 v235, s[48:51], s55 offen offset:1024 lds
    v_mfma_f32_16x16x32_bf16 v[80:83], v[208:211], v[148:151], v[80:83]
    s_add_u32 s55, s55, s56
    v_mfma_f32_16x16x32_bf16 v[84:87], v[196:199], v[152:155], v[84:87]
    v_mfma_f32_16x16x32_bf16 v[88:91], v[200:203], v[152:155], v[88:91]
    v_mfma_f32_16x16x32_bf16 v[92:95], v[204:207], v[152:155], v[92:95]
    v_mfma_f32_16x16x32_bf16 v[96:99], v[208:211], v[152:155], v[96:99]
    v_mfma_f32_16x16x32_bf16 v[100:103], v[196:199], v[156:159], v[100:103]
    v_mfma_f32_16x16x32_bf16 v[104:107], v[200:203], v[156:159], v[104:107]
    v_mfma_f32_16x16x32_bf16 v[108:111], v[204:207], v[156:159], v[108:111]
    v_mfma_f32_16x16x32_bf16 v[112:115], v[208:211], v[156:159], v[112:115]
    v_mfma_f32_16x16x32_bf16 v[116:119], v[196:199], v[160:163], v[116:119]
    v_mfma_f32_16x16x32_bf16 v[120:123], v[200:203], v[160:163], v[120:123]
    v_mfma_f32_16x16x32_bf16 v[124:127], v[204:207], v[160:163], v[124:127]
    v_mfma_f32_16x16x32_bf16 v[128:131], v[208:211], v[160:163], v[128:131]
    s_waitcnt lgkmcnt(13)
    v_mfma_f32_16x16x32_bf16 v[4:7], v[212:215], v[164:167], v[4:7]
    s_waitcnt vmcnt(6) lgkmcnt(0)
    v_mfma_f32_16x16x32_bf16 v[8:11], v[216:219], v[164:167], v[8:11]
    s_barrier
    v_mfma_f32_16x16x32_bf16 v[20:23], v[212:215], v[168:171], v[20:23]
    ds_read_b64_tr_b16 v[196:197], v230 offset:24576
    s_add_u32 m0, s57, 0
    v_mfma_f32_16x16x32_bf16 v[24:27], v[216:219], v[168:171], v[24:27]
    ds_read_b64_tr_b16 v[198:199], v230 offset:28672
    buffer_load_dwordx4 v233, s[44:47], s62 offen offset:0 sc1 lds
    v_mfma_f32_16x16x32_bf16 v[12:15], v[220:223], v[164:167], v[12:15]
    ds_read_b128 v[132:135], v228 offset:24576
    v_mfma_f32_16x16x32_bf16 v[28:31], v[220:223], v[168:171], v[28:31]
    ds_read_b64_tr_b16 v[200:201], v240 offset:24576
    v_mfma_f32_16x16x32_bf16 v[16:19], v[224:227], v[164:167], v[16:19]
    ds_read_b64_tr_b16 v[202:203], v240 offset:28672
    buffer_load_dwordx4 v233, s[44:47], s62 offen offset:1024 sc1 lds
    v_mfma_f32_16x16x32_bf16 v[32:35], v[224:227], v[168:171], v[32:35]
    ds_read_b128 v[136:139], v228 offset:24832
    s_add_u32 s62, s62, 2048
    v_mfma_f32_16x16x32_bf16 v[36:39], v[212:215], v[172:175], v[36:39]
    ds_read_b64_tr_b16 v[204:205], v230 offset:24832
    v_mfma_f32_16x16x32_bf16 v[40:43], v[216:219], v[172:175], v[40:43]
    ds_read_b64_tr_b16 v[206:207], v230 offset:28928
    buffer_load_dwordx4 v233, s[44:47], s63 offen offset:2048 sc1 lds
    v_mfma_f32_16x16x32_bf16 v[44:47], v[220:223], v[172:175], v[44:47]
    ds_read_b64_tr_b16 v[208:209], v240 offset:24832
    v_mfma_f32_16x16x32_bf16 v[48:51], v[224:227], v[172:175], v[48:51]
    ds_read_b64_tr_b16 v[210:211], v240 offset:28928
    v_mfma_f32_16x16x32_bf16 v[52:55], v[212:215], v[176:179], v[52:55]
    ds_read_b128 v[140:143], v228 offset:26624
    buffer_load_dwordx4 v233, s[44:47], s63 offen offset:3072 sc1 lds
    v_mfma_f32_16x16x32_bf16 v[56:59], v[216:219], v[176:179], v[56:59]
    ds_read_b128 v[144:147], v228 offset:26880
    s_add_u32 s63, s63, 2048
    v_mfma_f32_16x16x32_bf16 v[60:63], v[220:223], v[176:179], v[60:63]
    ds_read_b128 v[148:151], v228 offset:28672
    s_add_u32 m0, s60, 0
    v_mfma_f32_16x16x32_bf16 v[64:67], v[224:227], v[176:179], v[64:67]
    ds_read_b128 v[152:155], v228 offset:28928
    buffer_load_dwordx4 v234, s[48:51], s55 offen offset:0 lds
    v_mfma_f32_16x16x32_bf16 v[68:71], v[212:215], v[180:183], v[68:71]
    ds_read_b128 v[156:159], v228 offset:30720
    v_mfma_f32_16x16x32_bf16 v[72:75], v[216:219], v[180:183], v[72:75]
    ds_read_b128 v[160:163], v228 offset:30976
    v_mfma_f32_16x16x32_bf16 v[76:79], v[220:223], v[180:183], v[76:79]
    buffer_load_dwordx4 v235, s[48:51], s55 offen offset:1024 lds
    v_mfma_f32_16x16x32_bf16 v[80:83], v[224:227], v[180:183], v[80:83]
    s_add_u32 s55, s55, s56
    v_mfma_f32_16x16x32_bf16 v[84:87], v[212:215], v[184:187], v[84:87]
    v_mfma_f32_16x16x32_bf16 v[88:91], v[216:219], v[184:187], v[88:91]
    v_mfma_f32_16x16x32_bf16 v[92:95], v[220:223], v[184:187], v[92:95]
    v_mfma_f32_16x16x32_bf16 v[96:99], v[224:227], v[184:187], v[96:99]
    v_mfma_f32_16x16x32_bf16 v[100:103], v[212:215], v[188:191], v[100:103]
    v_mfma_f32_16x16x32_bf16 v[104:107], v[216:219], v[188:191], v[104:107]
    v_mfma_f32_16x16x32_bf16 v[108:111], v[220:223], v[188:191], v[108:111]
    v_mfma_f32_16x16x32_bf16 v[112:115], v[224:227], v[188:191], v[112:115]
    v_mfma_f32_16x16x32_bf16 v[116:119], v[212:215], v[192:195], v[116:119]
    v_mfma_f32_16x16x32_bf16 v[120:123], v[216:219], v[192:195], v[120:123]
    v_mfma_f32_16x16x32_bf16 v[124:127], v[220:223], v[192:195], v[124:127]
    v_mfma_f32_16x16x32_bf16 v[128:131], v[224:227], v[192:195], v[128:131]
    s_waitcnt lgkmcnt(13)
    v_mfma_f32_16x16x32_bf16 v[4:7], v[196:199], v[132:135], v[4:7]
    s_waitcnt vmcnt(6) lgkmcnt(0)
    v_mfma_f32_16x16x32_bf16 v[8:11], v[200:203], v[132:135], v[8:11]
    s_barrier
    v_mfma_f32_16x16x32_bf16 v[20:23], v[196:199], v[136:139], v[20:23]
    ds_read_b64_tr_b16 v[212:213], v231 offset:0
    s_add_u32 m0, s57, 24576
    v_mfma_f32_16x16x32_bf16 v[24:27], v[200:203], v[136:139], v[24:27]
    ds_read_b64_tr_b16 v[214:215], v231 offset:4096
    buffer_load_dwordx4 v233, s[44:47], s62 offen offset:0 sc1 lds
    v_mfma_f32_16x16x32_bf16 v[12:15], v[204:207], v[132:135], v[12:15]
    ds_read_b128 v[164:167], v229 offset:0
    v_mfma_f32_16x16x32_bf16 v[28:31], v[204:207], v[136:139], v[28:31]
    ds_read_b64_tr_b16 v[216:217], v241 offset:0
    v_mfma_f32_16x16x32_bf16 v[16:19], v[208:211], v[132:135], v[16:19]
    ds_read_b64_tr_b16 v[218:219], v241 offset:4096
    buffer_load_dwordx4 v233, s[44:47], s62 offen offset:1024 sc1 lds
    v_mfma_f32_16x16x32_bf16 v[32:35], v[208:211], v[136:139], v[32:35]
    ds_read_b128 v[168:171], v229 offset:256
    s_add_u32 s62, s62, 2048
    v_mfma_f32_16x16x32_bf16 v[36:39], v[196:199], v[140:143], v[36:39]
    ds_read_b64_tr_b16 v[220:221], v231 offset:256
    v_mfma_f32_16x16x32_bf16 v[40:43], v[200:203], v[140:143], v[40:43]
    ds_read_b64_tr_b16 v[222:223], v231 offset:4352
    buffer_load_dwordx4 v233, s[44:47], s63 offen offset:2048 sc1 lds
    v_mfma_f32_16x16x32_bf16 v[44:47], v[204:207], v[140:143], v[44:47]
    ds_read_b64_tr_b16 v[224:225], v241 offset:256
    v_mfma_f32_16x16x32_bf16 v[48:51], v[208:211], v[140:143], v[48:51]
    ds_read_b64_tr_b16 v[226:227], v241 offset:4352
    v_mfma_f32_16x16x32_bf16 v[52:55], v[196:199], v[144:147], v[52:55]
    ds_read_b128 v[172:175], v229 offset:2048
    buffer_load_dwordx4 v233, s[44:47], s63 offen offset:3072 sc1 lds
    v_mfma_f32_16x16x32_bf16 v[56:59], v[200:203], v[144:147], v[56:59]
    ds_read_b128 v[176:179], v229 offset:2304
    s_add_u32 s63, s63, 2048
    v_mfma_f32_16x16x32_bf16 v[60:63], v[204:207], v[144:147], v[60:63]
    ds_read_b128 v[180:183], v229 offset:4096
    s_add_u32 m0, s60, 24576
    v_mfma_f32_16x16x32_bf16 v[64:67], v[208:211], v[144:147], v[64:67]
    ds_read_b128 v[184:187], v229 offset:4352
    buffer_load_dwordx4 v234, s[48:51], s55 offen offset:0 lds
    v_mfma_f32_16x16x32_bf16 v[68:71], v[196:199], v[148:151], v[68:71]
    ds_read_b128 v[188:191], v229 offset:6144
    v_mfma_f32_16x16x32_bf16 v[72:75], v[200:203], v[148:151], v[72:75]
    ds_read_b128 v[192:195], v229 offset:6400
    v_mfma_f32_16x16x32_bf16 v[76:79], v[204:207], v[148:151], v[76:79]
    buffer_load_dwordx4 v235, s[48:51], s55 offen offset:1024 lds
    v_mfma_f32_16x16x32_bf16 v[80:83], v[208:211], v[148:151], v[80:83]
    s_add_u32 s55, s55, s56
    v_mfma_f32_16x16x32_bf16 v[84:87], v[196:199], v[152:155], v[84:87]
    v_mfma_f32_16x16x32_bf16 v[88:91], v[200:203], v[152:155], v[88:91]
    v_mfma_f32_16x16x32_bf16 v[92:95], v[204:207], v[152:155], v[92:95]
    v_mfma_f32_16x16x32_bf16 v[96:99], v[208:211], v[152:155], v[96:99]
    v_mfma_f32_16x16x32_bf16 v[100:103], v[196:199], v[156:159], v[100:103]
    v_mfma_f32_16x16x32_bf16 v[104:107], v[200:203], v[156:159], v[104:107]
    v_mfma_f32_16x16x32_bf16 v[108:111], v[204:207], v[156:159], v[108:111]
    v_mfma_f32_16x16x32_bf16 v[112:115], v[208:211], v[156:159], v[112:115]
    v_mfma_f32_16x16x32_bf16 v[116:119], v[196:199], v[160:163], v[116:119]
    v_mfma_f32_16x16x32_bf16 v[120:123], v[200:203], v[160:163], v[120:123]
    v_mfma_f32_16x16x32_bf16 v[124:127], v[204:207], v[160:163], v[124:127]
    v_mfma_f32_16x16x32_bf16 v[128:131], v[208:211], v[160:163], v[128:131]
    s_waitcnt lgkmcnt(13)
    v_mfma_f32_16x16x32_bf16 v[4:7], v[212:215], v[164:167], v[4:7]
    s_waitcnt vmcnt(6) lgkmcnt(0)
    v_mfma_f32_16x16x32_bf16 v[8:11], v[216:219], v[164:167], v[8:11]
    s_barrier
    v_mfma_f32_16x16x32_bf16 v[20:23], v[212:215], v[168:171], v[20:23]
    ds_read_b64_tr_b16 v[196:197], v230 offset:0
    s_add_u32 m0, s57, 49152
    v_mfma_f32_16x16x32_bf16 v[24:27], v[216:219], v[168:171], v[24:27]
    ds_read_b64_tr_b16 v[198:199], v230 offset:4096
    buffer_load_dwordx4 v233, s[44:47], s62 offen offset:0 sc1 lds
    v_mfma_f32_16x16x32_bf16 v[12:15], v[220:223], v[164:167], v[12:15]
    ds_read_b128 v[132:135], v228 offset:0
    v_mfma_f32_16x16x32_bf16 v[28:31], v[220:223], v[168:171], v[28:31]
    ds_read_b64_tr_b16 v[200:201], v240 offset:0
    v_mfma_f32_16x16x32_bf16 v[16:19], v[224:227], v[164:167], v[16:19]
    ds_read_b64_tr_b16 v[202:203], v240 offset:4096
    buffer_load_dwordx4 v233, s[44:47], s62 offen offset:1024 sc1 lds
    v_mfma_f32_16x16x32_bf16 v[32:35], v[224:227], v[168:171], v[32:35]
    ds_read_b128 v[136:139], v228 offset:256
    s_add_u32 s62, s62, 2048
    v_mfma_f32_16x16x32_bf16 v[36:39], v[212:215], v[172:175], v[36:39]
    ds_read_b64_tr_b16 v[204:205], v230 offset:256
    v_mfma_f32_16x16x32_bf16 v[40:43], v[216:219], v[172:175], v[40:43]
    ds_read_b64_tr_b16 v[206:207], v230 offset:4352
    buffer_load_dwordx4 v233, s[44:47], s63 offen offset:2048 sc1 lds
    v_mfma_f32_16x16x32_bf16 v[44:47], v[220:223], v[172:175], v[44:47]
    ds_read_b64_tr_b16 v[208:209], v240 offset:256
    v_mfma_f32_16x16x32_bf16 v[48:51], v[224:227], v[172:175], v[48:51]
    ds_read_b64_tr_b16 v[210:211], v240 offset:4352
    v_mfma_f32_16x16x32_bf16 v[52:55], v[212:215], v[176:179], v[52:55]
    ds_read_b128 v[140:143], v228 offset:2048
    buffer_load_dwordx4 v233, s[44:47], s63 offen offset:3072 sc1 lds
    v_mfma_f32_16x16x32_bf16 v[56:59], v[216:219], v[176:179], v[56:59]
    ds_read_b128 v[144:147], v228 offset:2304
    s_add_u32 s63, s63, 2048
    v_mfma_f32_16x16x32_bf16 v[60:63], v[220:223], v[176:179], v[60:63]
    ds_read_b128 v[148:151], v228 offset:4096
    s_add_u32 m0, s60, 49152
    v_mfma_f32_16x16x32_bf16 v[64:67], v[224:227], v[176:179], v[64:67]
    ds_read_b128 v[152:155], v228 offset:4352
    buffer_load_dwordx4 v234, s[48:51], s55 offen offset:0 lds
    v_mfma_f32_16x16x32_bf16 v[68:71], v[212:215], v[180:183], v[68:71]
    ds_read_b128 v[156:159], v228 offset:6144
    v_mfma_f32_16x16x32_bf16 v[72:75], v[216:219], v[180:183], v[72:75]
    ds_read_b128 v[160:163], v228 offset:6400
    v_mfma_f32_16x16x32_bf16 v[76:79], v[220:223], v[180:183], v[76:79]
    buffer_load_dwordx4 v235, s[48:51], s55 offen offset:1024 lds
    v_mfma_f32_16x16x32_bf16 v[80:83], v[224:227], v[180:183], v[80:83]
    s_add_u32 s55, s55, s56
    v_mfma_f32_16x16x32_bf16 v[84:87], v[212:215], v[184:187], v[84:87]
    v_mfma_f32_16x16x32_bf16 v[88:91], v[216:219], v[184:187], v[88:91]
    v_mfma_f32_16x16x32_bf16 v[92:95], v[220:223], v[184:187], v[92:95]
    v_mfma_f32_16x16x32_bf16 v[96:99], v[224:227], v[184:187], v[96:99]
    v_mfma_f32_16x16x32_bf16 v[100:103], v[212:215], v[188:191], v[100:103]
    v_mfma_f32_16x16x32_bf16 v[104:107], v[216:219], v[188:191], v[104:107]
    v_mfma_f32_16x16x32_bf16 v[108:111], v[220:223], v[188:191], v[108:111]
    v_mfma_f32_16x16x32_bf16 v[112:115], v[224:227], v[188:191], v[112:115]
    v_mfma_f32_16x16x32_bf16 v[116:119], v[212:215], v[192:195], v[116:119]
    v_mfma_f32_16x16x32_bf16 v[120:123], v[216:219], v[192:195], v[120:123]
    v_mfma_f32_16x16x32_bf16 v[124:127], v[220:223], v[192:195], v[124:127]
    v_mfma_f32_16x16x32_bf16 v[128:131], v[224:227], v[192:195], v[128:131]
    s_waitcnt lgkmcnt(13)
    v_mfma_f32_16x16x32_bf16 v[4:7], v[196:199], v[132:135], v[4:7]
    s_waitcnt vmcnt(6) lgkmcnt(0)
    v_mfma_f32_16x16x32_bf16 v[8:11], v[200:203], v[132:135], v[8:11]
    s_barrier
    v_mfma_f32_16x16x32_bf16 v[20:23], v[196:199], v[136:139], v[20:23]
    ds_read_b64_tr_b16 v[212:213], v230 offset:24576
    s_add_u32 m0, s57, 0
    v_mfma_f32_16x16x32_bf16 v[24:27], v[200:203], v[136:139], v[24:27]
    ds_read_b64_tr_b16 v[214:215], v230 offset:28672
    buffer_load_dwordx4 v233, s[44:47], s62 offen offset:0 sc1 lds
    v_mfma_f32_16x16x32_bf16 v[12:15], v[204:207], v[132:135], v[12:15]
    ds_read_b128 v[164:167], v228 offset:24576
    v_mfma_f32_16x16x32_bf16 v[28:31], v[204:207], v[136:139], v[28:31]
    ds_read_b64_tr_b16 v[216:217], v240 offset:24576
    v_mfma_f32_16x16x32_bf16 v[16:19], v[208:211], v[132:135], v[16:19]
    ds_read_b64_tr_b16 v[218:219], v240 offset:28672
    buffer_load_dwordx4 v233, s[44:47], s62 offen offset:1024 sc1 lds
    v_mfma_f32_16x16x32_bf16 v[32:35], v[208:211], v[136:139], v[32:35]
    ds_read_b128 v[168:171], v228 offset:24832
    s_add_u32 s62, s62, 2048
    v_mfma_f32_16x16x32_bf16 v[36:39], v[196:199], v[140:143], v[36:39]
    ds_read_b64_tr_b16 v[220:221], v230 offset:24832
    v_mfma_f32_16x16x32_bf16 v[40:43], v[200:203], v[140:143], v[40:43]
    ds_read_b64_tr_b16 v[222:223], v230 offset:28928
    buffer_load_dwordx4 v233, s[44:47], s63 offen offset:2048 sc1 lds
    v_mfma_f32_16x16x32_bf16 v[44:47], v[204:207], v[140:143], v[44:47]
    ds_read_b64_tr_b16 v[224:225], v240 offset:24832
    v_mfma_f32_16x16x32_bf16 v[48:51], v[208:211], v[140:143], v[48:51]
    ds_read_b64_tr_b16 v[226:227], v240 offset:28928
    v_mfma_f32_16x16x32_bf16 v[52:55], v[196:199], v[144:147], v[52:55]
    ds_read_b128 v[172:175], v228 offset:26624
    buffer_load_dwordx4 v233, s[44:47], s63 offen offset:3072 sc1 lds
    v_mfma_f32_16x16x32_bf16 v[56:59], v[200:203], v[144:147], v[56:59]
    ds_read_b128 v[176:179], v228 offset:26880
    s_add_u32 s63, s63, 2048
    v_mfma_f32_16x16x32_bf16 v[60:63], v[204:207], v[144:147], v[60:63]
    ds_read_b128 v[180:183], v228 offset:28672
    s_add_u32 m0, s60, 0
    v_mfma_f32_16x16x32_bf16 v[64:67], v[208:211], v[144:147], v[64:67]
    ds_read_b128 v[184:187], v228 offset:28928
    buffer_load_dwordx4 v234, s[48:51], s55 offen offset:0 lds
    v_mfma_f32_16x16x32_bf16 v[68:71], v[196:199], v[148:151], v[68:71]
    ds_read_b128 v[188:191], v228 offset:30720
    v_mfma_f32_16x16x32_bf16 v[72:75], v[200:203], v[148:151], v[72:75]
    ds_read_b128 v[192:195], v228 offset:30976
    v_mfma_f32_16x16x32_bf16 v[76:79], v[204:207], v[148:151], v[76:79]
    buffer_load_dwordx4 v235, s[48:51], s55 offen offset:1024 lds
    v_mfma_f32_16x16x32_bf16 v[80:83], v[208:211], v[148:151], v[80:83]
    s_add_u32 s55, s55, s56
    v_mfma_f32_16x16x32_bf16 v[84:87], v[196:199], v[152:155], v[84:87]
    v_mfma_f32_16x16x32_bf16 v[88:91], v[200:203], v[152:155], v[88:91]
    v_mfma_f32_16x16x32_bf16 v[92:95], v[204:207], v[152:155], v[92:95]
    v_mfma_f32_16x16x32_bf16 v[96:99], v[208:211], v[152:155], v[96:99]
    v_mfma_f32_16x16x32_bf16 v[100:103], v[196:199], v[156:159], v[100:103]
    v_mfma_f32_16x16x32_bf16 v[104:107], v[200:203], v[156:159], v[104:107]
    v_mfma_f32_16x16x32_bf16 v[108:111], v[204:207], v[156:159], v[108:111]
    v_mfma_f32_16x16x32_bf16 v[112:115], v[208:211], v[156:159], v[112:115]
    v_mfma_f32_16x16x32_bf16 v[116:119], v[196:199], v[160:163], v[116:119]
    v_mfma_f32_16x16x32_bf16 v[120:123], v[200:203], v[160:163], v[120:123]
    v_mfma_f32_16x16x32_bf16 v[124:127], v[204:207], v[160:163], v[124:127]
    v_mfma_f32_16x16x32_bf16 v[128:131], v[208:211], v[160:163], v[128:131]
    s_add_u32 s61, s61, 1
    s_cmp_lg_u32 s61, 5
    s_waitcnt lgkmcnt(13)
    v_mfma_f32_16x16x32_bf16 v[4:7], v[212:215], v[164:167], v[4:7]
    s_waitcnt vmcnt(6) lgkmcnt(0)
    v_mfma_f32_16x16x32_bf16 v[8:11], v[216:219], v[164:167], v[8:11]
    s_barrier
    s_cbranch_scc1 g4_loop
    v_mfma_f32_16x16x32_bf16 v[20:23], v[212:215], v[168:171], v[20:23]
    ds_read_b64_tr_b16 v[196:197], v231 offset:0
    s_add_u32 m0, s57, 24576
    v_mfma_f32_16x16x32_bf16 v[24:27], v[216:219], v[168:171], v[24:27]
    ds_read_b64_tr_b16 v[198:199], v231 offset:4096
    buffer_load_dwordx4 v233, s[44:47], s62 offen offset:0 sc1 lds
    v_mfma_f32_16x16x32_bf16 v[12:15], v[220:223], v[164:167], v[12:15]
    ds_read_b128 v[132:135], v229 offset:0
    v_mfma_f32_16x16x32_bf16 v[28:31], v[220:223], v[168:171], v[28:31]
    ds_read_b64_tr_b16 v[200:201], v241 offset:0
    v_mfma_f32_16x16x32_bf16 v[16:19], v[224:227], v[164:167], v[16:19]
    ds_read_b64_tr_b16 v[202:203], v241 offset:4096
    buffer_load_dwordx4 v233, s[44:47], s62 offen offset:1024 sc1 lds
    v_mfma_f32_16x16x32_bf16 v[32:35], v[224:227], v[168:171], v[32:35]
    ds_read_b128 v[136:139], v229 offset:256
    s_add_u32 s62, s62, 2048
    v_mfma_f32_16x16x32_bf16 v[36:39], v[212:215], v[172:175], v[36:39]
    ds_read_b64_tr_b16 v[204:205], v231 offset:256
    v_mfma_f32_16x16x32_bf16 v[40:43], v[216:219], v[172:175], v[40:43]
    ds_read_b64_tr_b16 v[206:207], v231 offset:4352
    buffer_load_dwordx4 v233, s[44:47], s63 offen offset:2048 sc1 lds
    v_mfma_f32_16x16x32_bf16 v[44:47], v[220:223], v[172:175], v[44:47]
    ds_read_b64_tr_b16 v[208:209], v241 offset:256
    v_mfma_f32_16x16x32_bf16 v[48:51], v[224:227], v[172:175], v[48:51]
    ds_read_b64_tr_b16 v[210:211], v241 offset:4352
    v_mfma_f32_16x16x32_bf16 v[52:55], v[212:215], v[176:179], v[52:55]
    ds_read_b128 v[140:143], v229 offset:2048
    buffer_load_dwordx4 v233, s[44:47], s63 offen offset:3072 sc1 lds
    v_mfma_f32_16x16x32_bf16 v[56:59], v[216:219], v[176:179], v[56:59]
    ds_read_b128 v[144:147], v229 offset:2304
    s_add_u32 s63, s63, 2048
    v_mfma_f32_16x16x32_bf16 v[60:63], v[220:223], v[176:179], v[60:63]
    ds_read_b128 v[148:151], v229 offset:4096
    s_add_u32 m0, s60, 24576
    v_mfma_f32_16x16x32_bf16 v[64:67], v[224:227], v[176:179], v[64:67]
    ds_read_b128 v[152:155], v229 offset:4352
    buffer_load_dwordx4 v234, s[48:51], s55 offen offset:0 lds
    v_mfma_f32_16x16x32_bf16 v[68:71], v[212:215], v[180:183], v[68:71]
    ds_read_b128 v[156:159], v229 offset:6144
    v_mfma_f32_16x16x32_bf16 v[72:75], v[216:219], v[180:183], v[72:75]
    ds_read_b128 v[160:163], v229 offset:6400
    v_mfma_f32_16x16x32_bf16 v[76:79], v[220:223], v[180:183], v[76:79]
    buffer_load_dwordx4 v235, s[48:51], s55 offen offset:1024 lds
    v_mfma_f32_16x16x32_bf16 v[80:83], v[224:227], v[180:183], v[80:83]
    s_add_u32 s55, s55, s56
    v_mfma_f32_16x16x32_bf16 v[84:87], v[212:215], v[184:187], v[84:87]
    v_mfma_f32_16x16x32_bf16 v[88:91], v[216:219], v[184:187], v[88:91]
    v_mfma_f32_16x16x32_bf16 v[92:95], v[220:223], v[184:187], v[92:95]
    v_mfma_f32_16x16x32_bf16 v[96:99], v[224:227], v[184:187], v[96:99]
    v_mfma_f32_16x16x32_bf16 v[100:103], v[212:215], v[188:191], v[100:103]
    v_mfma_f32_16x16x32_bf16 v[104:107], v[216:219], v[188:191], v[104:107]
    v_mfma_f32_16x16x32_bf16 v[108:111], v[220:223], v[188:191], v[108:111]
    v_mfma_f32_16x16x32_bf16 v[112:115], v[224:227], v[188:191], v[112:115]
    v_mfma_f32_16x16x32_bf16 v[116:119], v[212:215], v[192:195], v[116:119]
    v_mfma_f32_16x16x32_bf16 v[120:123], v[216:219], v[192:195], v[120:123]
    v_mfma_f32_16x16x32_bf16 v[124:127], v[220:223], v[192:195], v[124:127]
    v_mfma_f32_16x16x32_bf16 v[128:131], v[224:227], v[192:195], v[128:131]
    s_waitcnt lgkmcnt(13)
    v_mfma_f32_16x16x32_bf16 v[4:7], v[196:199], v[132:135], v[4:7]
    s_waitcnt vmcnt(6) lgkmcnt(0)
    v_mfma_f32_16x16x32_bf16 v[8:11], v[200:203], v[132:135], v[8:11]
    s_barrier
    v_mfma_f32_16x16x32_bf16 v[20:23], v[196:199], v[136:139], v[20:23]
    ds_read_b64_tr_b16 v[212:213], v230 offset:0
    s_add_u32 m0, s57, 49152
    v_mfma_f32_16x16x32_bf16 v[24:27], v[200:203], v[136:139], v[24:27]
    ds_read_b64_tr_b16 v[214:215], v230 offset:4096
    buffer_load_dwordx4 v233, s[44:47], s62 offen offset:0 sc1 lds
    v_mfma_f32_16x16x32_bf16 v[12:15], v[204:207], v[132:135], v[12:15]
    ds_read_b128 v[164:167], v228 offset:0
    v_mfma_f32_16x16x32_bf16 v[28:31], v[204:207], v[136:139], v[28:31]
    ds_read_b64_tr_b16 v[216:217], v240 offset:0
    v_mfma_f32_16x16x32_bf16 v[16:19], v[208:211], v[132:135], v[16:19]
    ds_read_b64_tr_b16 v[218:219], v240 offset:4096
    buffer_load_dwordx4 v233, s[44:47], s62 offen offset:1024 sc1 lds
    v_mfma_f32_16x16x32_bf16 v[32:35], v[208:211], v[136:139], v[32:35]
    ds_read_b128 v[168:171], v228 offset:256
    s_add_u32 s62, s62, 2048
    v_mfma_f32_16x16x32_bf16 v[36:39], v[196:199], v[140:143], v[36:39]
    ds_read_b64_tr_b16 v[220:221], v230 offset:256
    v_mfma_f32_16x16x32_bf16 v[40:43], v[200:203], v[140:143], v[40:43]
    ds_read_b64_tr_b16 v[222:223], v230 offset:4352
    buffer_load_dwordx4 v233, s[44:47], s63 offen offset:2048 sc1 lds
    v_mfma_f32_16x16x32_bf16 v[44:47], v[204:207], v[140:143], v[44:47]
    ds_read_b64_tr_b16 v[224:225], v240 offset:256
    v_mfma_f32_16x16x32_bf16 v[48:51], v[208:211], v[140:143], v[48:51]
    ds_read_b64_tr_b16 v[226:227], v240 offset:4352
    v_mfma_f32_16x16x32_bf16 v[52:55], v[196:199], v[144:147], v[52:55]
    ds_read_b128 v[172:175], v228 offset:2048
    buffer_load_dwordx4 v233, s[44:47], s63 offen offset:3072 sc1 lds
    v_mfma_f32_16x16x32_bf16 v[56:59], v[200:203], v[144:147], v[56:59]
    ds_read_b128 v[176:179], v228 offset:2304
    s_add_u32 s63, s63, 2048
    v_mfma_f32_16x16x32_bf16 v[60:63], v[204:207], v[144:147], v[60:63]
    ds_read_b128 v[180:183], v228 offset:4096
    s_add_u32 m0, s60, 49152
    v_mfma_f32_16x16x32_bf16 v[64:67], v[208:211], v[144:147], v[64:67]
    ds_read_b128 v[184:187], v228 offset:4352
    buffer_load_dwordx4 v234, s[48:51], s55 offen offset:0 lds
    v_mfma_f32_16x16x32_bf16 v[68:71], v[196:199], v[148:151], v[68:71]
    ds_read_b128 v[188:191], v228 offset:6144
    v_mfma_f32_16x16x32_bf16 v[72:75], v[200:203], v[148:151], v[72:75]
    ds_read_b128 v[192:195], v228 offset:6400
    v_mfma_f32_16x16x32_bf16 v[76:79], v[204:207], v[148:151], v[76:79]
    buffer_load_dwordx4 v235, s[48:51], s55 offen offset:1024 lds
    v_mfma_f32_16x16x32_bf16 v[80:83], v[208:211], v[148:151], v[80:83]
    s_add_u32 s55, s55, s56
    v_mfma_f32_16x16x32_bf16 v[84:87], v[196:199], v[152:155], v[84:87]
    v_mfma_f32_16x16x32_bf16 v[88:91], v[200:203], v[152:155], v[88:91]
    v_mfma_f32_16x16x32_bf16 v[92:95], v[204:207], v[152:155], v[92:95]
    v_mfma_f32_16x16x32_bf16 v[96:99], v[208:211], v[152:155], v[96:99]
    v_mfma_f32_16x16x32_bf16 v[100:103], v[196:199], v[156:159], v[100:103]
    v_mfma_f32_16x16x32_bf16 v[104:107], v[200:203], v[156:159], v[104:107]
    v_mfma_f32_16x16x32_bf16 v[108:111], v[204:207], v[156:159], v[108:111]
    v_mfma_f32_16x16x32_bf16 v[112:115], v[208:211], v[156:159], v[112:115]
    v_mfma_f32_16x16x32_bf16 v[116:119], v[196:199], v[160:163], v[116:119]
    v_mfma_f32_16x16x32_bf16 v[120:123], v[200:203], v[160:163], v[120:123]
    v_mfma_f32_16x16x32_bf16 v[124:127], v[204:207], v[160:163], v[124:127]
    v_mfma_f32_16x16x32_bf16 v[128:131], v[208:211], v[160:163], v[128:131]
    s_waitcnt lgkmcnt(13)
    v_mfma_f32_16x16x32_bf16 v[4:7], v[212:215], v[164:167], v[4:7]
    s_waitcnt vmcnt(6) lgkmcnt(0)
    v_mfma_f32_16x16x32_bf16 v[8:11], v[216:219], v[164:167], v[8:11]
    s_barrier
    v_mfma_f32_16x16x32_bf16 v[20:23], v[212:215], v[168:171], v[20:23]
    ds_read_b64_tr_b16 v[196:197], v230 offset:24576
    v_mfma_f32_16x16x32_bf16 v[24:27], v[216:219], v[168:171], v[24:27]
    ds_read_b64_tr_b16 v[198:199], v230 offset:28672
    v_mfma_f32_16x16x32_bf16 v[12:15], v[220:223], v[164:167], v[12:15]
    ds_read_b128 v[132:135], v228 offset:24576
    v_mfma_f32_16x16x32_bf16 v[28:31], v[220:223], v[168:171], v[28:31]
    ds_read_b64_tr_b16 v[200:201], v240 offset:24576
    v_mfma_f32_16x16x32_bf16 v[16:19], v[224:227], v[164:167], v[16:19]
    ds_read_b64_tr_b16 v[202:203], v240 offset:28672
    v_mfma_f32_16x16x32_bf16 v[32:35], v[224:227], v[168:171], v[32:35]
    ds_read_b128 v[136:139], v228 offset:24832
    v_mfma_f32_16x16x32_bf16 v[36:39], v[212:215], v[172:175], v[36:39]
    ds_read_b64_tr_b16 v[204:205], v230 offset:24832
    v_mfma_f32_16x16x32_bf16 v[40:43], v[216:219], v[172:175], v[40:43]
    ds_read_b64_tr_b16 v[206:207], v230 offset:28928
    v_mfma_f32_16x16x32_bf16 v[44:47], v[220:223], v[172:175], v[44:47]
    ds_read_b64_tr_b16 v[208:209], v240 offset:24832
    v_mfma_f32_16x16x32_bf16 v[48:51], v[224:227], v[172:175], v[48:51]
    ds_read_b64_tr_b16 v[210:211], v240 offset:28928
    v_mfma_f32_16x16x32_bf16 v[52:55], v[212:215], v[176:179], v[52:55]
    ds_read_b128 v[140:143], v228 offset:26624
    v_mfma_f32_16x16x32_bf16 v[56:59], v[216:219], v[176:179], v[56:59]
    ds_read_b128 v[144:147], v228 offset:26880
    v_mfma_f32_16x16x32_bf16 v[60:63], v[220:223], v[176:179], v[60:63]
    ds_read_b128 v[148:151], v228 offset:28672
    v_mfma_f32_16x16x32_bf16 v[64:67], v[224:227], v[176:179], v[64:67]
    ds_read_b128 v[152:155], v228 offset:28928
    v_mfma_f32_16x16x32_bf16 v[68:71], v[212:215], v[180:183], v[68:71]
    ds_read_b128 v[156:159], v228 offset:30720
    v_mfma_f32_16x16x32_bf16 v[72:75], v[216:219], v[180:183], v[72:75]
    ds_read_b128 v[160:163], v228 offset:30976
    v_mfma_f32_16x16x32_bf16 v[76:79], v[220:223], v[180:183], v[76:79]
    v_mfma_f32_16x16x32_bf16 v[80:83], v[224:227], v[180:183], v[80:83]
    v_mfma_f32_16x16x32_bf16 v[84:87], v[212:215], v[184:187], v[84:87]
    v_mfma_f32_16x16x32_bf16 v[88:91], v[216:219], v[184:187], v[88:91]
    v_mfma_f32_16x16x32_bf16 v[92:95], v[220:223], v[184:187], v[92:95]
    v_mfma_f32_16x16x32_bf16 v[96:99], v[224:227], v[184:187], v[96:99]
    v_mfma_f32_16x16x32_bf16 v[100:103], v[212:215], v[188:191], v[100:103]
    v_mfma_f32_16x16x32_bf16 v[104:107], v[216:219], v[188:191], v[104:107]
    v_mfma_f32_16x16x32_bf16 v[108:111], v[220:223], v[188:191], v[108:111]
    v_mfma_f32_16x16x32_bf16 v[112:115], v[224:227], v[188:191], v[112:115]
    v_mfma_f32_16x16x32_bf16 v[116:119], v[212:215], v[192:195], v[116:119]
    v_mfma_f32_16x16x32_bf16 v[120:123], v[216:219], v[192:195], v[120:123]
    v_mfma_f32_16x16x32_bf16 v[124:127], v[220:223], v[192:195], v[124:127]
    v_mfma_f32_16x16x32_bf16 v[128:131], v[224:227], v[192:195], v[128:131]
    s_waitcnt lgkmcnt(13)
    v_mfma_f32_16x16x32_bf16 v[4:7], v[196:199], v[132:135], v[4:7]
    s_waitcnt vmcnt(0) lgkmcnt(0)
    v_mfma_f32_16x16x32_bf16 v[8:11], v[200:203], v[132:135], v[8:11]
    s_barrier
    v_mfma_f32_16x16x32_bf16 v[20:23], v[196:199], v[136:139], v[20:23]
    ds_read_b64_tr_b16 v[212:213], v231 offset:0
    v_mfma_f32_16x16x32_bf16 v[24:27], v[200:203], v[136:139], v[24:27]
    ds_read_b64_tr_b16 v[214:215], v231 offset:4096
    v_mfma_f32_16x16x32_bf16 v[12:15], v[204:207], v[132:135], v[12:15]
    ds_read_b128 v[164:167], v229 offset:0
    v_mfma_f32_16x16x32_bf16 v[28:31], v[204:207], v[136:139], v[28:31]
    ds_read_b64_tr_b16 v[216:217], v241 offset:0
    v_mfma_f32_16x16x32_bf16 v[16:19], v[208:211], v[132:135], v[16:19]
    ds_read_b64_tr_b16 v[218:219], v241 offset:4096
    v_mfma_f32_16x16x32_bf16 v[32:35], v[208:211], v[136:139], v[32:35]
    ds_read_b128 v[168:171], v229 offset:256
    v_mfma_f32_16x16x32_bf16 v[36:39], v[196:199], v[140:143], v[36:39]
    ds_read_b64_tr_b16 v[220:221], v231 offset:256
    v_mfma_f32_16x16x32_bf16 v[40:43], v[200:203], v[140:143], v[40:43]
    ds_read_b64_tr_b16 v[222:223], v231 offset:4352
    v_mfma_f32_16x16x32_bf16 v[44:47], v[204:207], v[140:143], v[44:47]
    ds_read_b64_tr_b16 v[224:225], v241 offset:256
    v_mfma_f32_16x16x32_bf16 v[48:51], v[208:211], v[140:143], v[48:51]
    ds_read_b64_tr_b16 v[226:227], v241 offset:4352
    v_mfma_f32_16x16x32_bf16 v[52:55], v[196:199], v[144:147], v[52:55]
    ds_read_b128 v[172:175], v229 offset:2048
    v_mfma_f32_16x16x32_bf16 v[56:59], v[200:203], v[144:147], v[56:59]
    ds_read_b128 v[176:179], v229 offset:2304
    v_mfma_f32_16x16x32_bf16 v[60:63], v[204:207], v[144:147], v[60:63]
    ds_read_b128 v[180:183], v229 offset:4096
    v_mfma_f32_16x16x32_bf16 v[64:67], v[208:211], v[144:147], v[64:67]
    ds_read_b128 v[184:187], v229 offset:4352
    v_mfma_f32_16x16x32_bf16 v[68:71], v[196:199], v[148:151], v[68:71]
    ds_read_b128 v[188:191], v229 offset:6144
    v_mfma_f32_16x16x32_bf16 v[72:75], v[200:203], v[148:151], v[72:75]
    ds_read_b128 v[192:195], v229 offset:6400
    v_mfma_f32_16x16x32_bf16 v[76:79], v[204:207], v[148:151], v[76:79]
    v_mfma_f32_16x16x32_bf16 v[80:83], v[208:211], v[148:151], v[80:83]
    v_mfma_f32_16x16x32_bf16 v[84:87], v[196:199], v[152:155], v[84:87]
    v_mfma_f32_16x16x32_bf16 v[88:91], v[200:203], v[152:155], v[88:91]
    v_mfma_f32_16x16x32_bf16 v[92:95], v[204:207], v[152:155], v[92:95]
    v_mfma_f32_16x16x32_bf16 v[96:99], v[208:211], v[152:155], v[96:99]
    v_mfma_f32_16x16x32_bf16 v[100:103], v[196:199], v[156:159], v[100:103]
    v_mfma_f32_16x16x32_bf16 v[104:107], v[200:203], v[156:159], v[104:107]
    v_mfma_f32_16x16x32_bf16 v[108:111], v[204:207], v[156:159], v[108:111]
    v_mfma_f32_16x16x32_bf16 v[112:115], v[208:211], v[156:159], v[112:115]
    v_mfma_f32_16x16x32_bf16 v[116:119], v[196:199], v[160:163], v[116:119]
    v_mfma_f32_16x16x32_bf16 v[120:123], v[200:203], v[160:163], v[120:123]
    v_mfma_f32_16x16x32_bf16 v[124:127], v[204:207], v[160:163], v[124:127]
    v_mfma_f32_16x16x32_bf16 v[128:131], v[208:211], v[160:163], v[128:131]
    s_waitcnt lgkmcnt(13)
    v_mfma_f32_16x16x32_bf16 v[4:7], v[212:215], v[164:167], v[4:7]
    s_waitcnt lgkmcnt(11)
    v_mfma_f32_16x16x32_bf16 v[8:11], v[216:219], v[164:167], v[8:11]
    s_waitcnt lgkmcnt(10)
    v_mfma_f32_16x16x32_bf16 v[20:23], v[212:215], v[168:171], v[20:23]
    v_mfma_f32_16x16x32_bf16 v[24:27], v[216:219], v[168:171], v[24:27]
    s_waitcnt lgkmcnt(8)
    v_mfma_f32_16x16x32_bf16 v[12:15], v[220:223], v[164:167], v[12:15]
    v_mfma_f32_16x16x32_bf16 v[28:31], v[220:223], v[168:171], v[28:31]
    s_waitcnt lgkmcnt(6)
    v_mfma_f32_16x16x32_bf16 v[16:19], v[224:227], v[164:167], v[16:19]
    v_mfma_f32_16x16x32_bf16 v[32:35], v[224:227], v[168:171], v[32:35]
    s_waitcnt lgkmcnt(5)
    v_mfma_f32_16x16x32_bf16 v[36:39], v[212:215], v[172:175], v[36:39]
    v_mfma_f32_16x16x32_bf16 v[40:43], v[216:219], v[172:175], v[40:43]
    v_mfma_f32_16x16x32_bf16 v[44:47], v[220:223], v[172:175], v[44:47]
    v_mfma_f32_16x16x32_bf16 v[48:51], v[224:227], v[172:175], v[48:51]
    s_waitcnt lgkmcnt(4)
    v_mfma_f32_16x16x32_bf16 v[52:55], v[212:215], v[176:179], v[52:55]
    v_mfma_f32_16x16x32_bf16 v[56:59], v[216:219], v[176:179], v[56:59]
    v_mfma_f32_16x16x32_bf16 v[60:63], v[220:223], v[176:179], v[60:63]
    v_mfma_f32_16x16x32_bf16 v[64:67], v[224:227], v[176:179], v[64:67]
    s_waitcnt lgkmcnt(3)
    v_mfma_f32_16x16x32_bf16 v[68:71], v[212:215], v[180:183], v[68:71]
    v_mfma_f32_16x16x32_bf16 v[72:75], v[216:219], v[180:183], v[72:75]
    v_mfma_f32_16x16x32_bf16 v[76:79], v[220:223], v[180:183], v[76:79]
    v_mfma_f32_16x16x32_bf16 v[80:83], v[224:227], v[180:183], v[80:83]
    s_waitcnt lgkmcnt(2)
    v_mfma_f32_16x16x32_bf16 v[84:87], v[212:215], v[184:187], v[84:87]
    v_mfma_f32_16x16x32_bf16 v[88:91], v[216:219], v[184:187], v[88:91]
    v_mfma_f32_16x16x32_bf16 v[92:95], v[220:223], v[184:187], v[92:95]
    v_mfma_f32_16x16x32_bf16 v[96:99], v[224:227], v[184:187], v[96:99]
    s_waitcnt lgkmcnt(1)
    v_mfma_f32_16x16x32_bf16 v[100:103], v[212:215], v[188:191], v[100:103]
    v_mfma_f32_16x16x32_bf16 v[104:107], v[216:219], v[188:191], v[104:107]
    v_mfma_f32_16x16x32_bf16 v[108:111], v[220:223], v[188:191], v[108:111]
    v_mfma_f32_16x16x32_bf16 v[112:115], v[224:227], v[188:191], v[112:115]
    s_waitcnt lgkmcnt(0)
    v_mfma_f32_16x16x32_bf16 v[116:119], v[212:215], v[192:195], v[116:119]
    v_mfma_f32_16x16x32_bf16 v[120:123], v[216:219], v[192:195], v[120:123]
    v_mfma_f32_16x16x32_bf16 v[124:127], v[220:223], v[192:195], v[124:127]
    v_mfma_f32_16x16x32_bf16 v[128:131], v[224:227], v[192:195], v[128:131]
    s_branch g4_loop_done
g4_loop_mid:
    s_cmp_eq_u32 s61, 3
    s_cbranch_scc0 g4_h1
    s_lshr_b32 s64, s59, 8
    s_lshl_b32 s64, s64, 7
    s_add_u32 s64, s64, 41782272
    v_mov_b32 v242, 0
    buffer_load_dword v244, v242, s[8:11], s64 offen sc1
    s_mov_b32 s43, 4
    s_branch g4_hE
g4_h1:
    s_cmp_eq_u32 s61, 4
    s_cbranch_scc0 g4_h2
    s_lshr_b32 s64, s59, 8
    s_lshl_b32 s64, s64, 7
    s_add_u32 s64, s64, 41782272
    v_readfirstlane_b32 s65, v244
    s_nop 3
    s_cmp_ge_u32 s65, 32
    s_cbranch_scc1 k2_ckA
    v_mov_b32 v242, 0
    s_mov_b32 s66, 0
k2_pl11:
    buffer_load_dword v243, v242, s[8:11], s64 offen sc1
    s_waitcnt vmcnt(0)
    v_readfirstlane_b32 s65, v243
    s_nop 3
    s_cmp_ge_u32 s65, 32
    s_cbranch_scc1 k2_pk11
    s_add_u32 s66, s66, 1
    s_sleep 8
    s_cmp_lt_u32 s66, 0x40000
    s_cbranch_scc1 k2_pl11
k2_pk11:
k2_ckA:
    s_mov_b32 s48, s14
    s_mov_b32 s49, s15
    s_mov_b32 s50, 2097152
    s_mul_i32 s55, s67, 524288
    s_mul_i32 s64, s67, 40960
    s_add_u32 s64, s64, 122880
    s_sub_u32 s62, s62, s64
    s_sub_u32 s63, s63, s64
    s_mov_b32 s43, -1
    s_branch g4_hE
g4_h2:
g4_hE:
    s_branch g4_loop_back
g4_loop_done:
    s_nop 15
    s_setprio 2
    s_mul_i32 s69, s68, 196608
    s_lshl_b32 s64, s30, 12
    s_add_u32 s69, s69, s64
    s_add_u32 s69, s69, 52428800
    s_add_u32 s64, s67, 1
    s_and_b32 s64, s64, 3
    s_mul_i32 s64, s64, 49152
    s_add_u32 s64, s64, s69
    s_add_u32 s64, s64, 0
    v_cvt_pk_bf16_f32 v148, v36, v37
    v_cvt_pk_bf16_f32 v149, v38, v39
    v_cvt_pk_bf16_f32 v150, v40, v41
    v_cvt_pk_bf16_f32 v151, v42, v43
    buffer_store_dwordx4 v[148:151], v233, s[8:11], s64 offen offset:0 sc1
    v_cvt_pk_bf16_f32 v152, v44, v45
    v_cvt_pk_bf16_f32 v153, v46, v47
    v_cvt_pk_bf16_f32 v154, v48, v49
    v_cvt_pk_bf16_f32 v155, v50, v51
    buffer_store_dwordx4 v[152:155], v233, s[8:11], s64 offen offset:1024 sc1
    v_cvt_pk_bf16_f32 v156, v52, v53
    v_cvt_pk_bf16_f32 v157, v54, v55
    v_cvt_pk_bf16_f32 v158, v56, v57
    v_cvt_pk_bf16_f32 v159, v58, v59
    buffer_store_dwordx4 v[156:159], v233, s[8:11], s64 offen offset:2048 sc1
    v_cvt_pk_bf16_f32 v160, v60, v61
    v_cvt_pk_bf16_f32 v161, v62, v63
    v_cvt_pk_bf16_f32 v162, v64, v65
    v_cvt_pk_bf16_f32 v163, v66, v67
    buffer_store_dwordx4 v[160:163], v233, s[8:11], s64 offen offset:3072 sc1
    s_add_u32 s64, s67, 2
    s_and_b32 s64, s64, 3
    s_mul_i32 s64, s64, 49152
    s_add_u32 s64, s64, s69
    s_add_u32 s64, s64, 16384
    v_cvt_pk_bf16_f32 v132, v68, v69
    v_cvt_pk_bf16_f32 v133, v70, v71
    v_cvt_pk_bf16_f32 v134, v72, v73
    v_cvt_pk_bf16_f32 v135, v74, v75
    buffer_store_dwordx4 v[132:135], v233, s[8:11], s64 offen offset:0 sc1
    v_cvt_pk_bf16_f32 v136, v76, v77
    v_cvt_pk_bf16_f32 v137, v78, v79
    v_cvt_pk_bf16_f32 v138, v80, v81
    v_cvt_pk_bf16_f32 v139, v82, v83
    buffer_store_dwordx4 v[136:139], v233, s[8:11], s64 offen offset:1024 sc1
    v_cvt_pk_bf16_f32 v140, v84, v85
    v_cvt_pk_bf16_f32 v141, v86, v87
    v_cvt_pk_bf16_f32 v142, v88, v89
    v_cvt_pk_bf16_f32 v143, v90, v91
    buffer_store_dwordx4 v[140:143], v233, s[8:11], s64 offen offset:2048 sc1
    v_cvt_pk_bf16_f32 v144, v92, v93
    v_cvt_pk_bf16_f32 v145, v94, v95
    v_cvt_pk_bf16_f32 v146, v96, v97
    v_cvt_pk_bf16_f32 v147, v98, v99
    buffer_store_dwordx4 v[144:147], v233, s[8:11], s64 offen offset:3072 sc1
    s_add_u32 s64, s67, 3
    s_and_b32 s64, s64, 3
    s_mul_i32 s64, s64, 49152
    s_add_u32 s64, s64, s69
    s_add_u32 s64, s64, 32768
    v_cvt_pk_bf16_f32 v148, v100, v101
    v_cvt_pk_bf16_f32 v149, v102, v103
    v_cvt_pk_bf16_f32 v150, v104, v105
    v_cvt_pk_bf16_f32 v151, v106, v107
    buffer_store_dwordx4 v[148:151], v233, s[8:11], s64 offen offset:0 sc1
    v_cvt_pk_bf16_f32 v152, v108, v109
    v_cvt_pk_bf16_f32 v153, v110, v111
    v_cvt_pk_bf16_f32 v154, v112, v113
    v_cvt_pk_bf16_f32 v155, v114, v115
    buffer_store_dwordx4 v[152:155], v233, s[8:11], s64 offen offset:1024 sc1
    v_cvt_pk_bf16_f32 v156, v116, v117
    v_cvt_pk_bf16_f32 v157, v118, v119
    v_cvt_pk_bf16_f32 v158, v120, v121
    v_cvt_pk_bf16_f32 v159, v122, v123
    buffer_store_dwordx4 v[156:159], v233, s[8:11], s64 offen offset:2048 sc1
    v_cvt_pk_bf16_f32 v160, v124, v125
    v_cvt_pk_bf16_f32 v161, v126, v127
    v_cvt_pk_bf16_f32 v162, v128, v129
    v_cvt_pk_bf16_f32 v163, v130, v131
    buffer_store_dwordx4 v[160:163], v233, s[8:11], s64 offen offset:3072 sc1
    s_lshr_b32 s55, s59, 5
    s_lshl_b32 s64, s53, 2
    s_add_u32 s55, s55, s64
    s_add_u32 s55, s55, s67
    v_and_b32 v236, 15, v232
    v_lshrrev_b32 v237, 4, v232
    v_and_b32 v238, 1, v237
    v_lshrrev_b32 v239, 1, v237
    v_lshlrev_b32 v182, 4, v236
    v_lshl_add_u32 v182, v238, 9, v182
    v_lshl_add_u32 v182, v239, 3, v182
    s_lshl_b32 s64, s55, 5
    v_add_u32 v236, s64, v236
    v_lshlrev_b32 v184, 2, v236
    v_lshlrev_b32 v236, 11, v236
    v_lshl_add_u32 v236, v238, 5, v236
    v_lshl_add_u32 v236, v239, 4, v236
    s_lshl_b32 s64, s54, 6
    s_add_u32 s64, s64, s58
    s_lshl_b32 s65, s64, 1
    v_add_u32 v183, s65, v236
    s_lshl_b32 s64, s64, 6
    s_lshl_b32 s65, s55, 16
    s_add_u32 s64, s64, s65
    s_add_u32 s64, s64, 16777216
    buffer_load_dwordx2 v[164:165], v182, s[8:11], s64 offen offset:0 sc1
    buffer_load_dwordx2 v[166:167], v182, s[8:11], s64 offen offset:1024 sc1
    buffer_load_dwordx2 v[168:169], v182, s[8:11], s64 offen offset:2048 sc1
    buffer_load_dwordx2 v[170:171], v182, s[8:11], s64 offen offset:3072 sc1
    buffer_load_dwordx2 v[172:173], v182, s[8:11], s64 offen offset:256 sc1
    buffer_load_dwordx2 v[174:175], v182, s[8:11], s64 offen offset:1280 sc1
    buffer_load_dwordx2 v[176:177], v182, s[8:11], s64 offen offset:2304 sc1
    buffer_load_dwordx2 v[178:179], v182, s[8:11], s64 offen offset:3328 sc1
    s_mov_b32 s64, 41164800
    buffer_load_dword v180, v184, s[8:11], s64 offen offset:0 sc1
    buffer_load_dword v181, v184, s[8:11], s64 offen offset:64 sc1
    s_waitcnt vmcnt(0)
    s_barrier
    s_cmp_lg_u32 s30, 0
    s_cbranch_scc1 k2_ns12
    s_mov_b64 exec, 1
    v_mov_b32 v237, 0
    v_mov_b32 v238, 1
    buffer_atomic_add v238, v237, s[8:11], s70 offen sc1
    s_mov_b64 exec, -1
k2_ns12:
    s_cmp_lg_u32 s30, 0
    s_cbranch_scc1 k2_pw13
    v_mov_b32 v237, 0
    s_mov_b32 s66, 0
k2_pl14:
    buffer_load_dword v238, v237, s[8:11], s70 offen sc1
    s_waitcnt vmcnt(0)
    v_readfirstlane_b32 s65, v238
    s_nop 3
    s_cmp_ge_u32 s65, 4
    s_cbranch_scc1 k2_pk14
    s_add_u32 s66, s66, 1
    s_sleep 8
    s_cmp_lt_u32 s66, 0x40000
    s_cbranch_scc1 k2_pl14
k2_pk14:
k2_pw13:
    s_barrier
    s_mul_i32 s64, s67, 49152
    s_add_u32 s64, s64, s69
    buffer_load_dwordx4 v[36:39], v233, s[8:11], s64 offen offset:0 sc1
    buffer_load_dwordx4 v[40:43], v233, s[8:11], s64 offen offset:1024 sc1
    buffer_load_dwordx4 v[44:47], v233, s[8:11], s64 offen offset:2048 sc1
    buffer_load_dwordx4 v[48:51], v233, s[8:11], s64 offen offset:3072 sc1
    s_add_u32 s64, s64, 16384
    buffer_load_dwordx4 v[52:55], v233, s[8:11], s64 offen offset:0 sc1
    buffer_load_dwordx4 v[56:59], v233, s[8:11], s64 offen offset:1024 sc1
    buffer_load_dwordx4 v[60:63], v233, s[8:11], s64 offen offset:2048 sc1
    buffer_load_dwordx4 v[64:67], v233, s[8:11], s64 offen offset:3072 sc1
    s_add_u32 s64, s64, 16384
    buffer_load_dwordx4 v[68:71], v233, s[8:11], s64 offen offset:0 sc1
    buffer_load_dwordx4 v[72:75], v233, s[8:11], s64 offen offset:1024 sc1
    buffer_load_dwordx4 v[76:79], v233, s[8:11], s64 offen offset:2048 sc1
    buffer_load_dwordx4 v[80:83], v233, s[8:11], s64 offen offset:3072 sc1
    s_add_u32 s64, s64, 16384
    s_mov_b32 s64, 0
    s_waitcnt vmcnt(0)
    v_lshlrev_b32 v184, 16, v36
    v_and_b32 v185, 0xffff0000, v36
    v_pk_add_f32 v[4:5], v[4:5], v[184:185]
    v_lshlrev_b32 v184, 16, v52
    v_and_b32 v185, 0xffff0000, v52
    v_pk_add_f32 v[4:5], v[4:5], v[184:185]
    v_lshlrev_b32 v184, 16, v68
    v_and_b32 v185, 0xffff0000, v68
    v_pk_add_f32 v[4:5], v[4:5], v[184:185]
    v_lshlrev_b32 v236, 16, v164
    v_and_b32 v237, 0xffff0000, v164
    v_fma_f32 v236, v236, v180, v4
    v_fma_f32 v237, v237, v180, v5
    v_cvt_pk_bf16_f32 v132, v236, v237
    v_lshlrev_b32 v184, 16, v37
    v_and_b32 v185, 0xffff0000, v37
    v_pk_add_f32 v[6:7], v[6:7], v[184:185]
    v_lshlrev_b32 v184, 16, v53
    v_and_b32 v185, 0xffff0000, v53
    v_pk_add_f32 v[6:7], v[6:7], v[184:185]
    v_lshlrev_b32 v184, 16, v69
    v_and_b32 v185, 0xffff0000, v69
    v_pk_add_f32 v[6:7], v[6:7], v[184:185]
    v_lshlrev_b32 v236, 16, v165
    v_and_b32 v237, 0xffff0000, v165
    v_fma_f32 v236, v236, v180, v6
    v_fma_f32 v237, v237, v180, v7
    v_cvt_pk_bf16_f32 v133, v236, v237
    v_lshlrev_b32 v184, 16, v38
    v_and_b32 v185, 0xffff0000, v38
    v_pk_add_f32 v[8:9], v[8:9], v[184:185]
    v_lshlrev_b32 v184, 16, v54
    v_and_b32 v185, 0xffff0000, v54
    v_pk_add_f32 v[8:9], v[8:9], v[184:185]
    v_lshlrev_b32 v184, 16, v70
    v_and_b32 v185, 0xffff0000, v70
    v_pk_add_f32 v[8:9], v[8:9], v[184:185]
    v_lshlrev_b32 v236, 16, v166
    v_and_b32 v237, 0xffff0000, v166
    v_fma_f32 v236, v236, v180, v8
    v_fma_f32 v237, v237, v180, v9
    v_cvt_pk_bf16_f32 v134, v236, v237
    v_lshlrev_b32 v184, 16, v39
    v_and_b32 v185, 0xffff0000, v39
    v_pk_add_f32 v[10:11], v[10:11], v[184:185]
    v_lshlrev_b32 v184, 16, v55
    v_and_b32 v185, 0xffff0000, v55
    v_pk_add_f32 v[10:11], v[10:11], v[184:185]
    v_lshlrev_b32 v184, 16, v71
    v_and_b32 v185, 0xffff0000, v71
    v_pk_add_f32 v[10:11], v[10:11], v[184:185]
    v_lshlrev_b32 v236, 16, v167
    v_and_b32 v237, 0xffff0000, v167
    v_fma_f32 v236, v236, v180, v10
    v_fma_f32 v237, v237, v180, v11
    v_cvt_pk_bf16_f32 v135, v236, v237
    s_nop 1
    v_permlane16_swap_b32 v132, v134
    v_permlane16_swap_b32 v133, v135
    s_nop 0
    buffer_store_dwordx4 v[132:135], v183, s[32:35], s64 offen offset:0
    v_lshlrev_b32 v184, 16, v40
    v_and_b32 v185, 0xffff0000, v40
    v_pk_add_f32 v[12:13], v[12:13], v[184:185]
    v_lshlrev_b32 v184, 16, v56
    v_and_b32 v185, 0xffff0000, v56
    v_pk_add_f32 v[12:13], v[12:13], v[184:185]
    v_lshlrev_b32 v184, 16, v72
    v_and_b32 v185, 0xffff0000, v72
    v_pk_add_f32 v[12:13], v[12:13], v[184:185]
    v_lshlrev_b32 v236, 16, v168
    v_and_b32 v237, 0xffff0000, v168
    v_fma_f32 v236, v236, v180, v12
    v_fma_f32 v237, v237, v180, v13
    v_cvt_pk_bf16_f32 v136, v236, v237
    v_lshlrev_b32 v184, 16, v41
    v_and_b32 v185, 0xffff0000, v41
    v_pk_add_f32 v[14:15], v[14:15], v[184:185]
    v_lshlrev_b32 v184, 16, v57
    v_and_b32 v185, 0xffff0000, v57
    v_pk_add_f32 v[14:15], v[14:15], v[184:185]
    v_lshlrev_b32 v184, 16, v73
    v_and_b32 v185, 0xffff0000, v73
    v_pk_add_f32 v[14:15], v[14:15], v[184:185]
    v_lshlrev_b32 v236, 16, v169
    v_and_b32 v237, 0xffff0000, v169
    v_fma_f32 v236, v236, v180, v14
    v_fma_f32 v237, v237, v180, v15
    v_cvt_pk_bf16_f32 v137, v236, v237
    v_lshlrev_b32 v184, 16, v42
    v_and_b32 v185, 0xffff0000, v42
    v_pk_add_f32 v[16:17], v[16:17], v[184:185]
    v_lshlrev_b32 v184, 16, v58
    v_and_b32 v185, 0xffff0000, v58
    v_pk_add_f32 v[16:17], v[16:17], v[184:185]
    v_lshlrev_b32 v184, 16, v74
    v_and_b32 v185, 0xffff0000, v74
    v_pk_add_f32 v[16:17], v[16:17], v[184:185]
    v_lshlrev_b32 v236, 16, v170
    v_and_b32 v237, 0xffff0000, v170
    v_fma_f32 v236, v236, v180, v16
    v_fma_f32 v237, v237, v180, v17
    v_cvt_pk_bf16_f32 v138, v236, v237
    v_lshlrev_b32 v184, 16, v43
    v_and_b32 v185, 0xffff0000, v43
    v_pk_add_f32 v[18:19], v[18:19], v[184:185]
    v_lshlrev_b32 v184, 16, v59
    v_and_b32 v185, 0xffff0000, v59
    v_pk_add_f32 v[18:19], v[18:19], v[184:185]
    v_lshlrev_b32 v184, 16, v75
    v_and_b32 v185, 0xffff0000, v75
    v_pk_add_f32 v[18:19], v[18:19], v[184:185]
    v_lshlrev_b32 v236, 16, v171
    v_and_b32 v237, 0xffff0000, v171
    v_fma_f32 v236, v236, v180, v18
    v_fma_f32 v237, v237, v180, v19
    v_cvt_pk_bf16_f32 v139, v236, v237
    s_nop 1
    v_permlane16_swap_b32 v136, v138
    v_permlane16_swap_b32 v137, v139
    s_nop 0
    buffer_store_dwordx4 v[136:139], v183, s[32:35], s64 offen offset:64
    s_add_u32 s64, s64, 32768
    v_lshlrev_b32 v184, 16, v44
    v_and_b32 v185, 0xffff0000, v44
    v_pk_add_f32 v[20:21], v[20:21], v[184:185]
    v_lshlrev_b32 v184, 16, v60
    v_and_b32 v185, 0xffff0000, v60
    v_pk_add_f32 v[20:21], v[20:21], v[184:185]
    v_lshlrev_b32 v184, 16, v76
    v_and_b32 v185, 0xffff0000, v76
    v_pk_add_f32 v[20:21], v[20:21], v[184:185]
    v_lshlrev_b32 v236, 16, v172
    v_and_b32 v237, 0xffff0000, v172
    v_fma_f32 v236, v236, v181, v20
    v_fma_f32 v237, v237, v181, v21
    v_cvt_pk_bf16_f32 v140, v236, v237
    v_lshlrev_b32 v184, 16, v45
    v_and_b32 v185, 0xffff0000, v45
    v_pk_add_f32 v[22:23], v[22:23], v[184:185]
    v_lshlrev_b32 v184, 16, v61
    v_and_b32 v185, 0xffff0000, v61
    v_pk_add_f32 v[22:23], v[22:23], v[184:185]
    v_lshlrev_b32 v184, 16, v77
    v_and_b32 v185, 0xffff0000, v77
    v_pk_add_f32 v[22:23], v[22:23], v[184:185]
    v_lshlrev_b32 v236, 16, v173
    v_and_b32 v237, 0xffff0000, v173
    v_fma_f32 v236, v236, v181, v22
    v_fma_f32 v237, v237, v181, v23
    v_cvt_pk_bf16_f32 v141, v236, v237
    v_lshlrev_b32 v184, 16, v46
    v_and_b32 v185, 0xffff0000, v46
    v_pk_add_f32 v[24:25], v[24:25], v[184:185]
    v_lshlrev_b32 v184, 16, v62
    v_and_b32 v185, 0xffff0000, v62
    v_pk_add_f32 v[24:25], v[24:25], v[184:185]
    v_lshlrev_b32 v184, 16, v78
    v_and_b32 v185, 0xffff0000, v78
    v_pk_add_f32 v[24:25], v[24:25], v[184:185]
    v_lshlrev_b32 v236, 16, v174
    v_and_b32 v237, 0xffff0000, v174
    v_fma_f32 v236, v236, v181, v24
    v_fma_f32 v237, v237, v181, v25
    v_cvt_pk_bf16_f32 v142, v236, v237
    v_lshlrev_b32 v184, 16, v47
    v_and_b32 v185, 0xffff0000, v47
    v_pk_add_f32 v[26:27], v[26:27], v[184:185]
    v_lshlrev_b32 v184, 16, v63
    v_and_b32 v185, 0xffff0000, v63
    v_pk_add_f32 v[26:27], v[26:27], v[184:185]
    v_lshlrev_b32 v184, 16, v79
    v_and_b32 v185, 0xffff0000, v79
    v_pk_add_f32 v[26:27], v[26:27], v[184:185]
    v_lshlrev_b32 v236, 16, v175
    v_and_b32 v237, 0xffff0000, v175
    v_fma_f32 v236, v236, v181, v26
    v_fma_f32 v237, v237, v181, v27
    v_cvt_pk_bf16_f32 v143, v236, v237
    s_nop 1
    v_permlane16_swap_b32 v140, v142
    v_permlane16_swap_b32 v141, v143
    s_nop 0
    buffer_store_dwordx4 v[140:143], v183, s[32:35], s64 offen offset:0
    v_lshlrev_b32 v184, 16, v48
    v_and_b32 v185, 0xffff0000, v48
    v_pk_add_f32 v[28:29], v[28:29], v[184:185]
    v_lshlrev_b32 v184, 16, v64
    v_and_b32 v185, 0xffff0000, v64
    v_pk_add_f32 v[28:29], v[28:29], v[184:185]
    v_lshlrev_b32 v184, 16, v80
    v_and_b32 v185, 0xffff0000, v80
    v_pk_add_f32 v[28:29], v[28:29], v[184:185]
    v_lshlrev_b32 v236, 16, v176
    v_and_b32 v237, 0xffff0000, v176
    v_fma_f32 v236, v236, v181, v28
    v_fma_f32 v237, v237, v181, v29
    v_cvt_pk_bf16_f32 v144, v236, v237
    v_lshlrev_b32 v184, 16, v49
    v_and_b32 v185, 0xffff0000, v49
    v_pk_add_f32 v[30:31], v[30:31], v[184:185]
    v_lshlrev_b32 v184, 16, v65
    v_and_b32 v185, 0xffff0000, v65
    v_pk_add_f32 v[30:31], v[30:31], v[184:185]
    v_lshlrev_b32 v184, 16, v81
    v_and_b32 v185, 0xffff0000, v81
    v_pk_add_f32 v[30:31], v[30:31], v[184:185]
    v_lshlrev_b32 v236, 16, v177
    v_and_b32 v237, 0xffff0000, v177
    v_fma_f32 v236, v236, v181, v30
    v_fma_f32 v237, v237, v181, v31
    v_cvt_pk_bf16_f32 v145, v236, v237
    v_lshlrev_b32 v184, 16, v50
    v_and_b32 v185, 0xffff0000, v50
    v_pk_add_f32 v[32:33], v[32:33], v[184:185]
    v_lshlrev_b32 v184, 16, v66
    v_and_b32 v185, 0xffff0000, v66
    v_pk_add_f32 v[32:33], v[32:33], v[184:185]
    v_lshlrev_b32 v184, 16, v82
    v_and_b32 v185, 0xffff0000, v82
    v_pk_add_f32 v[32:33], v[32:33], v[184:185]
    v_lshlrev_b32 v236, 16, v178
    v_and_b32 v237, 0xffff0000, v178
    v_fma_f32 v236, v236, v181, v32
    v_fma_f32 v237, v237, v181, v33
    v_cvt_pk_bf16_f32 v146, v236, v237
    v_lshlrev_b32 v184, 16, v51
    v_and_b32 v185, 0xffff0000, v51
    v_pk_add_f32 v[34:35], v[34:35], v[184:185]
    v_lshlrev_b32 v184, 16, v67
    v_and_b32 v185, 0xffff0000, v67
    v_pk_add_f32 v[34:35], v[34:35], v[184:185]
    v_lshlrev_b32 v184, 16, v83
    v_and_b32 v185, 0xffff0000, v83
    v_pk_add_f32 v[34:35], v[34:35], v[184:185]
    v_lshlrev_b32 v236, 16, v179
    v_and_b32 v237, 0xffff0000, v179
    v_fma_f32 v236, v236, v181, v34
    v_fma_f32 v237, v237, v181, v35
    v_cvt_pk_bf16_f32 v147, v236, v237
    s_nop 1
    v_permlane16_swap_b32 v144, v146
    v_permlane16_swap_b32 v145, v147
    s_nop 0
    buffer_store_dwordx4 v[144:147], v183, s[32:35], s64 offen offset:64
    s_add_u32 s64, s64, 32768
k2_end:
    s_endpgm
code_end:
.fill 256, 4, 0xBF810000
.section .rodata,"a"
.p2align 6
.amdhsa_kernel k1_kernel
  .amdhsa_next_free_vgpr 240
  .amdhsa_next_free_sgpr 75
  .amdhsa_accum_offset 240
  .amdhsa_group_segment_fixed_size 0
  .amdhsa_kernarg_size 96
  .amdhsa_user_sgpr_count 2
  .amdhsa_user_sgpr_kernarg_segment_ptr 1
  .amdhsa_system_sgpr_workgroup_id_x 1
.end_amdhsa_kernel
.p2align 6
.amdhsa_kernel k2_kernel
  .amdhsa_next_free_vgpr 248
  .amdhsa_next_free_sgpr 71
  .amdhsa_accum_offset 248
  .amdhsa_group_segment_fixed_size 0
  .amdhsa_kernarg_size 96
  .amdhsa_user_sgpr_count 2
  .amdhsa_user_sgpr_kernarg_segment_ptr 1
  .amdhsa_system_sgpr_workgroup_id_x 1
.end_amdhsa_kernel
```
